```python
import torch

def _softmax(x, axis=-1):
    return torch.softmax(x, dim=axis)
def _gelu(x):
    return torch.nn.functional.gelu(x, approximate="tanh")
def _silu(x):
    return torch.nn.functional.silu(x)
def _sigmoid(x):
    return torch.sigmoid(x)
def _layernorm(x, axis=-1, eps=1e-5):
    m = x.mean(dim=axis, keepdim=True)
    v = x.var(dim=axis, keepdim=True, unbiased=False)
    return (x - m) / torch.sqrt(v + eps)
def _scatter_add(tgt, idx, src, axis=0):
    return tgt.clone().index_add_(axis, idx, src)
def _segment_sum(src, seg, n):
    out = torch.zeros((n,) + src.shape[1:], dtype=src.dtype)
    return out.index_add_(0, seg, src)
def _pad(x, pw):
    flat = tuple(v for pair in reversed(pw) for v in pair)
    return torch.nn.functional.pad(x, flat)

kernel_name = 'concat_heads__gqa_block_cached__gqa_block_cached__near_ridge'

def setup_inputs():

    _w = (lambda a: (lambda t: t.to(torch.bfloat16) if t.is_floating_point() else t)(torch.as_tensor(a)))
    def _A_setup():
        B, Sq, D = 8, 32, 512
        Hq, Hkv, Sk, Dh = 32, 8, 2048, 128
        assert Hq % Hkv == 0, (Hq, Hkv)
        return {
            "x": _w((lambda *s: torch.randn(*s, dtype=torch.bfloat16) * 0.8)(B, Sq, D)),
            "k_cache": _w((lambda *s: torch.randn(*s, dtype=torch.bfloat16) * 0.8)(B, Hkv, Sk, Dh)),
            "v_cache": _w((lambda *s: torch.randn(*s, dtype=torch.bfloat16) * 0.05)(B, Hkv, Sk, Dh)),
            "wq": _w((lambda *s: torch.randn(*s, dtype=torch.bfloat16) * 0.8)(D, Hq * Dh) * (D ** -0.5)),
            "wo": _w((lambda *s: torch.randn(*s, dtype=torch.bfloat16) * 0.05)(Hq * Dh, D) * ((Hq * Dh) ** -0.5)),
        }
    _A_in = _A_setup()

    def _B_setup():
        B, Sq, D = 8, 32, 512
        Hq, Hkv, Sk, Dh = 32, 8, 2048, 128
        assert Hq % Hkv == 0, (Hq, Hkv)
        return {
            "x": _w((lambda *s: torch.randn(*s, dtype=torch.bfloat16) * 0.8)(B, Sq, D)),
            "k_cache": _w((lambda *s: torch.randn(*s, dtype=torch.bfloat16) * 0.8)(B, Hkv, Sk, Dh)),
            "v_cache": _w((lambda *s: torch.randn(*s, dtype=torch.bfloat16) * 0.05)(B, Hkv, Sk, Dh)),
            "wq": _w((lambda *s: torch.randn(*s, dtype=torch.bfloat16) * 0.8)(D, Hq * Dh) * (D ** -0.5)),
            "wo": _w((lambda *s: torch.randn(*s, dtype=torch.bfloat16) * 0.05)(Hq * Dh, D) * ((Hq * Dh) ** -0.5)),
        }
    _B_in = _B_setup()

    return {
        "A_x": _A_in["x"],
        "A_k_cache": _A_in["k_cache"],
        "A_v_cache": _A_in["v_cache"],
        "A_wq": _A_in["wq"],
        "A_wo": _A_in["wo"],
        "B_x": _B_in["x"],
        "B_k_cache": _B_in["k_cache"],
        "B_v_cache": _B_in["v_cache"],
        "B_wq": _B_in["wq"],
        "B_wo": _B_in["wo"],
    }

def reference(A_x, A_k_cache, A_v_cache, A_wq, A_wo, B_x, B_k_cache, B_v_cache, B_wq, B_wo):
    def _A_ref(x, k_cache, v_cache, wq, wo):
        B, Sq, D = x.shape
        Hq, Dh = 32, 128
        Hkv = k_cache.shape[1]
        rep = Hq // Hkv
        q = (lambda x, *d: x.permute(*d))((x @ wq).reshape(B, Sq, Hq, Dh), 0, 2, 1, 3)
        k = (lambda x, n, axis: torch.repeat_interleave(x, n, dim=axis))(k_cache, rep, axis=1)
        v = (lambda x, n, axis: torch.repeat_interleave(x, n, dim=axis))(v_cache, rep, axis=1)
        scores = torch.einsum("bhqd,bhkd->bhqk", q, k) * (Dh ** -0.5)
        p = _softmax(scores, axis=-1)
        o = torch.einsum("bhqk,bhkd->bhqd", p, v)
        return (lambda x, *d: x.permute(*d))(o, 0, 2, 1, 3).reshape(B, Sq, Hq * Dh) @ wo

    def _B_ref(x, k_cache, v_cache, wq, wo):
        B, Sq, D = x.shape
        Hq, Dh = 32, 128
        Hkv = k_cache.shape[1]
        rep = Hq // Hkv
        q = (lambda x, *d: x.permute(*d))((x @ wq).reshape(B, Sq, Hq, Dh), 0, 2, 1, 3)
        k = (lambda x, n, axis: torch.repeat_interleave(x, n, dim=axis))(k_cache, rep, axis=1)
        v = (lambda x, n, axis: torch.repeat_interleave(x, n, dim=axis))(v_cache, rep, axis=1)
        scores = torch.einsum("bhqd,bhkd->bhqk", q, k) * (Dh ** -0.5)
        p = _softmax(scores, axis=-1)
        o = torch.einsum("bhqk,bhkd->bhqd", p, v)
        return (lambda x, *d: x.permute(*d))(o, 0, 2, 1, 3).reshape(B, Sq, Hq * Dh) @ wo

    a = _A_ref(A_x, A_k_cache, A_v_cache, A_wq, A_wo)
    b = _B_ref(B_x, B_k_cache, B_v_cache, B_wq, B_wo)
    return torch.concatenate([a, b], axis=-1)
```

```asm
; @launch grid=(256,1,1) block=(512,1,1) lds=163840
.amdgcn_target "amdgcn-amd-amdhsa--gfx950"
.text
.globl concat_heads__gqa_block_cached__gqa_block_cached__near_ridge_kernel
.p2align 8
.type concat_heads__gqa_block_cached__gqa_block_cached__near_ridge_kernel,@function
concat_heads__gqa_block_cached__gqa_block_cached__near_ridge_kernel:
  s_cmp_ge_u32 s2, 256
  s_cbranch_scc1 L_end
  s_lshr_b32 s4, s2, 7
  s_mul_i32 s42, s4, 40
  s_add_u32 s10, s0, s42
  s_addc_u32 s11, s1, 0
  s_load_dwordx2 s[12:13], s[10:11], 0
  s_load_dwordx2 s[20:21], s[10:11], 8
  s_load_dwordx2 s[24:25], s[10:11], 16
  s_load_dwordx2 s[16:17], s[10:11], 24
  s_load_dwordx2 s[28:29], s[10:11], 32
  s_load_dwordx2 s[92:93], s[0:1], 80
  s_load_dwordx2 s[36:37], s[0:1], 88
  s_load_dwordx2 s[32:33], s[0:1], 96
  s_and_b32 s89, s2, 7
  s_mov_b32 s3, s89
  s_lshr_b32 s9, s2, 3
  s_and_b32 s9, s9, 15
  s_lshr_b32 s5, s9, 1
  s_and_b32 s6, s9, 1
  v_lshrrev_b32 v240, 6, v0
  v_and_b32 v255, 63, v0
  v_readfirstlane_b32 s7, v240
  v_and_b32 v254, 15, v255
  v_lshrrev_b32 v253, 4, v255
  v_and_b32 v252, 31, v255
  v_lshrrev_b32 v251, 5, v255
  v_lshlrev_b32 v250, 4, v255
  s_and_b32 s8, s7, 3
  s_getreg_b32 s80, hwreg(HW_REG_XCC_ID)
  s_and_b32 s80, s80, 15
  s_add_u32 s80, s80, 1
  s_mov_b32 s40, 0x3e0293ee
  s_lshl_b32 s53, s2, 7
  s_add_u32 s53, s53, 25165824
  s_lshl_b32 s42, s5, 3
  s_add_u32 s42, s42, s3
  s_lshl_b32 s42, s42, 1
  s_add_u32 s42, s42, s6
  s_lshl_b32 s42, s42, 18
  s_waitcnt lgkmcnt(0)
  s_add_u32 s20, s20, s42
  s_addc_u32 s21, s21, 0
  s_mov_b32 s22, 0x40000
  s_mov_b32 s23, 0x00020000
  s_add_u32 s24, s24, s42
  s_addc_u32 s25, s25, 0
  s_mov_b32 s26, 0x40000
  s_mov_b32 s27, 0x00020000
  s_mov_b32 s14, 0x40000
  s_mov_b32 s15, 0x00020000
  s_mov_b32 s18, 0x400000
  s_mov_b32 s19, 0x00020000
  s_mov_b32 s30, 0x400000
  s_mov_b32 s31, 0x00020000
  s_mov_b32 s34, 0x10000000
  s_mov_b32 s35, 0x00020000
  s_mov_b32 s38, 0x100
  s_mov_b32 s39, 0x00020000
  s_mov_b32 s94, 0x80000
  s_mov_b32 s95, 0x00020000
  v_mov_b32 v240, 0
  v_lshlrev_b32 v241, 2, v252
  v_add_u32 v241, 147456, v241
  ds_write_b32 v241, v240
  s_waitcnt lgkmcnt(0)
  s_barrier
  s_cmp_ge_u32 s7, 4
  s_cbranch_scc1 L_helper
  v_lshrrev_b32 v240, 3, v255
  v_and_b32 v241, 7, v255
  v_and_b32 v242, 1, v253
  v_lshlrev_b32 v242, 2, v242
  v_xor_b32 v241, v241, v242
  v_lshlrev_b32 v241, 4, v241
  v_lshl_add_u32 v240, v240, 13, v241
  s_and_b32 s42, s9, 7
  s_lshl_b32 s42, s42, 7
  s_lshl_b32 s43, s3, 10
  s_add_u32 s42, s42, s43
  s_mov_b32 s85, 0
  s_add_u32 s43, s7, s85
  s_and_b32 s43, s43, 3
  s_lshl_b32 s43, s43, 20
  s_add_u32 s42, s42, s43
  s_lshl_b32 s43, s7, 14
  s_add_u32 s43, s43, 65536
  s_add_u32 m0, s43, 0
  s_add_u32 s44, s42, 0
  buffer_load_dwordx4 v240, s[16:19], s44 offen nt lds
  s_add_u32 m0, s43, 1024
  s_add_u32 s44, s42, 65536
  buffer_load_dwordx4 v240, s[16:19], s44 offen nt lds
  s_add_u32 m0, s43, 2048
  s_add_u32 s44, s42, 131072
  buffer_load_dwordx4 v240, s[16:19], s44 offen nt lds
  s_add_u32 m0, s43, 3072
  s_add_u32 s44, s42, 196608
  buffer_load_dwordx4 v240, s[16:19], s44 offen nt lds
  s_add_u32 m0, s43, 4096
  s_add_u32 s44, s42, 262144
  buffer_load_dwordx4 v240, s[16:19], s44 offen nt lds
  s_add_u32 m0, s43, 5120
  s_add_u32 s44, s42, 327680
  buffer_load_dwordx4 v240, s[16:19], s44 offen nt lds
  s_add_u32 m0, s43, 6144
  s_add_u32 s44, s42, 393216
  buffer_load_dwordx4 v240, s[16:19], s44 offen nt lds
  s_add_u32 m0, s43, 7168
  s_add_u32 s44, s42, 458752
  buffer_load_dwordx4 v240, s[16:19], s44 offen nt lds
  s_add_u32 m0, s43, 8192
  s_add_u32 s44, s42, 524288
  buffer_load_dwordx4 v240, s[16:19], s44 offen nt lds
  s_add_u32 m0, s43, 9216
  s_add_u32 s44, s42, 589824
  buffer_load_dwordx4 v240, s[16:19], s44 offen nt lds
  s_add_u32 m0, s43, 10240
  s_add_u32 s44, s42, 655360
  buffer_load_dwordx4 v240, s[16:19], s44 offen nt lds
  s_add_u32 m0, s43, 11264
  s_add_u32 s44, s42, 720896
  buffer_load_dwordx4 v240, s[16:19], s44 offen nt lds
  s_add_u32 m0, s43, 12288
  s_add_u32 s44, s42, 786432
  buffer_load_dwordx4 v240, s[16:19], s44 offen nt lds
  s_add_u32 m0, s43, 13312
  s_add_u32 s44, s42, 851968
  buffer_load_dwordx4 v240, s[16:19], s44 offen nt lds
  s_add_u32 m0, s43, 14336
  s_add_u32 s44, s42, 917504
  buffer_load_dwordx4 v240, s[16:19], s44 offen nt lds
  s_add_u32 m0, s43, 15360
  s_add_u32 s44, s42, 983040
  buffer_load_dwordx4 v240, s[16:19], s44 offen nt lds
  s_lshr_b32 s42, s9, 3
  s_lshl_b32 s42, s42, 2
  s_add_u32 s42, s42, s7
  s_lshl_b32 s54, s42, 15
  s_lshl_b32 s55, s7, 14
  s_add_u32 s55, s55, 0
  v_xor_b32 v241, v254, v253
  v_lshlrev_b32 v241, 4, v241
  v_lshl_add_u32 v241, v253, 10, v241
  v_xor_b32 v224, 0, v241
  v_xor_b32 v225, 64, v241
  v_xor_b32 v226, 128, v241
  v_xor_b32 v227, 192, v241
  s_add_u32 s84, s85, 0
  s_and_b32 s84, s84, 3
  s_lshl_b32 s84, s84, 8
  s_add_u32 s84, s84, s54
  s_add_u32 m0, s55, 0
  s_add_u32 s44, s84, 0
  buffer_load_dwordx4 v224, s[12:15], s44 offen lds
  s_add_u32 m0, s55, 1024
  s_add_u32 s44, s84, 4096
  buffer_load_dwordx4 v225, s[12:15], s44 offen lds
  s_add_u32 m0, s55, 2048
  s_add_u32 s44, s84, 8192
  buffer_load_dwordx4 v226, s[12:15], s44 offen lds
  s_add_u32 m0, s55, 3072
  s_add_u32 s44, s84, 12288
  buffer_load_dwordx4 v227, s[12:15], s44 offen lds
  s_add_u32 m0, s55, 4096
  s_add_u32 s44, s84, 16384
  buffer_load_dwordx4 v224, s[12:15], s44 offen lds
  s_add_u32 m0, s55, 5120
  s_add_u32 s44, s84, 20480
  buffer_load_dwordx4 v225, s[12:15], s44 offen lds
  s_add_u32 m0, s55, 6144
  s_add_u32 s44, s84, 24576
  buffer_load_dwordx4 v226, s[12:15], s44 offen lds
  s_add_u32 m0, s55, 7168
  s_add_u32 s44, s84, 28672
  buffer_load_dwordx4 v227, s[12:15], s44 offen lds
  s_add_u32 s84, s85, 1
  s_and_b32 s84, s84, 3
  s_lshl_b32 s84, s84, 8
  s_add_u32 s84, s84, s54
  s_add_u32 m0, s55, 8192
  s_add_u32 s44, s84, 0
  buffer_load_dwordx4 v224, s[12:15], s44 offen lds
  s_add_u32 m0, s55, 9216
  s_add_u32 s44, s84, 4096
  buffer_load_dwordx4 v225, s[12:15], s44 offen lds
  s_add_u32 m0, s55, 10240
  s_add_u32 s44, s84, 8192
  buffer_load_dwordx4 v226, s[12:15], s44 offen lds
  s_add_u32 m0, s55, 11264
  s_add_u32 s44, s84, 12288
  buffer_load_dwordx4 v227, s[12:15], s44 offen lds
  s_add_u32 m0, s55, 12288
  s_add_u32 s44, s84, 16384
  buffer_load_dwordx4 v224, s[12:15], s44 offen lds
  s_add_u32 m0, s55, 13312
  s_add_u32 s44, s84, 20480
  buffer_load_dwordx4 v225, s[12:15], s44 offen lds
  s_add_u32 m0, s55, 14336
  s_add_u32 s44, s84, 24576
  buffer_load_dwordx4 v226, s[12:15], s44 offen lds
  s_add_u32 m0, s55, 15360
  s_add_u32 s44, s84, 28672
  buffer_load_dwordx4 v227, s[12:15], s44 offen lds
  s_lshl_b32 s43, s4, 3
  s_add_u32 s43, s43, s89
  s_lshl_b32 s43, s43, 18
  s_add_u32 s43, s43, 0
  s_lshl_b32 s46, s42, 15
  s_add_u32 s46, s46, s43
  s_and_b32 s44, s9, 6
  s_lshl_b32 s44, s44, 12
  s_add_u32 s46, s46, s44
  s_and_b32 s44, s9, 1
  s_lshl_b32 s44, s44, 11
  s_add_u32 s46, s46, s44
  s_lshl_b32 s48, s5, 15
  s_add_u32 s48, s48, s43
  s_lshl_b32 s44, s7, 13
  s_add_u32 s48, s48, s44
  v_xor_b32 v240, v251, v254
  v_lshlrev_b32 v240, 4, v240
  v_lshl_add_u32 v240, v252, 8, v240
  v_add_u32 v240, s55, v240
  v_xor_b32 v228, 0, v240
  v_xor_b32 v229, 32, v240
  v_xor_b32 v230, 64, v240
  v_xor_b32 v231, 96, v240
  v_xor_b32 v232, 128, v240
  v_xor_b32 v233, 160, v240
  v_xor_b32 v234, 192, v240
  v_xor_b32 v235, 224, v240
  v_xor_b32 v240, v253, v254
  v_lshlrev_b32 v240, 4, v240
  v_lshl_add_u32 v240, v254, 8, v240
  v_xor_b32 v200, 0, v240
  v_xor_b32 v201, 64, v240
  v_xor_b32 v202, 128, v240
  v_xor_b32 v203, 192, v240
  v_lshrrev_b32 v240, 2, v254
  v_and_b32 v241, 3, v254
  v_and_b32 v242, 1, v253
  v_lshl_add_u32 v243, v253, 2, v240
  v_lshlrev_b32 v243, 8, v243
  v_lshl_add_u32 v244, v242, 2, v240
  v_lshl_add_u32 v243, v244, 5, v243
  v_lshl_add_u32 v243, v241, 3, v243
  v_xor_b32 v204, 0, v243
  v_xor_b32 v205, 32, v243
  v_xor_b32 v206, 64, v243
  v_xor_b32 v207, 96, v243
  v_xor_b32 v208, 128, v243
  v_xor_b32 v209, 160, v243
  v_xor_b32 v210, 192, v243
  v_xor_b32 v211, 224, v243
  v_lshl_add_u32 v243, v251, 3, v240
  v_lshlrev_b32 v243, 7, v243
  v_lshl_add_u32 v243, v242, 5, v243
  v_and_b32 v244, 1, v241
  v_lshl_add_u32 v243, v244, 4, v243
  v_lshrrev_b32 v244, 1, v241
  v_lshl_add_u32 v243, v244, 3, v243
  v_add_u32 v243, 65536, v243
  v_lshrrev_b32 v244, 1, v240
  v_lshl_add_u32 v220, v244, 6, v243
  v_xor_b32 v221, 64, v220
  s_waitcnt vmcnt(8)
  ds_read_b128 v[0:3], v228 offset:0
  ds_read_b128 v[4:7], v229 offset:0
  ds_read_b128 v[8:11], v230 offset:0
  ds_read_b128 v[12:15], v231 offset:0
  ds_read_b128 v[16:19], v232 offset:0
  ds_read_b128 v[20:23], v233 offset:0
  ds_read_b128 v[24:27], v234 offset:0
  ds_read_b128 v[28:31], v235 offset:0
  v_mov_b32 v240, 1
  s_lshl_b32 s42, s7, 2
  s_add_u32 s42, s42, 147504
  v_mov_b32 v241, s42
  s_mov_b64 exec, 1
  ds_write_b32 v241, v240
  s_mov_b64 exec, -1
  s_waitcnt lgkmcnt(0)
  s_add_u32 s84, s85, 2
  s_and_b32 s84, s84, 3
  s_lshl_b32 s84, s84, 8
  s_add_u32 s84, s84, s54
  s_add_u32 m0, s55, 0
  s_add_u32 s44, s84, 0
  buffer_load_dwordx4 v224, s[12:15], s44 offen lds
  s_add_u32 m0, s55, 1024
  s_add_u32 s44, s84, 4096
  buffer_load_dwordx4 v225, s[12:15], s44 offen lds
  s_add_u32 m0, s55, 2048
  s_add_u32 s44, s84, 8192
  buffer_load_dwordx4 v226, s[12:15], s44 offen lds
  s_add_u32 m0, s55, 3072
  s_add_u32 s44, s84, 12288
  buffer_load_dwordx4 v227, s[12:15], s44 offen lds
  s_add_u32 m0, s55, 4096
  s_add_u32 s44, s84, 16384
  buffer_load_dwordx4 v224, s[12:15], s44 offen lds
  s_add_u32 m0, s55, 5120
  s_add_u32 s44, s84, 20480
  buffer_load_dwordx4 v225, s[12:15], s44 offen lds
  s_add_u32 m0, s55, 6144
  s_add_u32 s44, s84, 24576
  buffer_load_dwordx4 v226, s[12:15], s44 offen lds
  s_add_u32 m0, s55, 7168
  s_add_u32 s44, s84, 28672
  buffer_load_dwordx4 v227, s[12:15], s44 offen lds
  s_waitcnt vmcnt(8)
  ds_read_b128 v[32:35], v228 offset:8192
  ds_read_b128 v[36:39], v229 offset:8192
  ds_read_b128 v[40:43], v230 offset:8192
  ds_read_b128 v[44:47], v231 offset:8192
  ds_read_b128 v[48:51], v232 offset:8192
  ds_read_b128 v[52:55], v233 offset:8192
  ds_read_b128 v[56:59], v234 offset:8192
  ds_read_b128 v[60:63], v235 offset:8192
  s_waitcnt lgkmcnt(0)
  s_add_u32 s84, s85, 3
  s_and_b32 s84, s84, 3
  s_lshl_b32 s84, s84, 8
  s_add_u32 s84, s84, s54
  s_add_u32 m0, s55, 8192
  s_add_u32 s44, s84, 0
  buffer_load_dwordx4 v224, s[12:15], s44 offen lds
  s_add_u32 m0, s55, 9216
  s_add_u32 s44, s84, 4096
  buffer_load_dwordx4 v225, s[12:15], s44 offen lds
  s_add_u32 m0, s55, 10240
  s_add_u32 s44, s84, 8192
  buffer_load_dwordx4 v226, s[12:15], s44 offen lds
  s_add_u32 m0, s55, 11264
  s_add_u32 s44, s84, 12288
  buffer_load_dwordx4 v227, s[12:15], s44 offen lds
  s_add_u32 m0, s55, 12288
  s_add_u32 s44, s84, 16384
  buffer_load_dwordx4 v224, s[12:15], s44 offen lds
  s_add_u32 m0, s55, 13312
  s_add_u32 s44, s84, 20480
  buffer_load_dwordx4 v225, s[12:15], s44 offen lds
  s_add_u32 m0, s55, 14336
  s_add_u32 s44, s84, 24576
  buffer_load_dwordx4 v226, s[12:15], s44 offen lds
  s_add_u32 m0, s55, 15360
  s_add_u32 s44, s84, 28672
  buffer_load_dwordx4 v227, s[12:15], s44 offen lds
  v_mov_b32 v236, 147504
  s_lshl_b32 s42, s7, 2
  s_add_u32 s42, s42, 147504
  v_mov_b32 v237, s42
  s_mov_b32 s91, 1
  s_call_b64 s[50:51], L_sspin
  ds_read_b64_tr_b16 v[160:161], v220 offset:0
  ds_read_b64_tr_b16 v[162:163], v220 offset:512
  ds_read_b64_tr_b16 v[164:165], v221 offset:0
  ds_read_b64_tr_b16 v[166:167], v221 offset:512
  ds_read_b64_tr_b16 v[168:169], v220 offset:2048
  ds_read_b64_tr_b16 v[170:171], v220 offset:2560
  ds_read_b64_tr_b16 v[172:173], v221 offset:2048
  ds_read_b64_tr_b16 v[174:175], v221 offset:2560
  ds_read_b64_tr_b16 v[176:177], v220 offset:4096
  ds_read_b64_tr_b16 v[178:179], v220 offset:4608
  ds_read_b64_tr_b16 v[180:181], v221 offset:4096
  ds_read_b64_tr_b16 v[182:183], v221 offset:4608
  ds_read_b64_tr_b16 v[184:185], v220 offset:6144
  ds_read_b64_tr_b16 v[186:187], v220 offset:6656
  ds_read_b64_tr_b16 v[188:189], v221 offset:6144
  ds_read_b64_tr_b16 v[190:191], v221 offset:6656
  s_waitcnt lgkmcnt(12)
  v_mfma_f32_32x32x16_bf16 v[128:143], v[160:163], v[0:3], 0
  v_mfma_f32_32x32x16_bf16 v[144:159], v[164:167], v[0:3], 0
  ds_read_b64_tr_b16 v[192:193], v220 offset:8192
  ds_read_b64_tr_b16 v[194:195], v220 offset:8704
  ds_read_b64_tr_b16 v[196:197], v221 offset:8192
  ds_read_b64_tr_b16 v[198:199], v221 offset:8704
  s_waitcnt lgkmcnt(12)
  v_mfma_f32_32x32x16_bf16 v[128:143], v[168:171], v[4:7], v[128:143]
  v_mfma_f32_32x32x16_bf16 v[144:159], v[172:175], v[4:7], v[144:159]
  ds_read_b64_tr_b16 v[160:161], v220 offset:10240
  ds_read_b64_tr_b16 v[162:163], v220 offset:10752
  ds_read_b64_tr_b16 v[164:165], v221 offset:10240
  ds_read_b64_tr_b16 v[166:167], v221 offset:10752
  s_waitcnt lgkmcnt(12)
  v_mfma_f32_32x32x16_bf16 v[128:143], v[176:179], v[8:11], v[128:143]
  v_mfma_f32_32x32x16_bf16 v[144:159], v[180:183], v[8:11], v[144:159]
  ds_read_b64_tr_b16 v[168:169], v220 offset:12288
  ds_read_b64_tr_b16 v[170:171], v220 offset:12800
  ds_read_b64_tr_b16 v[172:173], v221 offset:12288
  ds_read_b64_tr_b16 v[174:175], v221 offset:12800
  s_waitcnt lgkmcnt(12)
  v_mfma_f32_32x32x16_bf16 v[128:143], v[184:187], v[12:15], v[128:143]
  v_mfma_f32_32x32x16_bf16 v[144:159], v[188:191], v[12:15], v[144:159]
  ds_read_b64_tr_b16 v[176:177], v220 offset:14336
  ds_read_b64_tr_b16 v[178:179], v220 offset:14848
  ds_read_b64_tr_b16 v[180:181], v221 offset:14336
  ds_read_b64_tr_b16 v[182:183], v221 offset:14848
  s_waitcnt lgkmcnt(12)
  v_mfma_f32_32x32x16_bf16 v[128:143], v[192:195], v[16:19], v[128:143]
  v_mfma_f32_32x32x16_bf16 v[144:159], v[196:199], v[16:19], v[144:159]
  ds_read_b64_tr_b16 v[184:185], v220 offset:16384
  ds_read_b64_tr_b16 v[186:187], v220 offset:16896
  ds_read_b64_tr_b16 v[188:189], v221 offset:16384
  ds_read_b64_tr_b16 v[190:191], v221 offset:16896
  s_waitcnt lgkmcnt(12)
  v_mfma_f32_32x32x16_bf16 v[128:143], v[160:163], v[20:23], v[128:143]
  v_mfma_f32_32x32x16_bf16 v[144:159], v[164:167], v[20:23], v[144:159]
  ds_read_b64_tr_b16 v[192:193], v220 offset:18432
  ds_read_b64_tr_b16 v[194:195], v220 offset:18944
  ds_read_b64_tr_b16 v[196:197], v221 offset:18432
  ds_read_b64_tr_b16 v[198:199], v221 offset:18944
  s_waitcnt lgkmcnt(12)
  v_mfma_f32_32x32x16_bf16 v[128:143], v[168:171], v[24:27], v[128:143]
  v_mfma_f32_32x32x16_bf16 v[144:159], v[172:175], v[24:27], v[144:159]
  ds_read_b64_tr_b16 v[160:161], v220 offset:20480
  ds_read_b64_tr_b16 v[162:163], v220 offset:20992
  ds_read_b64_tr_b16 v[164:165], v221 offset:20480
  ds_read_b64_tr_b16 v[166:167], v221 offset:20992
  s_waitcnt lgkmcnt(12)
  v_mfma_f32_32x32x16_bf16 v[128:143], v[176:179], v[28:31], v[128:143]
  v_mfma_f32_32x32x16_bf16 v[144:159], v[180:183], v[28:31], v[144:159]
  ds_read_b64_tr_b16 v[168:169], v220 offset:22528
  ds_read_b64_tr_b16 v[170:171], v220 offset:23040
  ds_read_b64_tr_b16 v[172:173], v221 offset:22528
  ds_read_b64_tr_b16 v[174:175], v221 offset:23040
  s_waitcnt lgkmcnt(12)
  v_mfma_f32_32x32x16_bf16 v[128:143], v[184:187], v[32:35], v[128:143]
  v_mfma_f32_32x32x16_bf16 v[144:159], v[188:191], v[32:35], v[144:159]
  ds_read_b64_tr_b16 v[176:177], v220 offset:24576
  ds_read_b64_tr_b16 v[178:179], v220 offset:25088
  ds_read_b64_tr_b16 v[180:181], v221 offset:24576
  ds_read_b64_tr_b16 v[182:183], v221 offset:25088
  s_waitcnt lgkmcnt(12)
  v_mfma_f32_32x32x16_bf16 v[128:143], v[192:195], v[36:39], v[128:143]
  v_mfma_f32_32x32x16_bf16 v[144:159], v[196:199], v[36:39], v[144:159]
  ds_read_b64_tr_b16 v[184:185], v220 offset:26624
  ds_read_b64_tr_b16 v[186:187], v220 offset:27136
  ds_read_b64_tr_b16 v[188:189], v221 offset:26624
  ds_read_b64_tr_b16 v[190:191], v221 offset:27136
  s_waitcnt lgkmcnt(12)
  v_mfma_f32_32x32x16_bf16 v[128:143], v[160:163], v[40:43], v[128:143]
  v_mfma_f32_32x32x16_bf16 v[144:159], v[164:167], v[40:43], v[144:159]
  ds_read_b64_tr_b16 v[192:193], v220 offset:28672
  ds_read_b64_tr_b16 v[194:195], v220 offset:29184
  ds_read_b64_tr_b16 v[196:197], v221 offset:28672
  ds_read_b64_tr_b16 v[198:199], v221 offset:29184
  s_waitcnt lgkmcnt(12)
  v_mfma_f32_32x32x16_bf16 v[128:143], v[168:171], v[44:47], v[128:143]
  v_mfma_f32_32x32x16_bf16 v[144:159], v[172:175], v[44:47], v[144:159]
  s_waitcnt vmcnt(8)
  ds_read_b128 v[64:67], v228 offset:0
  ds_read_b128 v[68:71], v229 offset:0
  ds_read_b128 v[72:75], v230 offset:0
  ds_read_b128 v[76:79], v231 offset:0
  ds_read_b128 v[80:83], v232 offset:0
  ds_read_b128 v[84:87], v233 offset:0
  ds_read_b128 v[88:91], v234 offset:0
  ds_read_b128 v[92:95], v235 offset:0
  ds_read_b64_tr_b16 v[160:161], v220 offset:30720
  ds_read_b64_tr_b16 v[162:163], v220 offset:31232
  ds_read_b64_tr_b16 v[164:165], v221 offset:30720
  ds_read_b64_tr_b16 v[166:167], v221 offset:31232
  s_waitcnt lgkmcnt(15)
  v_mfma_f32_32x32x16_bf16 v[128:143], v[176:179], v[48:51], v[128:143]
  v_mfma_f32_32x32x16_bf16 v[144:159], v[180:183], v[48:51], v[144:159]
  ds_read_b64_tr_b16 v[168:169], v220 offset:32768
  ds_read_b64_tr_b16 v[170:171], v220 offset:33280
  ds_read_b64_tr_b16 v[172:173], v221 offset:32768
  ds_read_b64_tr_b16 v[174:175], v221 offset:33280
  v_mfma_f32_32x32x16_bf16 v[128:143], v[184:187], v[52:55], v[128:143]
  v_mfma_f32_32x32x16_bf16 v[144:159], v[188:191], v[52:55], v[144:159]
  ds_read_b64_tr_b16 v[176:177], v220 offset:34816
  ds_read_b64_tr_b16 v[178:179], v220 offset:35328
  ds_read_b64_tr_b16 v[180:181], v221 offset:34816
  ds_read_b64_tr_b16 v[182:183], v221 offset:35328
  s_waitcnt lgkmcnt(15)
  v_mfma_f32_32x32x16_bf16 v[128:143], v[192:195], v[56:59], v[128:143]
  v_mfma_f32_32x32x16_bf16 v[144:159], v[196:199], v[56:59], v[144:159]
  ds_read_b64_tr_b16 v[184:185], v220 offset:36864
  ds_read_b64_tr_b16 v[186:187], v220 offset:37376
  ds_read_b64_tr_b16 v[188:189], v221 offset:36864
  ds_read_b64_tr_b16 v[190:191], v221 offset:37376
  s_waitcnt lgkmcnt(12)
  v_mfma_f32_32x32x16_bf16 v[128:143], v[160:163], v[60:63], v[128:143]
  v_mfma_f32_32x32x16_bf16 v[144:159], v[164:167], v[60:63], v[144:159]
  ds_read_b64_tr_b16 v[192:193], v220 offset:38912
  ds_read_b64_tr_b16 v[194:195], v220 offset:39424
  ds_read_b64_tr_b16 v[196:197], v221 offset:38912
  ds_read_b64_tr_b16 v[198:199], v221 offset:39424
  s_waitcnt lgkmcnt(12)
  v_mfma_f32_32x32x16_bf16 v[128:143], v[168:171], v[64:67], v[128:143]
  v_mfma_f32_32x32x16_bf16 v[144:159], v[172:175], v[64:67], v[144:159]
  ds_read_b64_tr_b16 v[160:161], v220 offset:40960
  ds_read_b64_tr_b16 v[162:163], v220 offset:41472
  ds_read_b64_tr_b16 v[164:165], v221 offset:40960
  ds_read_b64_tr_b16 v[166:167], v221 offset:41472
  s_waitcnt lgkmcnt(12)
  v_mfma_f32_32x32x16_bf16 v[128:143], v[176:179], v[68:71], v[128:143]
  v_mfma_f32_32x32x16_bf16 v[144:159], v[180:183], v[68:71], v[144:159]
  ds_read_b64_tr_b16 v[168:169], v220 offset:43008
  ds_read_b64_tr_b16 v[170:171], v220 offset:43520
  ds_read_b64_tr_b16 v[172:173], v221 offset:43008
  ds_read_b64_tr_b16 v[174:175], v221 offset:43520
  s_waitcnt lgkmcnt(12)
  v_mfma_f32_32x32x16_bf16 v[128:143], v[184:187], v[72:75], v[128:143]
  v_mfma_f32_32x32x16_bf16 v[144:159], v[188:191], v[72:75], v[144:159]
  ds_read_b64_tr_b16 v[176:177], v220 offset:45056
  ds_read_b64_tr_b16 v[178:179], v220 offset:45568
  ds_read_b64_tr_b16 v[180:181], v221 offset:45056
  ds_read_b64_tr_b16 v[182:183], v221 offset:45568
  s_waitcnt lgkmcnt(12)
  v_mfma_f32_32x32x16_bf16 v[128:143], v[192:195], v[76:79], v[128:143]
  v_mfma_f32_32x32x16_bf16 v[144:159], v[196:199], v[76:79], v[144:159]
  s_waitcnt vmcnt(0)
  ds_read_b128 v[96:99], v228 offset:8192
  ds_read_b128 v[100:103], v229 offset:8192
  ds_read_b128 v[104:107], v230 offset:8192
  ds_read_b128 v[108:111], v231 offset:8192
  ds_read_b128 v[112:115], v232 offset:8192
  ds_read_b128 v[116:119], v233 offset:8192
  ds_read_b128 v[120:123], v234 offset:8192
  ds_read_b128 v[124:127], v235 offset:8192
  ds_read_b64_tr_b16 v[184:185], v220 offset:47104
  ds_read_b64_tr_b16 v[186:187], v220 offset:47616
  ds_read_b64_tr_b16 v[188:189], v221 offset:47104
  ds_read_b64_tr_b16 v[190:191], v221 offset:47616
  s_waitcnt lgkmcnt(15)
  v_mfma_f32_32x32x16_bf16 v[128:143], v[160:163], v[80:83], v[128:143]
  v_mfma_f32_32x32x16_bf16 v[144:159], v[164:167], v[80:83], v[144:159]
  ds_read_b64_tr_b16 v[192:193], v220 offset:49152
  ds_read_b64_tr_b16 v[194:195], v220 offset:49664
  ds_read_b64_tr_b16 v[196:197], v221 offset:49152
  ds_read_b64_tr_b16 v[198:199], v221 offset:49664
  v_mfma_f32_32x32x16_bf16 v[128:143], v[168:171], v[84:87], v[128:143]
  v_mfma_f32_32x32x16_bf16 v[144:159], v[172:175], v[84:87], v[144:159]
  ds_read_b64_tr_b16 v[160:161], v220 offset:51200
  ds_read_b64_tr_b16 v[162:163], v220 offset:51712
  ds_read_b64_tr_b16 v[164:165], v221 offset:51200
  ds_read_b64_tr_b16 v[166:167], v221 offset:51712
  s_waitcnt lgkmcnt(15)
  v_mfma_f32_32x32x16_bf16 v[128:143], v[176:179], v[88:91], v[128:143]
  v_mfma_f32_32x32x16_bf16 v[144:159], v[180:183], v[88:91], v[144:159]
  ds_read_b64_tr_b16 v[168:169], v220 offset:53248
  ds_read_b64_tr_b16 v[170:171], v220 offset:53760
  ds_read_b64_tr_b16 v[172:173], v221 offset:53248
  ds_read_b64_tr_b16 v[174:175], v221 offset:53760
  s_waitcnt lgkmcnt(12)
  v_mfma_f32_32x32x16_bf16 v[128:143], v[184:187], v[92:95], v[128:143]
  v_mfma_f32_32x32x16_bf16 v[144:159], v[188:191], v[92:95], v[144:159]
  ds_read_b64_tr_b16 v[176:177], v220 offset:55296
  ds_read_b64_tr_b16 v[178:179], v220 offset:55808
  ds_read_b64_tr_b16 v[180:181], v221 offset:55296
  ds_read_b64_tr_b16 v[182:183], v221 offset:55808
  s_waitcnt lgkmcnt(12)
  v_mfma_f32_32x32x16_bf16 v[128:143], v[192:195], v[96:99], v[128:143]
  v_mfma_f32_32x32x16_bf16 v[144:159], v[196:199], v[96:99], v[144:159]
  ds_read_b64_tr_b16 v[184:185], v220 offset:57344
  ds_read_b64_tr_b16 v[186:187], v220 offset:57856
  ds_read_b64_tr_b16 v[188:189], v221 offset:57344
  ds_read_b64_tr_b16 v[190:191], v221 offset:57856
  s_waitcnt lgkmcnt(12)
  v_mfma_f32_32x32x16_bf16 v[128:143], v[160:163], v[100:103], v[128:143]
  v_mfma_f32_32x32x16_bf16 v[144:159], v[164:167], v[100:103], v[144:159]
  ds_read_b64_tr_b16 v[192:193], v220 offset:59392
  ds_read_b64_tr_b16 v[194:195], v220 offset:59904
  ds_read_b64_tr_b16 v[196:197], v221 offset:59392
  ds_read_b64_tr_b16 v[198:199], v221 offset:59904
  s_waitcnt lgkmcnt(12)
  v_mfma_f32_32x32x16_bf16 v[128:143], v[168:171], v[104:107], v[128:143]
  v_mfma_f32_32x32x16_bf16 v[144:159], v[172:175], v[104:107], v[144:159]
  ds_read_b64_tr_b16 v[160:161], v220 offset:61440
  ds_read_b64_tr_b16 v[162:163], v220 offset:61952
  ds_read_b64_tr_b16 v[164:165], v221 offset:61440
  ds_read_b64_tr_b16 v[166:167], v221 offset:61952
  s_waitcnt lgkmcnt(12)
  v_mfma_f32_32x32x16_bf16 v[128:143], v[176:179], v[108:111], v[128:143]
  v_mfma_f32_32x32x16_bf16 v[144:159], v[180:183], v[108:111], v[144:159]
  ds_read_b64_tr_b16 v[168:169], v220 offset:63488
  ds_read_b64_tr_b16 v[170:171], v220 offset:64000
  ds_read_b64_tr_b16 v[172:173], v221 offset:63488
  ds_read_b64_tr_b16 v[174:175], v221 offset:64000
  s_waitcnt lgkmcnt(12)
  v_mfma_f32_32x32x16_bf16 v[128:143], v[184:187], v[112:115], v[128:143]
  v_mfma_f32_32x32x16_bf16 v[144:159], v[188:191], v[112:115], v[144:159]
  s_waitcnt lgkmcnt(8)
  v_mfma_f32_32x32x16_bf16 v[128:143], v[192:195], v[116:119], v[128:143]
  v_mfma_f32_32x32x16_bf16 v[144:159], v[196:199], v[116:119], v[144:159]
  s_waitcnt lgkmcnt(4)
  v_mfma_f32_32x32x16_bf16 v[128:143], v[160:163], v[120:123], v[128:143]
  v_mfma_f32_32x32x16_bf16 v[144:159], v[164:167], v[120:123], v[144:159]
  s_waitcnt lgkmcnt(0)
  v_mfma_f32_32x32x16_bf16 v[128:143], v[168:171], v[124:127], v[128:143]
  v_mfma_f32_32x32x16_bf16 v[144:159], v[172:175], v[124:127], v[144:159]
  v_mov_b32 v240, 2
  s_mov_b64 exec, 1
  ds_write_b32 v237, v240
  s_mov_b64 exec, -1
  v_lshrrev_b32 v245, 4, v252
  v_lshlrev_b32 v245, 12, v245
  v_lshl_add_u32 v245, v251, 8, v245
  v_lshl_add_u32 v245, v254, 4, v245
  s_nop 2
  v_mul_f32 v128, s40, v128
  v_mul_f32 v129, s40, v129
  v_mul_f32 v130, s40, v130
  v_mul_f32 v131, s40, v131
  v_mul_f32 v132, s40, v132
  v_mul_f32 v133, s40, v133
  v_mul_f32 v134, s40, v134
  v_mul_f32 v135, s40, v135
  v_cvt_pk_bf16_f32 v160, v128, v129
  v_cvt_pk_bf16_f32 v161, v130, v131
  v_cvt_pk_bf16_f32 v162, v132, v133
  v_cvt_pk_bf16_f32 v163, v134, v135
  buffer_store_dwordx4 v[160:163], v245, s[32:35], s46 offen offset:0 sc1
  v_mul_f32 v136, s40, v136
  v_mul_f32 v137, s40, v137
  v_mul_f32 v138, s40, v138
  v_mul_f32 v139, s40, v139
  v_mul_f32 v140, s40, v140
  v_mul_f32 v141, s40, v141
  v_mul_f32 v142, s40, v142
  v_mul_f32 v143, s40, v143
  v_cvt_pk_bf16_f32 v164, v136, v137
  v_cvt_pk_bf16_f32 v165, v138, v139
  v_cvt_pk_bf16_f32 v166, v140, v141
  v_cvt_pk_bf16_f32 v167, v142, v143
  buffer_store_dwordx4 v[164:167], v245, s[32:35], s46 offen offset:512 sc1
  v_mul_f32 v144, s40, v144
  v_mul_f32 v145, s40, v145
  v_mul_f32 v146, s40, v146
  v_mul_f32 v147, s40, v147
  v_mul_f32 v148, s40, v148
  v_mul_f32 v149, s40, v149
  v_mul_f32 v150, s40, v150
  v_mul_f32 v151, s40, v151
  v_cvt_pk_bf16_f32 v168, v144, v145
  v_cvt_pk_bf16_f32 v169, v146, v147
  v_cvt_pk_bf16_f32 v170, v148, v149
  v_cvt_pk_bf16_f32 v171, v150, v151
  buffer_store_dwordx4 v[168:171], v245, s[32:35], s46 offen offset:1024 sc1
  v_mul_f32 v152, s40, v152
  v_mul_f32 v153, s40, v153
  v_mul_f32 v154, s40, v154
  v_mul_f32 v155, s40, v155
  v_mul_f32 v156, s40, v156
  v_mul_f32 v157, s40, v157
  v_mul_f32 v158, s40, v158
  v_mul_f32 v159, s40, v159
  v_cvt_pk_bf16_f32 v172, v152, v153
  v_cvt_pk_bf16_f32 v173, v154, v155
  v_cvt_pk_bf16_f32 v174, v156, v157
  v_cvt_pk_bf16_f32 v175, v158, v159
  buffer_store_dwordx4 v[172:175], v245, s[32:35], s46 offen offset:1536 sc1
  v_mov_b32 v220, 147456
  s_lshl_b32 s42, s7, 2
  s_add_u32 s42, s42, 147472
  v_mov_b32 v221, s42
  s_lshr_b32 s42, s5, 2
  s_lshl_b32 s42, s42, 3
  s_lshl_b32 s43, s7, 1
  s_add_u32 s42, s42, s43
  s_lshl_b32 s42, s42, 3
  s_add_u32 s42, s42, s89
  s_lshl_b32 s43, s4, 7
  s_add_u32 s42, s42, s43
  s_lshl_b32 s42, s42, 7
  s_and_b32 s43, s5, 3
  s_lshl_b32 s43, s43, 2
  s_add_u32 s42, s42, s43
  s_add_u32 s49, s42, 25165824
  v_lshlrev_b32 v247, 10, v255
  v_add_u32 v224, 0x10000, v200
  v_add_u32 v225, 0x10000, v201
  v_add_u32 v226, 0x10000, v202
  v_add_u32 v227, 0x10000, v203
  v_add_u32 v228, 0x10000, v204
  v_add_u32 v229, 0x10000, v205
  v_add_u32 v230, 0x10000, v206
  v_add_u32 v231, 0x10000, v207
  v_add_u32 v232, 0x10000, v208
  v_add_u32 v233, 0x10000, v209
  v_add_u32 v234, 0x10000, v210
  v_add_u32 v235, 0x10000, v211
  s_mov_b32 s40, 0x41000000
  v_mov_b32 v236, 147520
  s_mov_b32 s91, 1
  s_call_b64 s[50:51], L_sspin
  s_waitcnt vmcnt(0) lgkmcnt(0)
  s_lshl_b32 s42, s8, 2
  s_add_u32 s42, s42, s53
  s_add_u32 s42, s42, 0x8000
  v_mov_b32 v240, 1
  v_mov_b32 v241, 0
  s_mov_b64 exec, 1
  buffer_store_dword v240, v241, s[32:35], s42 offen offset:0 sc1
  s_mov_b64 exec, -1
  s_add_u32 s78, s49, 0x8000
  s_mov_b32 s90, 0
  s_mov_b64 exec, 3
L_poll_qs:
  buffer_load_dword v249, v247, s[32:35], s78 offen sc1
  s_waitcnt vmcnt(0)
  v_cmp_ne_u32 vcc, 1, v249
  s_cbranch_vccz L_pok_qs
  s_sleep 2
  s_add_u32 s90, s90, 1
  s_cmp_lt_u32 s90, 0x20000
  s_cbranch_scc1 L_poll_qs
L_pok_qs:
  s_mov_b64 exec, -1
  s_add_u32 s76, s48, 0
  s_add_u32 s77, s48, 4096
  buffer_load_dwordx4 v[64:67], v250, s[32:35], s76 offen offset:0 sc1
  buffer_load_dwordx4 v[68:71], v250, s[32:35], s76 offen offset:1024 sc1
  buffer_load_dwordx4 v[72:75], v250, s[32:35], s76 offen offset:2048 sc1
  buffer_load_dwordx4 v[76:79], v250, s[32:35], s76 offen offset:3072 sc1
  buffer_load_dwordx4 v[80:83], v250, s[32:35], s77 offen offset:0 sc1
  buffer_load_dwordx4 v[84:87], v250, s[32:35], s77 offen offset:1024 sc1
  buffer_load_dwordx4 v[88:91], v250, s[32:35], s77 offen offset:2048 sc1
  buffer_load_dwordx4 v[92:95], v250, s[32:35], s77 offen offset:3072 sc1
  v_mov_b32 v240, 1
  s_mov_b64 exec, 1
  ds_write_b32 v221, v240 offset:16
  s_mov_b64 exec, -1
  v_mov_b32 v248, 0x3f803f80
  v_mov_b32 v249, 0x3f803f80
  v_mov_b32 v250, 0x3f803f80
  v_mov_b32 v251, 0x3f803f80
  s_mov_b32 s91, 1
  s_call_b64 s[50:51], L_cspin
  ds_read_b128 v[96:99], v200 offset:8192
  ds_read_b128 v[100:103], v200 offset:12288
  ds_read_b128 v[104:107], v201 offset:8192
  ds_read_b128 v[108:111], v201 offset:12288
  ds_read_b128 v[112:115], v202 offset:8192
  ds_read_b128 v[116:119], v202 offset:12288
  ds_read_b128 v[120:123], v203 offset:8192
  ds_read_b128 v[124:127], v203 offset:12288
  s_waitcnt vmcnt(0)
  s_waitcnt lgkmcnt(7)
  v_mfma_f32_16x16x32_bf16 v[160:163], v[96:99], v[64:67], 0
  v_mfma_f32_16x16x32_bf16 v[168:171], v[96:99], v[80:83], 0
  s_waitcnt lgkmcnt(6)
  v_mfma_f32_16x16x32_bf16 v[164:167], v[100:103], v[64:67], 0
  v_mfma_f32_16x16x32_bf16 v[172:175], v[100:103], v[80:83], 0
  ds_read_b128 v[96:99], v200 offset:24576
  s_waitcnt lgkmcnt(6)
  v_mfma_f32_16x16x32_bf16 v[160:163], v[104:107], v[68:71], v[160:163]
  v_mfma_f32_16x16x32_bf16 v[168:171], v[104:107], v[84:87], v[168:171]
  ds_read_b128 v[100:103], v200 offset:28672
  s_waitcnt lgkmcnt(6)
  v_mfma_f32_16x16x32_bf16 v[164:167], v[108:111], v[68:71], v[164:167]
  v_mfma_f32_16x16x32_bf16 v[172:175], v[108:111], v[84:87], v[172:175]
  ds_read_b128 v[104:107], v201 offset:24576
  s_waitcnt lgkmcnt(6)
  v_mfma_f32_16x16x32_bf16 v[160:163], v[112:115], v[72:75], v[160:163]
  v_mfma_f32_16x16x32_bf16 v[168:171], v[112:115], v[88:91], v[168:171]
  ds_read_b128 v[108:111], v201 offset:28672
  s_waitcnt lgkmcnt(6)
  v_mfma_f32_16x16x32_bf16 v[164:167], v[116:119], v[72:75], v[164:167]
  v_mfma_f32_16x16x32_bf16 v[172:175], v[116:119], v[88:91], v[172:175]
  ds_read_b128 v[112:115], v202 offset:24576
  s_waitcnt lgkmcnt(6)
  v_mfma_f32_16x16x32_bf16 v[160:163], v[120:123], v[76:79], v[160:163]
  v_mfma_f32_16x16x32_bf16 v[168:171], v[120:123], v[92:95], v[168:171]
  ds_read_b128 v[116:119], v202 offset:28672
  s_waitcnt lgkmcnt(6)
  v_mfma_f32_16x16x32_bf16 v[164:167], v[124:127], v[76:79], v[164:167]
  v_mfma_f32_16x16x32_bf16 v[172:175], v[124:127], v[92:95], v[172:175]
  ds_read_b128 v[120:123], v203 offset:24576
  ds_read_b128 v[236:239], v220
  ds_read_b128 v[124:127], v203 offset:28672
  s_waitcnt lgkmcnt(0)
  v_mov_b32 v254, 1
  v_min3_u32 v255, v236, v237, v238
  s_mov_b32 s91, 2
  s_mov_b64 exec, 1
  ds_write_b32 v221, v254
  s_mov_b64 exec, -1
  v_min_u32 v255, v255, v239
  v_cmp_gt_u32 vcc, s91, v255
  s_cbranch_vccz L_fok_0
  s_call_b64 s[50:51], L_cspin
L_fok_0:
  ds_read_b64_tr_b16 v[128:129], v204 offset:0
  ds_read_b64_tr_b16 v[130:131], v204 offset:4096
  ds_read_b64_tr_b16 v[132:133], v205 offset:0
  ds_read_b64_tr_b16 v[134:135], v205 offset:4096
  ds_read_b64_tr_b16 v[136:137], v206 offset:0
  ds_read_b64_tr_b16 v[138:139], v206 offset:4096
  ds_read_b64_tr_b16 v[140:141], v207 offset:0
  ds_read_b64_tr_b16 v[142:143], v207 offset:4096
  ds_read_b64_tr_b16 v[144:145], v208 offset:0
  ds_read_b64_tr_b16 v[146:147], v208 offset:4096
  ds_read_b64_tr_b16 v[148:149], v209 offset:0
  ds_read_b64_tr_b16 v[150:151], v209 offset:4096
  ds_read_b64_tr_b16 v[152:153], v210 offset:0
  ds_read_b64_tr_b16 v[154:155], v210 offset:4096
  v_max3_f32 v252, v160, v161, v162
  v_max3_f32 v252, v252, v163, v164
  v_max3_f32 v252, v252, v165, v166
  v_max_f32 v252, v252, v167
  v_mov_b32 v253, v252
  s_nop 1
  v_permlane16_swap_b32 v252, v253
  v_max_f32 v252, v252, v253
  v_mov_b32 v253, v252
  s_nop 1
  v_permlane32_swap_b32 v252, v253
  v_max_f32 v252, v252, v253
  v_sub_f32 v212, 0, v252
  v_sub_f32 v213, 0, v252
  v_sub_f32 v214, 0, v252
  v_sub_f32 v215, 0, v252
  v_sub_f32 v160, v160, v252
  v_sub_f32 v161, v161, v252
  v_sub_f32 v162, v162, v252
  v_sub_f32 v163, v163, v252
  v_sub_f32 v164, v164, v252
  v_sub_f32 v165, v165, v252
  v_sub_f32 v166, v166, v252
  v_sub_f32 v167, v167, v252
  v_max3_f32 v252, v168, v169, v170
  v_max3_f32 v252, v252, v171, v172
  v_max3_f32 v252, v252, v173, v174
  v_max_f32 v252, v252, v175
  v_mov_b32 v253, v252
  s_nop 1
  v_permlane16_swap_b32 v252, v253
  v_max_f32 v252, v252, v253
  v_mov_b32 v253, v252
  s_nop 1
  v_permlane32_swap_b32 v252, v253
  v_max_f32 v252, v252, v253
  v_sub_f32 v216, 0, v252
  v_sub_f32 v217, 0, v252
  v_sub_f32 v218, 0, v252
  v_sub_f32 v219, 0, v252
  v_sub_f32 v168, v168, v252
  v_sub_f32 v169, v169, v252
  v_sub_f32 v170, v170, v252
  v_sub_f32 v171, v171, v252
  v_sub_f32 v172, v172, v252
  v_sub_f32 v173, v173, v252
  v_sub_f32 v174, v174, v252
  v_sub_f32 v175, v175, v252
  v_mfma_f32_16x16x32_bf16 v[176:179], v[96:99], v[64:67], v[212:215]
  v_exp_f32 v160, v160
  v_exp_f32 v161, v161
  v_mfma_f32_16x16x32_bf16 v[184:187], v[96:99], v[80:83], v[216:219]
  ds_read_b64_tr_b16 v[156:157], v211 offset:0
  ds_read_b64_tr_b16 v[158:159], v211 offset:4096
  v_exp_f32 v162, v162
  v_mfma_f32_16x16x32_bf16 v[180:183], v[100:103], v[64:67], v[212:215]
  v_exp_f32 v163, v163
  v_cvt_pk_bf16_f32 v192, v160, v161
  v_mfma_f32_16x16x32_bf16 v[188:191], v[100:103], v[80:83], v[216:219]
  ds_read_b128 v[96:99], v200 offset:40960
  v_exp_f32 v164, v164
  v_mfma_f32_16x16x32_bf16 v[176:179], v[104:107], v[68:71], v[176:179]
  v_exp_f32 v165, v165
  v_cvt_pk_bf16_f32 v193, v162, v163
  v_mfma_f32_16x16x32_bf16 v[184:187], v[104:107], v[84:87], v[184:187]
  ds_read_b128 v[100:103], v200 offset:45056
  v_exp_f32 v166, v166
  v_mfma_f32_16x16x32_bf16 v[180:183], v[108:111], v[68:71], v[180:183]
  v_exp_f32 v167, v167
  v_cvt_pk_bf16_f32 v194, v164, v165
  v_mfma_f32_16x16x32_bf16 v[188:191], v[108:111], v[84:87], v[188:191]
  ds_read_b128 v[104:107], v201 offset:40960
  v_exp_f32 v168, v168
  v_mfma_f32_16x16x32_bf16 v[176:179], v[112:115], v[72:75], v[176:179]
  v_exp_f32 v169, v169
  v_cvt_pk_bf16_f32 v195, v166, v167
  v_mfma_f32_16x16x32_bf16 v[184:187], v[112:115], v[88:91], v[184:187]
  ds_read_b128 v[108:111], v201 offset:45056
  v_exp_f32 v170, v170
  v_mfma_f32_16x16x32_bf16 v[180:183], v[116:119], v[72:75], v[180:183]
  v_exp_f32 v171, v171
  v_cvt_pk_bf16_f32 v196, v168, v169
  v_mfma_f32_16x16x32_bf16 v[188:191], v[116:119], v[88:91], v[188:191]
  ds_read_b128 v[112:115], v202 offset:40960
  v_exp_f32 v172, v172
  v_mfma_f32_16x16x32_bf16 v[176:179], v[120:123], v[76:79], v[176:179]
  v_exp_f32 v173, v173
  v_cvt_pk_bf16_f32 v197, v170, v171
  v_mfma_f32_16x16x32_bf16 v[184:187], v[120:123], v[92:95], v[184:187]
  ds_read_b128 v[116:119], v202 offset:45056
  v_exp_f32 v174, v174
  v_mfma_f32_16x16x32_bf16 v[180:183], v[124:127], v[76:79], v[180:183]
  v_exp_f32 v175, v175
  v_cvt_pk_bf16_f32 v198, v172, v173
  v_mfma_f32_16x16x32_bf16 v[188:191], v[124:127], v[92:95], v[188:191]
  ds_read_b128 v[120:123], v203 offset:40960
  v_cvt_pk_bf16_f32 v199, v174, v175
  v_mfma_f32_16x16x32_bf16 v[240:243], v[248:251], v[192:195], 0
  s_nop 0
  v_mfma_f32_16x16x32_bf16 v[244:247], v[248:251], v[196:199], 0
  ds_read_b128 v[124:127], v203 offset:45056
  s_waitcnt lgkmcnt(15)
  v_mfma_f32_16x16x32_bf16 v[0:3], v[128:131], v[192:195], 0
  v_mfma_f32_16x16x32_bf16 v[32:35], v[128:131], v[196:199], 0
  v_mfma_f32_16x16x32_bf16 v[4:7], v[132:135], v[192:195], 0
  v_mfma_f32_16x16x32_bf16 v[36:39], v[132:135], v[196:199], 0
  ds_read_b64_tr_b16 v[128:129], v204 offset:16384
  ds_read_b64_tr_b16 v[130:131], v204 offset:20480
  v_mfma_f32_16x16x32_bf16 v[8:11], v[136:139], v[192:195], 0
  v_max3_f32 v252, v176, v177, v178
  v_mfma_f32_16x16x32_bf16 v[40:43], v[136:139], v[196:199], 0
  ds_read_b64_tr_b16 v[132:133], v205 offset:16384
  ds_read_b64_tr_b16 v[134:135], v205 offset:20480
  v_max3_f32 v253, v179, v180, v181
  v_mfma_f32_16x16x32_bf16 v[12:15], v[140:143], v[192:195], 0
  v_mfma_f32_16x16x32_bf16 v[44:47], v[140:143], v[196:199], 0
  ds_read_b64_tr_b16 v[136:137], v206 offset:16384
  ds_read_b64_tr_b16 v[138:139], v206 offset:20480
  v_max3_f32 v252, v252, v182, v183
  s_waitcnt lgkmcnt(15)
  v_mfma_f32_16x16x32_bf16 v[16:19], v[144:147], v[192:195], 0
  v_max3_f32 v253, v253, v184, v185
  v_mfma_f32_16x16x32_bf16 v[48:51], v[144:147], v[196:199], 0
  ds_read_b64_tr_b16 v[140:141], v207 offset:16384
  ds_read_b64_tr_b16 v[142:143], v207 offset:20480
  v_mfma_f32_16x16x32_bf16 v[20:23], v[148:151], v[192:195], 0
  v_max3_f32 v252, v252, v186, v187
  v_mfma_f32_16x16x32_bf16 v[52:55], v[148:151], v[196:199], 0
  ds_read_b64_tr_b16 v[144:145], v208 offset:16384
  ds_read_b64_tr_b16 v[146:147], v208 offset:20480
  v_max3_f32 v253, v253, v188, v189
  v_mfma_f32_16x16x32_bf16 v[24:27], v[152:155], v[192:195], 0
  v_mfma_f32_16x16x32_bf16 v[56:59], v[152:155], v[196:199], 0
  ds_read_b64_tr_b16 v[148:149], v209 offset:16384
  ds_read_b64_tr_b16 v[150:151], v209 offset:20480
  v_max3_f32 v252, v252, v190, v191
  s_waitcnt lgkmcnt(15)
  v_mfma_f32_16x16x32_bf16 v[28:31], v[156:159], v[192:195], 0
  v_max_f32 v252, v252, v253
  v_mfma_f32_16x16x32_bf16 v[60:63], v[156:159], v[196:199], 0
  ds_read_b64_tr_b16 v[152:153], v210 offset:16384
  ds_read_b64_tr_b16 v[154:155], v210 offset:20480
  v_cmp_lt_f32 vcc, s40, v252
  s_cbranch_vccz L_nr_1
  s_call_b64 s[50:51], L_rescale1
L_nr_1:
  v_mfma_f32_16x16x32_bf16 v[160:163], v[96:99], v[64:67], v[212:215]
  v_exp_f32 v176, v176
  v_exp_f32 v177, v177
  v_mfma_f32_16x16x32_bf16 v[168:171], v[96:99], v[80:83], v[216:219]
  ds_read_b64_tr_b16 v[156:157], v211 offset:16384
  ds_read_b64_tr_b16 v[158:159], v211 offset:20480
  v_exp_f32 v178, v178
  v_mfma_f32_16x16x32_bf16 v[164:167], v[100:103], v[64:67], v[212:215]
  v_exp_f32 v179, v179
  v_cvt_pk_bf16_f32 v192, v176, v177
  v_mfma_f32_16x16x32_bf16 v[172:175], v[100:103], v[80:83], v[216:219]
  ds_read_b128 v[96:99], v200 offset:57344
  v_exp_f32 v180, v180
  v_mfma_f32_16x16x32_bf16 v[160:163], v[104:107], v[68:71], v[160:163]
  v_exp_f32 v181, v181
  v_cvt_pk_bf16_f32 v193, v178, v179
  v_mfma_f32_16x16x32_bf16 v[168:171], v[104:107], v[84:87], v[168:171]
  ds_read_b128 v[100:103], v200 offset:61440
  v_exp_f32 v182, v182
  v_mfma_f32_16x16x32_bf16 v[164:167], v[108:111], v[68:71], v[164:167]
  v_exp_f32 v183, v183
  v_cvt_pk_bf16_f32 v194, v180, v181
  v_mfma_f32_16x16x32_bf16 v[172:175], v[108:111], v[84:87], v[172:175]
  ds_read_b128 v[104:107], v201 offset:57344
  v_exp_f32 v184, v184
  v_mfma_f32_16x16x32_bf16 v[160:163], v[112:115], v[72:75], v[160:163]
  v_exp_f32 v185, v185
  v_cvt_pk_bf16_f32 v195, v182, v183
  v_mfma_f32_16x16x32_bf16 v[168:171], v[112:115], v[88:91], v[168:171]
  ds_read_b128 v[108:111], v201 offset:61440
  v_exp_f32 v186, v186
  s_waitcnt lgkmcnt(15)
  v_mfma_f32_16x16x32_bf16 v[164:167], v[116:119], v[72:75], v[164:167]
  v_exp_f32 v187, v187
  v_cvt_pk_bf16_f32 v196, v184, v185
  v_mfma_f32_16x16x32_bf16 v[172:175], v[116:119], v[88:91], v[172:175]
  ds_read_b128 v[112:115], v202 offset:57344
  v_exp_f32 v188, v188
  v_mfma_f32_16x16x32_bf16 v[160:163], v[120:123], v[76:79], v[160:163]
  v_exp_f32 v189, v189
  v_cvt_pk_bf16_f32 v197, v186, v187
  v_mfma_f32_16x16x32_bf16 v[168:171], v[120:123], v[92:95], v[168:171]
  ds_read_b128 v[116:119], v202 offset:61440
  v_exp_f32 v190, v190
  v_mfma_f32_16x16x32_bf16 v[164:167], v[124:127], v[76:79], v[164:167]
  v_exp_f32 v191, v191
  v_cvt_pk_bf16_f32 v198, v188, v189
  v_mfma_f32_16x16x32_bf16 v[172:175], v[124:127], v[92:95], v[172:175]
  ds_read_b128 v[120:123], v203 offset:57344
  v_cvt_pk_bf16_f32 v199, v190, v191
  ds_read_b128 v[236:239], v220
  v_mfma_f32_16x16x32_bf16 v[240:243], v[248:251], v[192:195], v[240:243]
  v_mfma_f32_16x16x32_bf16 v[244:247], v[248:251], v[196:199], v[244:247]
  ds_read_b128 v[124:127], v203 offset:61440
  v_mfma_f32_16x16x32_bf16 v[0:3], v[128:131], v[192:195], v[0:3]
  v_mfma_f32_16x16x32_bf16 v[32:35], v[128:131], v[196:199], v[32:35]
  v_mfma_f32_16x16x32_bf16 v[4:7], v[132:135], v[192:195], v[4:7]
  s_waitcnt lgkmcnt(0)
  v_mov_b32 v254, 2
  v_min3_u32 v255, v236, v237, v238
  s_mov_b32 s91, 3
  s_mov_b64 exec, 1
  ds_write_b32 v221, v254
  s_mov_b64 exec, -1
  v_min_u32 v255, v255, v239
  v_cmp_gt_u32 vcc, s91, v255
  s_cbranch_vccz L_fok_2
  s_call_b64 s[50:51], L_cspin
L_fok_2:
  v_mfma_f32_16x16x32_bf16 v[36:39], v[132:135], v[196:199], v[36:39]
  ds_read_b64_tr_b16 v[128:129], v204 offset:32768
  ds_read_b64_tr_b16 v[130:131], v204 offset:36864
  v_mfma_f32_16x16x32_bf16 v[8:11], v[136:139], v[192:195], v[8:11]
  v_max3_f32 v252, v160, v161, v162
  v_mfma_f32_16x16x32_bf16 v[40:43], v[136:139], v[196:199], v[40:43]
  ds_read_b64_tr_b16 v[132:133], v205 offset:32768
  ds_read_b64_tr_b16 v[134:135], v205 offset:36864
  v_max3_f32 v253, v163, v164, v165
  v_mfma_f32_16x16x32_bf16 v[12:15], v[140:143], v[192:195], v[12:15]
  v_mfma_f32_16x16x32_bf16 v[44:47], v[140:143], v[196:199], v[44:47]
  ds_read_b64_tr_b16 v[136:137], v206 offset:32768
  ds_read_b64_tr_b16 v[138:139], v206 offset:36864
  v_max3_f32 v252, v252, v166, v167
  v_mfma_f32_16x16x32_bf16 v[16:19], v[144:147], v[192:195], v[16:19]
  v_max3_f32 v253, v253, v168, v169
  v_mfma_f32_16x16x32_bf16 v[48:51], v[144:147], v[196:199], v[48:51]
  ds_read_b64_tr_b16 v[140:141], v207 offset:32768
  ds_read_b64_tr_b16 v[142:143], v207 offset:36864
  v_mfma_f32_16x16x32_bf16 v[20:23], v[148:151], v[192:195], v[20:23]
  v_max3_f32 v252, v252, v170, v171
  v_mfma_f32_16x16x32_bf16 v[52:55], v[148:151], v[196:199], v[52:55]
  ds_read_b64_tr_b16 v[144:145], v208 offset:32768
  ds_read_b64_tr_b16 v[146:147], v208 offset:36864
  v_max3_f32 v253, v253, v172, v173
  v_mfma_f32_16x16x32_bf16 v[24:27], v[152:155], v[192:195], v[24:27]
  v_mfma_f32_16x16x32_bf16 v[56:59], v[152:155], v[196:199], v[56:59]
  ds_read_b64_tr_b16 v[148:149], v209 offset:32768
  ds_read_b64_tr_b16 v[150:151], v209 offset:36864
  v_max3_f32 v252, v252, v174, v175
  v_mfma_f32_16x16x32_bf16 v[28:31], v[156:159], v[192:195], v[28:31]
  v_max_f32 v252, v252, v253
  v_mfma_f32_16x16x32_bf16 v[60:63], v[156:159], v[196:199], v[60:63]
  ds_read_b64_tr_b16 v[152:153], v210 offset:32768
  ds_read_b64_tr_b16 v[154:155], v210 offset:36864
  v_cmp_lt_f32 vcc, s40, v252
  s_cbranch_vccz L_nr_2
  s_call_b64 s[50:51], L_rescale0
L_nr_2:
  v_mfma_f32_16x16x32_bf16 v[176:179], v[96:99], v[64:67], v[212:215]
  v_exp_f32 v160, v160
  v_exp_f32 v161, v161
  v_mfma_f32_16x16x32_bf16 v[184:187], v[96:99], v[80:83], v[216:219]
  ds_read_b64_tr_b16 v[156:157], v211 offset:32768
  ds_read_b64_tr_b16 v[158:159], v211 offset:36864
  v_exp_f32 v162, v162
  v_mfma_f32_16x16x32_bf16 v[180:183], v[100:103], v[64:67], v[212:215]
  v_exp_f32 v163, v163
  v_cvt_pk_bf16_f32 v192, v160, v161
  v_mfma_f32_16x16x32_bf16 v[188:191], v[100:103], v[80:83], v[216:219]
  ds_read_b128 v[96:99], v224 offset:8192
  v_exp_f32 v164, v164
  v_mfma_f32_16x16x32_bf16 v[176:179], v[104:107], v[68:71], v[176:179]
  v_exp_f32 v165, v165
  v_cvt_pk_bf16_f32 v193, v162, v163
  v_mfma_f32_16x16x32_bf16 v[184:187], v[104:107], v[84:87], v[184:187]
  ds_read_b128 v[100:103], v224 offset:12288
  v_exp_f32 v166, v166
  v_mfma_f32_16x16x32_bf16 v[180:183], v[108:111], v[68:71], v[180:183]
  v_exp_f32 v167, v167
  v_cvt_pk_bf16_f32 v194, v164, v165
  v_mfma_f32_16x16x32_bf16 v[188:191], v[108:111], v[84:87], v[188:191]
  ds_read_b128 v[104:107], v225 offset:8192
  v_exp_f32 v168, v168
  v_mfma_f32_16x16x32_bf16 v[176:179], v[112:115], v[72:75], v[176:179]
  v_exp_f32 v169, v169
  v_cvt_pk_bf16_f32 v195, v166, v167
  v_mfma_f32_16x16x32_bf16 v[184:187], v[112:115], v[88:91], v[184:187]
  ds_read_b128 v[108:111], v225 offset:12288
  v_exp_f32 v170, v170
  v_mfma_f32_16x16x32_bf16 v[180:183], v[116:119], v[72:75], v[180:183]
  v_exp_f32 v171, v171
  v_cvt_pk_bf16_f32 v196, v168, v169
  v_mfma_f32_16x16x32_bf16 v[188:191], v[116:119], v[88:91], v[188:191]
  ds_read_b128 v[112:115], v226 offset:8192
  v_exp_f32 v172, v172
  v_mfma_f32_16x16x32_bf16 v[176:179], v[120:123], v[76:79], v[176:179]
  v_exp_f32 v173, v173
  v_cvt_pk_bf16_f32 v197, v170, v171
  v_mfma_f32_16x16x32_bf16 v[184:187], v[120:123], v[92:95], v[184:187]
  ds_read_b128 v[116:119], v226 offset:12288
  v_exp_f32 v174, v174
  v_mfma_f32_16x16x32_bf16 v[180:183], v[124:127], v[76:79], v[180:183]
  v_exp_f32 v175, v175
  v_cvt_pk_bf16_f32 v198, v172, v173
  v_mfma_f32_16x16x32_bf16 v[188:191], v[124:127], v[92:95], v[188:191]
  ds_read_b128 v[120:123], v227 offset:8192
  v_cvt_pk_bf16_f32 v199, v174, v175
  v_mfma_f32_16x16x32_bf16 v[240:243], v[248:251], v[192:195], v[240:243]
  s_nop 0
  v_mfma_f32_16x16x32_bf16 v[244:247], v[248:251], v[196:199], v[244:247]
  ds_read_b128 v[124:127], v227 offset:12288
  s_waitcnt lgkmcnt(15)
  v_mfma_f32_16x16x32_bf16 v[0:3], v[128:131], v[192:195], v[0:3]
  v_mfma_f32_16x16x32_bf16 v[32:35], v[128:131], v[196:199], v[32:35]
  v_mfma_f32_16x16x32_bf16 v[4:7], v[132:135], v[192:195], v[4:7]
  v_mfma_f32_16x16x32_bf16 v[36:39], v[132:135], v[196:199], v[36:39]
  ds_read_b64_tr_b16 v[128:129], v204 offset:49152
  ds_read_b64_tr_b16 v[130:131], v204 offset:53248
  v_mfma_f32_16x16x32_bf16 v[8:11], v[136:139], v[192:195], v[8:11]
  v_max3_f32 v252, v176, v177, v178
  v_mfma_f32_16x16x32_bf16 v[40:43], v[136:139], v[196:199], v[40:43]
  ds_read_b64_tr_b16 v[132:133], v205 offset:49152
  ds_read_b64_tr_b16 v[134:135], v205 offset:53248
  v_max3_f32 v253, v179, v180, v181
  v_mfma_f32_16x16x32_bf16 v[12:15], v[140:143], v[192:195], v[12:15]
  v_mfma_f32_16x16x32_bf16 v[44:47], v[140:143], v[196:199], v[44:47]
  ds_read_b64_tr_b16 v[136:137], v206 offset:49152
  ds_read_b64_tr_b16 v[138:139], v206 offset:53248
  v_max3_f32 v252, v252, v182, v183
  s_waitcnt lgkmcnt(15)
  v_mfma_f32_16x16x32_bf16 v[16:19], v[144:147], v[192:195], v[16:19]
  v_max3_f32 v253, v253, v184, v185
  v_mfma_f32_16x16x32_bf16 v[48:51], v[144:147], v[196:199], v[48:51]
  ds_read_b64_tr_b16 v[140:141], v207 offset:49152
  ds_read_b64_tr_b16 v[142:143], v207 offset:53248
  v_mfma_f32_16x16x32_bf16 v[20:23], v[148:151], v[192:195], v[20:23]
  v_max3_f32 v252, v252, v186, v187
  v_mfma_f32_16x16x32_bf16 v[52:55], v[148:151], v[196:199], v[52:55]
  ds_read_b64_tr_b16 v[144:145], v208 offset:49152
  ds_read_b64_tr_b16 v[146:147], v208 offset:53248
  v_max3_f32 v253, v253, v188, v189
  v_mfma_f32_16x16x32_bf16 v[24:27], v[152:155], v[192:195], v[24:27]
  v_mfma_f32_16x16x32_bf16 v[56:59], v[152:155], v[196:199], v[56:59]
  ds_read_b64_tr_b16 v[148:149], v209 offset:49152
  ds_read_b64_tr_b16 v[150:151], v209 offset:53248
  v_max3_f32 v252, v252, v190, v191
  s_waitcnt lgkmcnt(15)
  v_mfma_f32_16x16x32_bf16 v[28:31], v[156:159], v[192:195], v[28:31]
  v_max_f32 v252, v252, v253
  v_mfma_f32_16x16x32_bf16 v[60:63], v[156:159], v[196:199], v[60:63]
  ds_read_b64_tr_b16 v[152:153], v210 offset:49152
  ds_read_b64_tr_b16 v[154:155], v210 offset:53248
  v_cmp_lt_f32 vcc, s40, v252
  s_cbranch_vccz L_nr_3
  s_call_b64 s[50:51], L_rescale1
L_nr_3:
  v_mfma_f32_16x16x32_bf16 v[160:163], v[96:99], v[64:67], v[212:215]
  v_exp_f32 v176, v176
  v_exp_f32 v177, v177
  v_mfma_f32_16x16x32_bf16 v[168:171], v[96:99], v[80:83], v[216:219]
  ds_read_b64_tr_b16 v[156:157], v211 offset:49152
  ds_read_b64_tr_b16 v[158:159], v211 offset:53248
  v_exp_f32 v178, v178
  v_mfma_f32_16x16x32_bf16 v[164:167], v[100:103], v[64:67], v[212:215]
  v_exp_f32 v179, v179
  v_cvt_pk_bf16_f32 v192, v176, v177
  v_mfma_f32_16x16x32_bf16 v[172:175], v[100:103], v[80:83], v[216:219]
  ds_read_b128 v[96:99], v224 offset:24576
  v_exp_f32 v180, v180
  v_mfma_f32_16x16x32_bf16 v[160:163], v[104:107], v[68:71], v[160:163]
  v_exp_f32 v181, v181
  v_cvt_pk_bf16_f32 v193, v178, v179
  v_mfma_f32_16x16x32_bf16 v[168:171], v[104:107], v[84:87], v[168:171]
  ds_read_b128 v[100:103], v224 offset:28672
  v_exp_f32 v182, v182
  v_mfma_f32_16x16x32_bf16 v[164:167], v[108:111], v[68:71], v[164:167]
  v_exp_f32 v183, v183
  v_cvt_pk_bf16_f32 v194, v180, v181
  v_mfma_f32_16x16x32_bf16 v[172:175], v[108:111], v[84:87], v[172:175]
  ds_read_b128 v[104:107], v225 offset:24576
  v_exp_f32 v184, v184
  v_mfma_f32_16x16x32_bf16 v[160:163], v[112:115], v[72:75], v[160:163]
  v_exp_f32 v185, v185
  v_cvt_pk_bf16_f32 v195, v182, v183
  v_mfma_f32_16x16x32_bf16 v[168:171], v[112:115], v[88:91], v[168:171]
  ds_read_b128 v[108:111], v225 offset:28672
  v_exp_f32 v186, v186
  s_waitcnt lgkmcnt(15)
  v_mfma_f32_16x16x32_bf16 v[164:167], v[116:119], v[72:75], v[164:167]
  v_exp_f32 v187, v187
  v_cvt_pk_bf16_f32 v196, v184, v185
  v_mfma_f32_16x16x32_bf16 v[172:175], v[116:119], v[88:91], v[172:175]
  ds_read_b128 v[112:115], v226 offset:24576
  v_exp_f32 v188, v188
  v_mfma_f32_16x16x32_bf16 v[160:163], v[120:123], v[76:79], v[160:163]
  v_exp_f32 v189, v189
  v_cvt_pk_bf16_f32 v197, v186, v187
  v_mfma_f32_16x16x32_bf16 v[168:171], v[120:123], v[92:95], v[168:171]
  ds_read_b128 v[116:119], v226 offset:28672
  v_exp_f32 v190, v190
  v_mfma_f32_16x16x32_bf16 v[164:167], v[124:127], v[76:79], v[164:167]
  v_exp_f32 v191, v191
  v_cvt_pk_bf16_f32 v198, v188, v189
  v_mfma_f32_16x16x32_bf16 v[172:175], v[124:127], v[92:95], v[172:175]
  ds_read_b128 v[120:123], v227 offset:24576
  v_cvt_pk_bf16_f32 v199, v190, v191
  ds_read_b128 v[236:239], v220
  v_mfma_f32_16x16x32_bf16 v[240:243], v[248:251], v[192:195], v[240:243]
  v_mfma_f32_16x16x32_bf16 v[244:247], v[248:251], v[196:199], v[244:247]
  ds_read_b128 v[124:127], v227 offset:28672
  v_mfma_f32_16x16x32_bf16 v[0:3], v[128:131], v[192:195], v[0:3]
  v_mfma_f32_16x16x32_bf16 v[32:35], v[128:131], v[196:199], v[32:35]
  v_mfma_f32_16x16x32_bf16 v[4:7], v[132:135], v[192:195], v[4:7]
  s_waitcnt lgkmcnt(0)
  v_mov_b32 v254, 3
  v_min3_u32 v255, v236, v237, v238
  s_mov_b32 s91, 4
  s_mov_b64 exec, 1
  ds_write_b32 v221, v254
  s_mov_b64 exec, -1
  v_min_u32 v255, v255, v239
  v_cmp_gt_u32 vcc, s91, v255
  s_cbranch_vccz L_fok_4
  s_call_b64 s[50:51], L_cspin
L_fok_4:
  v_mfma_f32_16x16x32_bf16 v[36:39], v[132:135], v[196:199], v[36:39]
  ds_read_b64_tr_b16 v[128:129], v228 offset:0
  ds_read_b64_tr_b16 v[130:131], v228 offset:4096
  v_mfma_f32_16x16x32_bf16 v[8:11], v[136:139], v[192:195], v[8:11]
  v_max3_f32 v252, v160, v161, v162
  v_mfma_f32_16x16x32_bf16 v[40:43], v[136:139], v[196:199], v[40:43]
  ds_read_b64_tr_b16 v[132:133], v229 offset:0
  ds_read_b64_tr_b16 v[134:135], v229 offset:4096
  v_max3_f32 v253, v163, v164, v165
  v_mfma_f32_16x16x32_bf16 v[12:15], v[140:143], v[192:195], v[12:15]
  v_mfma_f32_16x16x32_bf16 v[44:47], v[140:143], v[196:199], v[44:47]
  ds_read_b64_tr_b16 v[136:137], v230 offset:0
  ds_read_b64_tr_b16 v[138:139], v230 offset:4096
  v_max3_f32 v252, v252, v166, v167
  v_mfma_f32_16x16x32_bf16 v[16:19], v[144:147], v[192:195], v[16:19]
  v_max3_f32 v253, v253, v168, v169
  v_mfma_f32_16x16x32_bf16 v[48:51], v[144:147], v[196:199], v[48:51]
  ds_read_b64_tr_b16 v[140:141], v231 offset:0
  ds_read_b64_tr_b16 v[142:143], v231 offset:4096
  v_mfma_f32_16x16x32_bf16 v[20:23], v[148:151], v[192:195], v[20:23]
  v_max3_f32 v252, v252, v170, v171
  v_mfma_f32_16x16x32_bf16 v[52:55], v[148:151], v[196:199], v[52:55]
  ds_read_b64_tr_b16 v[144:145], v232 offset:0
  ds_read_b64_tr_b16 v[146:147], v232 offset:4096
  v_max3_f32 v253, v253, v172, v173
  v_mfma_f32_16x16x32_bf16 v[24:27], v[152:155], v[192:195], v[24:27]
  v_mfma_f32_16x16x32_bf16 v[56:59], v[152:155], v[196:199], v[56:59]
  ds_read_b64_tr_b16 v[148:149], v233 offset:0
  ds_read_b64_tr_b16 v[150:151], v233 offset:4096
  v_max3_f32 v252, v252, v174, v175
  v_mfma_f32_16x16x32_bf16 v[28:31], v[156:159], v[192:195], v[28:31]
  v_max_f32 v252, v252, v253
  v_mfma_f32_16x16x32_bf16 v[60:63], v[156:159], v[196:199], v[60:63]
  ds_read_b64_tr_b16 v[152:153], v234 offset:0
  ds_read_b64_tr_b16 v[154:155], v234 offset:4096
  v_cmp_lt_f32 vcc, s40, v252
  s_cbranch_vccz L_nr_4
  s_call_b64 s[50:51], L_rescale0
L_nr_4:
  v_mfma_f32_16x16x32_bf16 v[176:179], v[96:99], v[64:67], v[212:215]
  v_exp_f32 v160, v160
  v_exp_f32 v161, v161
  v_mfma_f32_16x16x32_bf16 v[184:187], v[96:99], v[80:83], v[216:219]
  ds_read_b64_tr_b16 v[156:157], v235 offset:0
  ds_read_b64_tr_b16 v[158:159], v235 offset:4096
  v_exp_f32 v162, v162
  v_mfma_f32_16x16x32_bf16 v[180:183], v[100:103], v[64:67], v[212:215]
  v_exp_f32 v163, v163
  v_cvt_pk_bf16_f32 v192, v160, v161
  v_mfma_f32_16x16x32_bf16 v[188:191], v[100:103], v[80:83], v[216:219]
  ds_read_b128 v[96:99], v224 offset:40960
  v_exp_f32 v164, v164
  v_mfma_f32_16x16x32_bf16 v[176:179], v[104:107], v[68:71], v[176:179]
  v_exp_f32 v165, v165
  v_cvt_pk_bf16_f32 v193, v162, v163
  v_mfma_f32_16x16x32_bf16 v[184:187], v[104:107], v[84:87], v[184:187]
  ds_read_b128 v[100:103], v224 offset:45056
  v_exp_f32 v166, v166
  v_mfma_f32_16x16x32_bf16 v[180:183], v[108:111], v[68:71], v[180:183]
  v_exp_f32 v167, v167
  v_cvt_pk_bf16_f32 v194, v164, v165
  v_mfma_f32_16x16x32_bf16 v[188:191], v[108:111], v[84:87], v[188:191]
  ds_read_b128 v[104:107], v225 offset:40960
  v_exp_f32 v168, v168
  v_mfma_f32_16x16x32_bf16 v[176:179], v[112:115], v[72:75], v[176:179]
  v_exp_f32 v169, v169
  v_cvt_pk_bf16_f32 v195, v166, v167
  v_mfma_f32_16x16x32_bf16 v[184:187], v[112:115], v[88:91], v[184:187]
  ds_read_b128 v[108:111], v225 offset:45056
  v_exp_f32 v170, v170
  v_mfma_f32_16x16x32_bf16 v[180:183], v[116:119], v[72:75], v[180:183]
  v_exp_f32 v171, v171
  v_cvt_pk_bf16_f32 v196, v168, v169
  v_mfma_f32_16x16x32_bf16 v[188:191], v[116:119], v[88:91], v[188:191]
  ds_read_b128 v[112:115], v226 offset:40960
  v_exp_f32 v172, v172
  v_mfma_f32_16x16x32_bf16 v[176:179], v[120:123], v[76:79], v[176:179]
  v_exp_f32 v173, v173
  v_cvt_pk_bf16_f32 v197, v170, v171
  v_mfma_f32_16x16x32_bf16 v[184:187], v[120:123], v[92:95], v[184:187]
  ds_read_b128 v[116:119], v226 offset:45056
  v_exp_f32 v174, v174
  v_mfma_f32_16x16x32_bf16 v[180:183], v[124:127], v[76:79], v[180:183]
  v_exp_f32 v175, v175
  v_cvt_pk_bf16_f32 v198, v172, v173
  v_mfma_f32_16x16x32_bf16 v[188:191], v[124:127], v[92:95], v[188:191]
  ds_read_b128 v[120:123], v227 offset:40960
  v_cvt_pk_bf16_f32 v199, v174, v175
  v_mfma_f32_16x16x32_bf16 v[240:243], v[248:251], v[192:195], v[240:243]
  s_nop 0
  v_mfma_f32_16x16x32_bf16 v[244:247], v[248:251], v[196:199], v[244:247]
  ds_read_b128 v[124:127], v227 offset:45056
  s_waitcnt lgkmcnt(15)
  v_mfma_f32_16x16x32_bf16 v[0:3], v[128:131], v[192:195], v[0:3]
  v_mfma_f32_16x16x32_bf16 v[32:35], v[128:131], v[196:199], v[32:35]
  v_mfma_f32_16x16x32_bf16 v[4:7], v[132:135], v[192:195], v[4:7]
  v_mfma_f32_16x16x32_bf16 v[36:39], v[132:135], v[196:199], v[36:39]
  ds_read_b64_tr_b16 v[128:129], v228 offset:16384
  ds_read_b64_tr_b16 v[130:131], v228 offset:20480
  v_mfma_f32_16x16x32_bf16 v[8:11], v[136:139], v[192:195], v[8:11]
  v_max3_f32 v252, v176, v177, v178
  v_mfma_f32_16x16x32_bf16 v[40:43], v[136:139], v[196:199], v[40:43]
  ds_read_b64_tr_b16 v[132:133], v229 offset:16384
  ds_read_b64_tr_b16 v[134:135], v229 offset:20480
  v_max3_f32 v253, v179, v180, v181
  v_mfma_f32_16x16x32_bf16 v[12:15], v[140:143], v[192:195], v[12:15]
  v_mfma_f32_16x16x32_bf16 v[44:47], v[140:143], v[196:199], v[44:47]
  ds_read_b64_tr_b16 v[136:137], v230 offset:16384
  ds_read_b64_tr_b16 v[138:139], v230 offset:20480
  v_max3_f32 v252, v252, v182, v183
  s_waitcnt lgkmcnt(15)
  v_mfma_f32_16x16x32_bf16 v[16:19], v[144:147], v[192:195], v[16:19]
  v_max3_f32 v253, v253, v184, v185
  v_mfma_f32_16x16x32_bf16 v[48:51], v[144:147], v[196:199], v[48:51]
  ds_read_b64_tr_b16 v[140:141], v231 offset:16384
  ds_read_b64_tr_b16 v[142:143], v231 offset:20480
  v_mfma_f32_16x16x32_bf16 v[20:23], v[148:151], v[192:195], v[20:23]
  v_max3_f32 v252, v252, v186, v187
  v_mfma_f32_16x16x32_bf16 v[52:55], v[148:151], v[196:199], v[52:55]
  ds_read_b64_tr_b16 v[144:145], v232 offset:16384
  ds_read_b64_tr_b16 v[146:147], v232 offset:20480
  v_max3_f32 v253, v253, v188, v189
  v_mfma_f32_16x16x32_bf16 v[24:27], v[152:155], v[192:195], v[24:27]
  v_mfma_f32_16x16x32_bf16 v[56:59], v[152:155], v[196:199], v[56:59]
  ds_read_b64_tr_b16 v[148:149], v233 offset:16384
  ds_read_b64_tr_b16 v[150:151], v233 offset:20480
  v_max3_f32 v252, v252, v190, v191
  s_waitcnt lgkmcnt(15)
  v_mfma_f32_16x16x32_bf16 v[28:31], v[156:159], v[192:195], v[28:31]
  v_max_f32 v252, v252, v253
  v_mfma_f32_16x16x32_bf16 v[60:63], v[156:159], v[196:199], v[60:63]
  ds_read_b64_tr_b16 v[152:153], v234 offset:16384
  ds_read_b64_tr_b16 v[154:155], v234 offset:20480
  v_cmp_lt_f32 vcc, s40, v252
  s_cbranch_vccz L_nr_5
  s_call_b64 s[50:51], L_rescale1
L_nr_5:
  v_mfma_f32_16x16x32_bf16 v[160:163], v[96:99], v[64:67], v[212:215]
  v_exp_f32 v176, v176
  v_exp_f32 v177, v177
  v_mfma_f32_16x16x32_bf16 v[168:171], v[96:99], v[80:83], v[216:219]
  ds_read_b64_tr_b16 v[156:157], v235 offset:16384
  ds_read_b64_tr_b16 v[158:159], v235 offset:20480
  v_exp_f32 v178, v178
  v_mfma_f32_16x16x32_bf16 v[164:167], v[100:103], v[64:67], v[212:215]
  v_exp_f32 v179, v179
  v_cvt_pk_bf16_f32 v192, v176, v177
  v_mfma_f32_16x16x32_bf16 v[172:175], v[100:103], v[80:83], v[216:219]
  ds_read_b128 v[96:99], v224 offset:57344
  v_exp_f32 v180, v180
  v_mfma_f32_16x16x32_bf16 v[160:163], v[104:107], v[68:71], v[160:163]
  v_exp_f32 v181, v181
  v_cvt_pk_bf16_f32 v193, v178, v179
  v_mfma_f32_16x16x32_bf16 v[168:171], v[104:107], v[84:87], v[168:171]
  ds_read_b128 v[100:103], v224 offset:61440
  v_exp_f32 v182, v182
  v_mfma_f32_16x16x32_bf16 v[164:167], v[108:111], v[68:71], v[164:167]
  v_exp_f32 v183, v183
  v_cvt_pk_bf16_f32 v194, v180, v181
  v_mfma_f32_16x16x32_bf16 v[172:175], v[108:111], v[84:87], v[172:175]
  ds_read_b128 v[104:107], v225 offset:57344
  v_exp_f32 v184, v184
  v_mfma_f32_16x16x32_bf16 v[160:163], v[112:115], v[72:75], v[160:163]
  v_exp_f32 v185, v185
  v_cvt_pk_bf16_f32 v195, v182, v183
  v_mfma_f32_16x16x32_bf16 v[168:171], v[112:115], v[88:91], v[168:171]
  ds_read_b128 v[108:111], v225 offset:61440
  v_exp_f32 v186, v186
  s_waitcnt lgkmcnt(15)
  v_mfma_f32_16x16x32_bf16 v[164:167], v[116:119], v[72:75], v[164:167]
  v_exp_f32 v187, v187
  v_cvt_pk_bf16_f32 v196, v184, v185
  v_mfma_f32_16x16x32_bf16 v[172:175], v[116:119], v[88:91], v[172:175]
  ds_read_b128 v[112:115], v226 offset:57344
  v_exp_f32 v188, v188
  v_mfma_f32_16x16x32_bf16 v[160:163], v[120:123], v[76:79], v[160:163]
  v_exp_f32 v189, v189
  v_cvt_pk_bf16_f32 v197, v186, v187
  v_mfma_f32_16x16x32_bf16 v[168:171], v[120:123], v[92:95], v[168:171]
  ds_read_b128 v[116:119], v226 offset:61440
  v_exp_f32 v190, v190
  v_mfma_f32_16x16x32_bf16 v[164:167], v[124:127], v[76:79], v[164:167]
  v_exp_f32 v191, v191
  v_cvt_pk_bf16_f32 v198, v188, v189
  v_mfma_f32_16x16x32_bf16 v[172:175], v[124:127], v[92:95], v[172:175]
  ds_read_b128 v[120:123], v227 offset:57344
  v_cvt_pk_bf16_f32 v199, v190, v191
  ds_read_b128 v[236:239], v220
  v_mfma_f32_16x16x32_bf16 v[240:243], v[248:251], v[192:195], v[240:243]
  v_mfma_f32_16x16x32_bf16 v[244:247], v[248:251], v[196:199], v[244:247]
  ds_read_b128 v[124:127], v227 offset:61440
  v_mfma_f32_16x16x32_bf16 v[0:3], v[128:131], v[192:195], v[0:3]
  v_mfma_f32_16x16x32_bf16 v[32:35], v[128:131], v[196:199], v[32:35]
  v_mfma_f32_16x16x32_bf16 v[4:7], v[132:135], v[192:195], v[4:7]
  s_waitcnt lgkmcnt(0)
  v_mov_b32 v254, 4
  v_min3_u32 v255, v236, v237, v238
  s_mov_b32 s91, 5
  s_mov_b64 exec, 1
  ds_write_b32 v221, v254
  s_mov_b64 exec, -1
  v_min_u32 v255, v255, v239
  v_cmp_gt_u32 vcc, s91, v255
  s_cbranch_vccz L_fok_6
  s_call_b64 s[50:51], L_cspin
L_fok_6:
  v_mfma_f32_16x16x32_bf16 v[36:39], v[132:135], v[196:199], v[36:39]
  ds_read_b64_tr_b16 v[128:129], v228 offset:32768
  ds_read_b64_tr_b16 v[130:131], v228 offset:36864
  v_mfma_f32_16x16x32_bf16 v[8:11], v[136:139], v[192:195], v[8:11]
  v_max3_f32 v252, v160, v161, v162
  v_mfma_f32_16x16x32_bf16 v[40:43], v[136:139], v[196:199], v[40:43]
  ds_read_b64_tr_b16 v[132:133], v229 offset:32768
  ds_read_b64_tr_b16 v[134:135], v229 offset:36864
  v_max3_f32 v253, v163, v164, v165
  v_mfma_f32_16x16x32_bf16 v[12:15], v[140:143], v[192:195], v[12:15]
  v_mfma_f32_16x16x32_bf16 v[44:47], v[140:143], v[196:199], v[44:47]
  ds_read_b64_tr_b16 v[136:137], v230 offset:32768
  ds_read_b64_tr_b16 v[138:139], v230 offset:36864
  v_max3_f32 v252, v252, v166, v167
  v_mfma_f32_16x16x32_bf16 v[16:19], v[144:147], v[192:195], v[16:19]
  v_max3_f32 v253, v253, v168, v169
  v_mfma_f32_16x16x32_bf16 v[48:51], v[144:147], v[196:199], v[48:51]
  ds_read_b64_tr_b16 v[140:141], v231 offset:32768
  ds_read_b64_tr_b16 v[142:143], v231 offset:36864
  v_mfma_f32_16x16x32_bf16 v[20:23], v[148:151], v[192:195], v[20:23]
  v_max3_f32 v252, v252, v170, v171
  v_mfma_f32_16x16x32_bf16 v[52:55], v[148:151], v[196:199], v[52:55]
  ds_read_b64_tr_b16 v[144:145], v232 offset:32768
  ds_read_b64_tr_b16 v[146:147], v232 offset:36864
  v_max3_f32 v253, v253, v172, v173
  v_mfma_f32_16x16x32_bf16 v[24:27], v[152:155], v[192:195], v[24:27]
  v_mfma_f32_16x16x32_bf16 v[56:59], v[152:155], v[196:199], v[56:59]
  ds_read_b64_tr_b16 v[148:149], v233 offset:32768
  ds_read_b64_tr_b16 v[150:151], v233 offset:36864
  v_max3_f32 v252, v252, v174, v175
  v_mfma_f32_16x16x32_bf16 v[28:31], v[156:159], v[192:195], v[28:31]
  v_max_f32 v252, v252, v253
  v_mfma_f32_16x16x32_bf16 v[60:63], v[156:159], v[196:199], v[60:63]
  ds_read_b64_tr_b16 v[152:153], v234 offset:32768
  ds_read_b64_tr_b16 v[154:155], v234 offset:36864
  v_cmp_lt_f32 vcc, s40, v252
  s_cbranch_vccz L_nr_6
  s_call_b64 s[50:51], L_rescale0
L_nr_6:
  v_mfma_f32_16x16x32_bf16 v[176:179], v[96:99], v[64:67], v[212:215]
  v_exp_f32 v160, v160
  v_exp_f32 v161, v161
  v_mfma_f32_16x16x32_bf16 v[184:187], v[96:99], v[80:83], v[216:219]
  ds_read_b64_tr_b16 v[156:157], v235 offset:32768
  ds_read_b64_tr_b16 v[158:159], v235 offset:36864
  v_exp_f32 v162, v162
  v_mfma_f32_16x16x32_bf16 v[180:183], v[100:103], v[64:67], v[212:215]
  v_exp_f32 v163, v163
  v_cvt_pk_bf16_f32 v192, v160, v161
  v_mfma_f32_16x16x32_bf16 v[188:191], v[100:103], v[80:83], v[216:219]
  ds_read_b128 v[96:99], v200 offset:8192
  v_exp_f32 v164, v164
  v_mfma_f32_16x16x32_bf16 v[176:179], v[104:107], v[68:71], v[176:179]
  v_exp_f32 v165, v165
  v_cvt_pk_bf16_f32 v193, v162, v163
  v_mfma_f32_16x16x32_bf16 v[184:187], v[104:107], v[84:87], v[184:187]
  ds_read_b128 v[100:103], v200 offset:12288
  v_exp_f32 v166, v166
  v_mfma_f32_16x16x32_bf16 v[180:183], v[108:111], v[68:71], v[180:183]
  v_exp_f32 v167, v167
  v_cvt_pk_bf16_f32 v194, v164, v165
  v_mfma_f32_16x16x32_bf16 v[188:191], v[108:111], v[84:87], v[188:191]
  ds_read_b128 v[104:107], v201 offset:8192
  v_exp_f32 v168, v168
  v_mfma_f32_16x16x32_bf16 v[176:179], v[112:115], v[72:75], v[176:179]
  v_exp_f32 v169, v169
  v_cvt_pk_bf16_f32 v195, v166, v167
  v_mfma_f32_16x16x32_bf16 v[184:187], v[112:115], v[88:91], v[184:187]
  ds_read_b128 v[108:111], v201 offset:12288
  v_exp_f32 v170, v170
  v_mfma_f32_16x16x32_bf16 v[180:183], v[116:119], v[72:75], v[180:183]
  v_exp_f32 v171, v171
  v_cvt_pk_bf16_f32 v196, v168, v169
  v_mfma_f32_16x16x32_bf16 v[188:191], v[116:119], v[88:91], v[188:191]
  ds_read_b128 v[112:115], v202 offset:8192
  v_exp_f32 v172, v172
  v_mfma_f32_16x16x32_bf16 v[176:179], v[120:123], v[76:79], v[176:179]
  v_exp_f32 v173, v173
  v_cvt_pk_bf16_f32 v197, v170, v171
  v_mfma_f32_16x16x32_bf16 v[184:187], v[120:123], v[92:95], v[184:187]
  ds_read_b128 v[116:119], v202 offset:12288
  v_exp_f32 v174, v174
  v_mfma_f32_16x16x32_bf16 v[180:183], v[124:127], v[76:79], v[180:183]
  v_exp_f32 v175, v175
  v_cvt_pk_bf16_f32 v198, v172, v173
  v_mfma_f32_16x16x32_bf16 v[188:191], v[124:127], v[92:95], v[188:191]
  ds_read_b128 v[120:123], v203 offset:8192
  v_cvt_pk_bf16_f32 v199, v174, v175
  v_mfma_f32_16x16x32_bf16 v[240:243], v[248:251], v[192:195], v[240:243]
  s_nop 0
  v_mfma_f32_16x16x32_bf16 v[244:247], v[248:251], v[196:199], v[244:247]
  ds_read_b128 v[124:127], v203 offset:12288
  s_waitcnt lgkmcnt(15)
  v_mfma_f32_16x16x32_bf16 v[0:3], v[128:131], v[192:195], v[0:3]
  v_mfma_f32_16x16x32_bf16 v[32:35], v[128:131], v[196:199], v[32:35]
  v_mfma_f32_16x16x32_bf16 v[4:7], v[132:135], v[192:195], v[4:7]
  v_mfma_f32_16x16x32_bf16 v[36:39], v[132:135], v[196:199], v[36:39]
  ds_read_b64_tr_b16 v[128:129], v228 offset:49152
  ds_read_b64_tr_b16 v[130:131], v228 offset:53248
  v_mfma_f32_16x16x32_bf16 v[8:11], v[136:139], v[192:195], v[8:11]
  v_max3_f32 v252, v176, v177, v178
  v_mfma_f32_16x16x32_bf16 v[40:43], v[136:139], v[196:199], v[40:43]
  ds_read_b64_tr_b16 v[132:133], v229 offset:49152
  ds_read_b64_tr_b16 v[134:135], v229 offset:53248
  v_max3_f32 v253, v179, v180, v181
  v_mfma_f32_16x16x32_bf16 v[12:15], v[140:143], v[192:195], v[12:15]
  v_mfma_f32_16x16x32_bf16 v[44:47], v[140:143], v[196:199], v[44:47]
  ds_read_b64_tr_b16 v[136:137], v230 offset:49152
  ds_read_b64_tr_b16 v[138:139], v230 offset:53248
  v_max3_f32 v252, v252, v182, v183
  s_waitcnt lgkmcnt(15)
  v_mfma_f32_16x16x32_bf16 v[16:19], v[144:147], v[192:195], v[16:19]
  v_max3_f32 v253, v253, v184, v185
  v_mfma_f32_16x16x32_bf16 v[48:51], v[144:147], v[196:199], v[48:51]
  ds_read_b64_tr_b16 v[140:141], v231 offset:49152
  ds_read_b64_tr_b16 v[142:143], v231 offset:53248
  v_mfma_f32_16x16x32_bf16 v[20:23], v[148:151], v[192:195], v[20:23]
  v_max3_f32 v252, v252, v186, v187
  v_mfma_f32_16x16x32_bf16 v[52:55], v[148:151], v[196:199], v[52:55]
  ds_read_b64_tr_b16 v[144:145], v232 offset:49152
  ds_read_b64_tr_b16 v[146:147], v232 offset:53248
  v_max3_f32 v253, v253, v188, v189
  v_mfma_f32_16x16x32_bf16 v[24:27], v[152:155], v[192:195], v[24:27]
  v_mfma_f32_16x16x32_bf16 v[56:59], v[152:155], v[196:199], v[56:59]
  ds_read_b64_tr_b16 v[148:149], v233 offset:49152
  ds_read_b64_tr_b16 v[150:151], v233 offset:53248
  v_max3_f32 v252, v252, v190, v191
  s_waitcnt lgkmcnt(15)
  v_mfma_f32_16x16x32_bf16 v[28:31], v[156:159], v[192:195], v[28:31]
  v_max_f32 v252, v252, v253
  v_mfma_f32_16x16x32_bf16 v[60:63], v[156:159], v[196:199], v[60:63]
  ds_read_b64_tr_b16 v[152:153], v234 offset:49152
  ds_read_b64_tr_b16 v[154:155], v234 offset:53248
  v_cmp_lt_f32 vcc, s40, v252
  s_cbranch_vccz L_nr_7
  s_call_b64 s[50:51], L_rescale1
L_nr_7:
  v_mfma_f32_16x16x32_bf16 v[160:163], v[96:99], v[64:67], v[212:215]
  v_exp_f32 v176, v176
  v_exp_f32 v177, v177
  v_mfma_f32_16x16x32_bf16 v[168:171], v[96:99], v[80:83], v[216:219]
  ds_read_b64_tr_b16 v[156:157], v235 offset:49152
  ds_read_b64_tr_b16 v[158:159], v235 offset:53248
  v_exp_f32 v178, v178
  v_mfma_f32_16x16x32_bf16 v[164:167], v[100:103], v[64:67], v[212:215]
  v_exp_f32 v179, v179
  v_cvt_pk_bf16_f32 v192, v176, v177
  v_mfma_f32_16x16x32_bf16 v[172:175], v[100:103], v[80:83], v[216:219]
  ds_read_b128 v[96:99], v200 offset:24576
  v_exp_f32 v180, v180
  v_mfma_f32_16x16x32_bf16 v[160:163], v[104:107], v[68:71], v[160:163]
  v_exp_f32 v181, v181
  v_cvt_pk_bf16_f32 v193, v178, v179
  v_mfma_f32_16x16x32_bf16 v[168:171], v[104:107], v[84:87], v[168:171]
  ds_read_b128 v[100:103], v200 offset:28672
  v_exp_f32 v182, v182
  v_mfma_f32_16x16x32_bf16 v[164:167], v[108:111], v[68:71], v[164:167]
  v_exp_f32 v183, v183
  v_cvt_pk_bf16_f32 v194, v180, v181
  v_mfma_f32_16x16x32_bf16 v[172:175], v[108:111], v[84:87], v[172:175]
  ds_read_b128 v[104:107], v201 offset:24576
  v_exp_f32 v184, v184
  v_mfma_f32_16x16x32_bf16 v[160:163], v[112:115], v[72:75], v[160:163]
  v_exp_f32 v185, v185
  v_cvt_pk_bf16_f32 v195, v182, v183
  v_mfma_f32_16x16x32_bf16 v[168:171], v[112:115], v[88:91], v[168:171]
  ds_read_b128 v[108:111], v201 offset:28672
  v_exp_f32 v186, v186
  s_waitcnt lgkmcnt(15)
  v_mfma_f32_16x16x32_bf16 v[164:167], v[116:119], v[72:75], v[164:167]
  v_exp_f32 v187, v187
  v_cvt_pk_bf16_f32 v196, v184, v185
  v_mfma_f32_16x16x32_bf16 v[172:175], v[116:119], v[88:91], v[172:175]
  ds_read_b128 v[112:115], v202 offset:24576
  v_exp_f32 v188, v188
  v_mfma_f32_16x16x32_bf16 v[160:163], v[120:123], v[76:79], v[160:163]
  v_exp_f32 v189, v189
  v_cvt_pk_bf16_f32 v197, v186, v187
  v_mfma_f32_16x16x32_bf16 v[168:171], v[120:123], v[92:95], v[168:171]
  ds_read_b128 v[116:119], v202 offset:28672
  v_exp_f32 v190, v190
  v_mfma_f32_16x16x32_bf16 v[164:167], v[124:127], v[76:79], v[164:167]
  v_exp_f32 v191, v191
  v_cvt_pk_bf16_f32 v198, v188, v189
  v_mfma_f32_16x16x32_bf16 v[172:175], v[124:127], v[92:95], v[172:175]
  ds_read_b128 v[120:123], v203 offset:24576
  v_cvt_pk_bf16_f32 v199, v190, v191
  ds_read_b128 v[236:239], v220
  v_mfma_f32_16x16x32_bf16 v[240:243], v[248:251], v[192:195], v[240:243]
  v_mfma_f32_16x16x32_bf16 v[244:247], v[248:251], v[196:199], v[244:247]
  ds_read_b128 v[124:127], v203 offset:28672
  v_mfma_f32_16x16x32_bf16 v[0:3], v[128:131], v[192:195], v[0:3]
  v_mfma_f32_16x16x32_bf16 v[32:35], v[128:131], v[196:199], v[32:35]
  v_mfma_f32_16x16x32_bf16 v[4:7], v[132:135], v[192:195], v[4:7]
  s_waitcnt lgkmcnt(0)
  v_mov_b32 v254, 5
  v_min3_u32 v255, v236, v237, v238
  s_mov_b32 s91, 6
  s_mov_b64 exec, 1
  ds_write_b32 v221, v254
  s_mov_b64 exec, -1
  v_min_u32 v255, v255, v239
  v_cmp_gt_u32 vcc, s91, v255
  s_cbranch_vccz L_fok_8
  s_call_b64 s[50:51], L_cspin
L_fok_8:
  v_mfma_f32_16x16x32_bf16 v[36:39], v[132:135], v[196:199], v[36:39]
  ds_read_b64_tr_b16 v[128:129], v204 offset:0
  ds_read_b64_tr_b16 v[130:131], v204 offset:4096
  v_mfma_f32_16x16x32_bf16 v[8:11], v[136:139], v[192:195], v[8:11]
  v_max3_f32 v252, v160, v161, v162
  v_mfma_f32_16x16x32_bf16 v[40:43], v[136:139], v[196:199], v[40:43]
  ds_read_b64_tr_b16 v[132:133], v205 offset:0
  ds_read_b64_tr_b16 v[134:135], v205 offset:4096
  v_max3_f32 v253, v163, v164, v165
  v_mfma_f32_16x16x32_bf16 v[12:15], v[140:143], v[192:195], v[12:15]
  v_mfma_f32_16x16x32_bf16 v[44:47], v[140:143], v[196:199], v[44:47]
  ds_read_b64_tr_b16 v[136:137], v206 offset:0
  ds_read_b64_tr_b16 v[138:139], v206 offset:4096
  v_max3_f32 v252, v252, v166, v167
  v_mfma_f32_16x16x32_bf16 v[16:19], v[144:147], v[192:195], v[16:19]
  v_max3_f32 v253, v253, v168, v169
  v_mfma_f32_16x16x32_bf16 v[48:51], v[144:147], v[196:199], v[48:51]
  ds_read_b64_tr_b16 v[140:141], v207 offset:0
  ds_read_b64_tr_b16 v[142:143], v207 offset:4096
  v_mfma_f32_16x16x32_bf16 v[20:23], v[148:151], v[192:195], v[20:23]
  v_max3_f32 v252, v252, v170, v171
  v_mfma_f32_16x16x32_bf16 v[52:55], v[148:151], v[196:199], v[52:55]
  ds_read_b64_tr_b16 v[144:145], v208 offset:0
  ds_read_b64_tr_b16 v[146:147], v208 offset:4096
  v_max3_f32 v253, v253, v172, v173
  v_mfma_f32_16x16x32_bf16 v[24:27], v[152:155], v[192:195], v[24:27]
  v_mfma_f32_16x16x32_bf16 v[56:59], v[152:155], v[196:199], v[56:59]
  ds_read_b64_tr_b16 v[148:149], v209 offset:0
  ds_read_b64_tr_b16 v[150:151], v209 offset:4096
  v_max3_f32 v252, v252, v174, v175
  v_mfma_f32_16x16x32_bf16 v[28:31], v[156:159], v[192:195], v[28:31]
  v_max_f32 v252, v252, v253
  v_mfma_f32_16x16x32_bf16 v[60:63], v[156:159], v[196:199], v[60:63]
  ds_read_b64_tr_b16 v[152:153], v210 offset:0
  ds_read_b64_tr_b16 v[154:155], v210 offset:4096
  v_cmp_lt_f32 vcc, s40, v252
  s_cbranch_vccz L_nr_8
  s_call_b64 s[50:51], L_rescale0
L_nr_8:
  v_mfma_f32_16x16x32_bf16 v[176:179], v[96:99], v[64:67], v[212:215]
  v_exp_f32 v160, v160
  v_exp_f32 v161, v161
  v_mfma_f32_16x16x32_bf16 v[184:187], v[96:99], v[80:83], v[216:219]
  ds_read_b64_tr_b16 v[156:157], v211 offset:0
  ds_read_b64_tr_b16 v[158:159], v211 offset:4096
  v_exp_f32 v162, v162
  v_mfma_f32_16x16x32_bf16 v[180:183], v[100:103], v[64:67], v[212:215]
  v_exp_f32 v163, v163
  v_cvt_pk_bf16_f32 v192, v160, v161
  v_mfma_f32_16x16x32_bf16 v[188:191], v[100:103], v[80:83], v[216:219]
  ds_read_b128 v[96:99], v200 offset:40960
  v_exp_f32 v164, v164
  v_mfma_f32_16x16x32_bf16 v[176:179], v[104:107], v[68:71], v[176:179]
  v_exp_f32 v165, v165
  v_cvt_pk_bf16_f32 v193, v162, v163
  v_mfma_f32_16x16x32_bf16 v[184:187], v[104:107], v[84:87], v[184:187]
  ds_read_b128 v[100:103], v200 offset:45056
  v_exp_f32 v166, v166
  v_mfma_f32_16x16x32_bf16 v[180:183], v[108:111], v[68:71], v[180:183]
  v_exp_f32 v167, v167
  v_cvt_pk_bf16_f32 v194, v164, v165
  v_mfma_f32_16x16x32_bf16 v[188:191], v[108:111], v[84:87], v[188:191]
  ds_read_b128 v[104:107], v201 offset:40960
  v_exp_f32 v168, v168
  v_mfma_f32_16x16x32_bf16 v[176:179], v[112:115], v[72:75], v[176:179]
  v_exp_f32 v169, v169
  v_cvt_pk_bf16_f32 v195, v166, v167
  v_mfma_f32_16x16x32_bf16 v[184:187], v[112:115], v[88:91], v[184:187]
  ds_read_b128 v[108:111], v201 offset:45056
  v_exp_f32 v170, v170
  v_mfma_f32_16x16x32_bf16 v[180:183], v[116:119], v[72:75], v[180:183]
  v_exp_f32 v171, v171
  v_cvt_pk_bf16_f32 v196, v168, v169
  v_mfma_f32_16x16x32_bf16 v[188:191], v[116:119], v[88:91], v[188:191]
  ds_read_b128 v[112:115], v202 offset:40960
  v_exp_f32 v172, v172
  v_mfma_f32_16x16x32_bf16 v[176:179], v[120:123], v[76:79], v[176:179]
  v_exp_f32 v173, v173
  v_cvt_pk_bf16_f32 v197, v170, v171
  v_mfma_f32_16x16x32_bf16 v[184:187], v[120:123], v[92:95], v[184:187]
  ds_read_b128 v[116:119], v202 offset:45056
  v_exp_f32 v174, v174
  v_mfma_f32_16x16x32_bf16 v[180:183], v[124:127], v[76:79], v[180:183]
  v_exp_f32 v175, v175
  v_cvt_pk_bf16_f32 v198, v172, v173
  v_mfma_f32_16x16x32_bf16 v[188:191], v[124:127], v[92:95], v[188:191]
  ds_read_b128 v[120:123], v203 offset:40960
  v_cvt_pk_bf16_f32 v199, v174, v175
  v_mfma_f32_16x16x32_bf16 v[240:243], v[248:251], v[192:195], v[240:243]
  s_nop 0
  v_mfma_f32_16x16x32_bf16 v[244:247], v[248:251], v[196:199], v[244:247]
  ds_read_b128 v[124:127], v203 offset:45056
  s_waitcnt lgkmcnt(15)
  v_mfma_f32_16x16x32_bf16 v[0:3], v[128:131], v[192:195], v[0:3]
  v_mfma_f32_16x16x32_bf16 v[32:35], v[128:131], v[196:199], v[32:35]
  v_mfma_f32_16x16x32_bf16 v[4:7], v[132:135], v[192:195], v[4:7]
  v_mfma_f32_16x16x32_bf16 v[36:39], v[132:135], v[196:199], v[36:39]
  ds_read_b64_tr_b16 v[128:129], v204 offset:16384
  ds_read_b64_tr_b16 v[130:131], v204 offset:20480
  v_mfma_f32_16x16x32_bf16 v[8:11], v[136:139], v[192:195], v[8:11]
  v_max3_f32 v252, v176, v177, v178
  v_mfma_f32_16x16x32_bf16 v[40:43], v[136:139], v[196:199], v[40:43]
  ds_read_b64_tr_b16 v[132:133], v205 offset:16384
  ds_read_b64_tr_b16 v[134:135], v205 offset:20480
  v_max3_f32 v253, v179, v180, v181
  v_mfma_f32_16x16x32_bf16 v[12:15], v[140:143], v[192:195], v[12:15]
  v_mfma_f32_16x16x32_bf16 v[44:47], v[140:143], v[196:199], v[44:47]
  ds_read_b64_tr_b16 v[136:137], v206 offset:16384
  ds_read_b64_tr_b16 v[138:139], v206 offset:20480
  v_max3_f32 v252, v252, v182, v183
  s_waitcnt lgkmcnt(15)
  v_mfma_f32_16x16x32_bf16 v[16:19], v[144:147], v[192:195], v[16:19]
  v_max3_f32 v253, v253, v184, v185
  v_mfma_f32_16x16x32_bf16 v[48:51], v[144:147], v[196:199], v[48:51]
  ds_read_b64_tr_b16 v[140:141], v207 offset:16384
  ds_read_b64_tr_b16 v[142:143], v207 offset:20480
  v_mfma_f32_16x16x32_bf16 v[20:23], v[148:151], v[192:195], v[20:23]
  v_max3_f32 v252, v252, v186, v187
  v_mfma_f32_16x16x32_bf16 v[52:55], v[148:151], v[196:199], v[52:55]
  ds_read_b64_tr_b16 v[144:145], v208 offset:16384
  ds_read_b64_tr_b16 v[146:147], v208 offset:20480
  v_max3_f32 v253, v253, v188, v189
  v_mfma_f32_16x16x32_bf16 v[24:27], v[152:155], v[192:195], v[24:27]
  v_mfma_f32_16x16x32_bf16 v[56:59], v[152:155], v[196:199], v[56:59]
  ds_read_b64_tr_b16 v[148:149], v209 offset:16384
  ds_read_b64_tr_b16 v[150:151], v209 offset:20480
  v_max3_f32 v252, v252, v190, v191
  s_waitcnt lgkmcnt(15)
  v_mfma_f32_16x16x32_bf16 v[28:31], v[156:159], v[192:195], v[28:31]
  v_max_f32 v252, v252, v253
  v_mfma_f32_16x16x32_bf16 v[60:63], v[156:159], v[196:199], v[60:63]
  ds_read_b64_tr_b16 v[152:153], v210 offset:16384
  ds_read_b64_tr_b16 v[154:155], v210 offset:20480
  v_cmp_lt_f32 vcc, s40, v252
  s_cbranch_vccz L_nr_9
  s_call_b64 s[50:51], L_rescale1
L_nr_9:
  v_mfma_f32_16x16x32_bf16 v[160:163], v[96:99], v[64:67], v[212:215]
  v_exp_f32 v176, v176
  v_exp_f32 v177, v177
  v_mfma_f32_16x16x32_bf16 v[168:171], v[96:99], v[80:83], v[216:219]
  ds_read_b64_tr_b16 v[156:157], v211 offset:16384
  ds_read_b64_tr_b16 v[158:159], v211 offset:20480
  v_exp_f32 v178, v178
  v_mfma_f32_16x16x32_bf16 v[164:167], v[100:103], v[64:67], v[212:215]
  v_exp_f32 v179, v179
  v_cvt_pk_bf16_f32 v192, v176, v177
  v_mfma_f32_16x16x32_bf16 v[172:175], v[100:103], v[80:83], v[216:219]
  ds_read_b128 v[96:99], v200 offset:57344
  v_exp_f32 v180, v180
  v_mfma_f32_16x16x32_bf16 v[160:163], v[104:107], v[68:71], v[160:163]
  v_exp_f32 v181, v181
  v_cvt_pk_bf16_f32 v193, v178, v179
  v_mfma_f32_16x16x32_bf16 v[168:171], v[104:107], v[84:87], v[168:171]
  ds_read_b128 v[100:103], v200 offset:61440
  v_exp_f32 v182, v182
  v_mfma_f32_16x16x32_bf16 v[164:167], v[108:111], v[68:71], v[164:167]
  v_exp_f32 v183, v183
  v_cvt_pk_bf16_f32 v194, v180, v181
  v_mfma_f32_16x16x32_bf16 v[172:175], v[108:111], v[84:87], v[172:175]
  ds_read_b128 v[104:107], v201 offset:57344
  v_exp_f32 v184, v184
  v_mfma_f32_16x16x32_bf16 v[160:163], v[112:115], v[72:75], v[160:163]
  v_exp_f32 v185, v185
  v_cvt_pk_bf16_f32 v195, v182, v183
  v_mfma_f32_16x16x32_bf16 v[168:171], v[112:115], v[88:91], v[168:171]
  ds_read_b128 v[108:111], v201 offset:61440
  v_exp_f32 v186, v186
  s_waitcnt lgkmcnt(15)
  v_mfma_f32_16x16x32_bf16 v[164:167], v[116:119], v[72:75], v[164:167]
  v_exp_f32 v187, v187
  v_cvt_pk_bf16_f32 v196, v184, v185
  v_mfma_f32_16x16x32_bf16 v[172:175], v[116:119], v[88:91], v[172:175]
  ds_read_b128 v[112:115], v202 offset:57344
  v_exp_f32 v188, v188
  v_mfma_f32_16x16x32_bf16 v[160:163], v[120:123], v[76:79], v[160:163]
  v_exp_f32 v189, v189
  v_cvt_pk_bf16_f32 v197, v186, v187
  v_mfma_f32_16x16x32_bf16 v[168:171], v[120:123], v[92:95], v[168:171]
  ds_read_b128 v[116:119], v202 offset:61440
  v_exp_f32 v190, v190
  v_mfma_f32_16x16x32_bf16 v[164:167], v[124:127], v[76:79], v[164:167]
  v_exp_f32 v191, v191
  v_cvt_pk_bf16_f32 v198, v188, v189
  v_mfma_f32_16x16x32_bf16 v[172:175], v[124:127], v[92:95], v[172:175]
  ds_read_b128 v[120:123], v203 offset:57344
  v_cvt_pk_bf16_f32 v199, v190, v191
  ds_read_b128 v[236:239], v220
  v_mfma_f32_16x16x32_bf16 v[240:243], v[248:251], v[192:195], v[240:243]
  v_mfma_f32_16x16x32_bf16 v[244:247], v[248:251], v[196:199], v[244:247]
  ds_read_b128 v[124:127], v203 offset:61440
  v_mfma_f32_16x16x32_bf16 v[0:3], v[128:131], v[192:195], v[0:3]
  v_mfma_f32_16x16x32_bf16 v[32:35], v[128:131], v[196:199], v[32:35]
  v_mfma_f32_16x16x32_bf16 v[4:7], v[132:135], v[192:195], v[4:7]
  s_waitcnt lgkmcnt(0)
  v_mov_b32 v254, 6
  v_min3_u32 v255, v236, v237, v238
  s_mov_b32 s91, 7
  s_mov_b64 exec, 1
  ds_write_b32 v221, v254
  s_mov_b64 exec, -1
  v_min_u32 v255, v255, v239
  v_cmp_gt_u32 vcc, s91, v255
  s_cbranch_vccz L_fok_10
  s_call_b64 s[50:51], L_cspin
L_fok_10:
  v_mfma_f32_16x16x32_bf16 v[36:39], v[132:135], v[196:199], v[36:39]
  ds_read_b64_tr_b16 v[128:129], v204 offset:32768
  ds_read_b64_tr_b16 v[130:131], v204 offset:36864
  v_mfma_f32_16x16x32_bf16 v[8:11], v[136:139], v[192:195], v[8:11]
  v_max3_f32 v252, v160, v161, v162
  v_mfma_f32_16x16x32_bf16 v[40:43], v[136:139], v[196:199], v[40:43]
  ds_read_b64_tr_b16 v[132:133], v205 offset:32768
  ds_read_b64_tr_b16 v[134:135], v205 offset:36864
  v_max3_f32 v253, v163, v164, v165
  v_mfma_f32_16x16x32_bf16 v[12:15], v[140:143], v[192:195], v[12:15]
  v_mfma_f32_16x16x32_bf16 v[44:47], v[140:143], v[196:199], v[44:47]
  ds_read_b64_tr_b16 v[136:137], v206 offset:32768
  ds_read_b64_tr_b16 v[138:139], v206 offset:36864
  v_max3_f32 v252, v252, v166, v167
  v_mfma_f32_16x16x32_bf16 v[16:19], v[144:147], v[192:195], v[16:19]
  v_max3_f32 v253, v253, v168, v169
  v_mfma_f32_16x16x32_bf16 v[48:51], v[144:147], v[196:199], v[48:51]
  ds_read_b64_tr_b16 v[140:141], v207 offset:32768
  ds_read_b64_tr_b16 v[142:143], v207 offset:36864
  v_mfma_f32_16x16x32_bf16 v[20:23], v[148:151], v[192:195], v[20:23]
  v_max3_f32 v252, v252, v170, v171
  v_mfma_f32_16x16x32_bf16 v[52:55], v[148:151], v[196:199], v[52:55]
  ds_read_b64_tr_b16 v[144:145], v208 offset:32768
  ds_read_b64_tr_b16 v[146:147], v208 offset:36864
  v_max3_f32 v253, v253, v172, v173
  v_mfma_f32_16x16x32_bf16 v[24:27], v[152:155], v[192:195], v[24:27]
  v_mfma_f32_16x16x32_bf16 v[56:59], v[152:155], v[196:199], v[56:59]
  ds_read_b64_tr_b16 v[148:149], v209 offset:32768
  ds_read_b64_tr_b16 v[150:151], v209 offset:36864
  v_max3_f32 v252, v252, v174, v175
  v_mfma_f32_16x16x32_bf16 v[28:31], v[156:159], v[192:195], v[28:31]
  v_max_f32 v252, v252, v253
  v_mfma_f32_16x16x32_bf16 v[60:63], v[156:159], v[196:199], v[60:63]
  ds_read_b64_tr_b16 v[152:153], v210 offset:32768
  ds_read_b64_tr_b16 v[154:155], v210 offset:36864
  v_cmp_lt_f32 vcc, s40, v252
  s_cbranch_vccz L_nr_10
  s_call_b64 s[50:51], L_rescale0
L_nr_10:
  v_mfma_f32_16x16x32_bf16 v[176:179], v[96:99], v[64:67], v[212:215]
  v_exp_f32 v160, v160
  v_exp_f32 v161, v161
  v_mfma_f32_16x16x32_bf16 v[184:187], v[96:99], v[80:83], v[216:219]
  ds_read_b64_tr_b16 v[156:157], v211 offset:32768
  ds_read_b64_tr_b16 v[158:159], v211 offset:36864
  v_exp_f32 v162, v162
  v_mfma_f32_16x16x32_bf16 v[180:183], v[100:103], v[64:67], v[212:215]
  v_exp_f32 v163, v163
  v_cvt_pk_bf16_f32 v192, v160, v161
  v_mfma_f32_16x16x32_bf16 v[188:191], v[100:103], v[80:83], v[216:219]
  ds_read_b128 v[96:99], v224 offset:8192
  v_exp_f32 v164, v164
  v_mfma_f32_16x16x32_bf16 v[176:179], v[104:107], v[68:71], v[176:179]
  v_exp_f32 v165, v165
  v_cvt_pk_bf16_f32 v193, v162, v163
  v_mfma_f32_16x16x32_bf16 v[184:187], v[104:107], v[84:87], v[184:187]
  ds_read_b128 v[100:103], v224 offset:12288
  v_exp_f32 v166, v166
  v_mfma_f32_16x16x32_bf16 v[180:183], v[108:111], v[68:71], v[180:183]
  v_exp_f32 v167, v167
  v_cvt_pk_bf16_f32 v194, v164, v165
  v_mfma_f32_16x16x32_bf16 v[188:191], v[108:111], v[84:87], v[188:191]
  ds_read_b128 v[104:107], v225 offset:8192
  v_exp_f32 v168, v168
  v_mfma_f32_16x16x32_bf16 v[176:179], v[112:115], v[72:75], v[176:179]
  v_exp_f32 v169, v169
  v_cvt_pk_bf16_f32 v195, v166, v167
  v_mfma_f32_16x16x32_bf16 v[184:187], v[112:115], v[88:91], v[184:187]
  ds_read_b128 v[108:111], v225 offset:12288
  v_exp_f32 v170, v170
  v_mfma_f32_16x16x32_bf16 v[180:183], v[116:119], v[72:75], v[180:183]
  v_exp_f32 v171, v171
  v_cvt_pk_bf16_f32 v196, v168, v169
  v_mfma_f32_16x16x32_bf16 v[188:191], v[116:119], v[88:91], v[188:191]
  ds_read_b128 v[112:115], v226 offset:8192
  v_exp_f32 v172, v172
  v_mfma_f32_16x16x32_bf16 v[176:179], v[120:123], v[76:79], v[176:179]
  v_exp_f32 v173, v173
  v_cvt_pk_bf16_f32 v197, v170, v171
  v_mfma_f32_16x16x32_bf16 v[184:187], v[120:123], v[92:95], v[184:187]
  ds_read_b128 v[116:119], v226 offset:12288
  v_exp_f32 v174, v174
  v_mfma_f32_16x16x32_bf16 v[180:183], v[124:127], v[76:79], v[180:183]
  v_exp_f32 v175, v175
  v_cvt_pk_bf16_f32 v198, v172, v173
  v_mfma_f32_16x16x32_bf16 v[188:191], v[124:127], v[92:95], v[188:191]
  ds_read_b128 v[120:123], v227 offset:8192
  v_cvt_pk_bf16_f32 v199, v174, v175
  v_mfma_f32_16x16x32_bf16 v[240:243], v[248:251], v[192:195], v[240:243]
  s_nop 0
  v_mfma_f32_16x16x32_bf16 v[244:247], v[248:251], v[196:199], v[244:247]
  ds_read_b128 v[124:127], v227 offset:12288
  s_waitcnt lgkmcnt(15)
  v_mfma_f32_16x16x32_bf16 v[0:3], v[128:131], v[192:195], v[0:3]
  v_mfma_f32_16x16x32_bf16 v[32:35], v[128:131], v[196:199], v[32:35]
  v_mfma_f32_16x16x32_bf16 v[4:7], v[132:135], v[192:195], v[4:7]
  v_mfma_f32_16x16x32_bf16 v[36:39], v[132:135], v[196:199], v[36:39]
  ds_read_b64_tr_b16 v[128:129], v204 offset:49152
  ds_read_b64_tr_b16 v[130:131], v204 offset:53248
  v_mfma_f32_16x16x32_bf16 v[8:11], v[136:139], v[192:195], v[8:11]
  v_max3_f32 v252, v176, v177, v178
  v_mfma_f32_16x16x32_bf16 v[40:43], v[136:139], v[196:199], v[40:43]
  ds_read_b64_tr_b16 v[132:133], v205 offset:49152
  ds_read_b64_tr_b16 v[134:135], v205 offset:53248
  v_max3_f32 v253, v179, v180, v181
  v_mfma_f32_16x16x32_bf16 v[12:15], v[140:143], v[192:195], v[12:15]
  v_mfma_f32_16x16x32_bf16 v[44:47], v[140:143], v[196:199], v[44:47]
  ds_read_b64_tr_b16 v[136:137], v206 offset:49152
  ds_read_b64_tr_b16 v[138:139], v206 offset:53248
  v_max3_f32 v252, v252, v182, v183
  s_waitcnt lgkmcnt(15)
  v_mfma_f32_16x16x32_bf16 v[16:19], v[144:147], v[192:195], v[16:19]
  v_max3_f32 v253, v253, v184, v185
  v_mfma_f32_16x16x32_bf16 v[48:51], v[144:147], v[196:199], v[48:51]
  ds_read_b64_tr_b16 v[140:141], v207 offset:49152
  ds_read_b64_tr_b16 v[142:143], v207 offset:53248
  v_mfma_f32_16x16x32_bf16 v[20:23], v[148:151], v[192:195], v[20:23]
  v_max3_f32 v252, v252, v186, v187
  v_mfma_f32_16x16x32_bf16 v[52:55], v[148:151], v[196:199], v[52:55]
  ds_read_b64_tr_b16 v[144:145], v208 offset:49152
  ds_read_b64_tr_b16 v[146:147], v208 offset:53248
  v_max3_f32 v253, v253, v188, v189
  v_mfma_f32_16x16x32_bf16 v[24:27], v[152:155], v[192:195], v[24:27]
  v_mfma_f32_16x16x32_bf16 v[56:59], v[152:155], v[196:199], v[56:59]
  ds_read_b64_tr_b16 v[148:149], v209 offset:49152
  ds_read_b64_tr_b16 v[150:151], v209 offset:53248
  v_max3_f32 v252, v252, v190, v191
  s_waitcnt lgkmcnt(15)
  v_mfma_f32_16x16x32_bf16 v[28:31], v[156:159], v[192:195], v[28:31]
  v_max_f32 v252, v252, v253
  v_mfma_f32_16x16x32_bf16 v[60:63], v[156:159], v[196:199], v[60:63]
  ds_read_b64_tr_b16 v[152:153], v210 offset:49152
  ds_read_b64_tr_b16 v[154:155], v210 offset:53248
  v_cmp_lt_f32 vcc, s40, v252
  s_cbranch_vccz L_nr_11
  s_call_b64 s[50:51], L_rescale1
L_nr_11:
  v_mfma_f32_16x16x32_bf16 v[160:163], v[96:99], v[64:67], v[212:215]
  v_exp_f32 v176, v176
  v_exp_f32 v177, v177
  v_mfma_f32_16x16x32_bf16 v[168:171], v[96:99], v[80:83], v[216:219]
  ds_read_b64_tr_b16 v[156:157], v211 offset:49152
  ds_read_b64_tr_b16 v[158:159], v211 offset:53248
  v_exp_f32 v178, v178
  v_mfma_f32_16x16x32_bf16 v[164:167], v[100:103], v[64:67], v[212:215]
  v_exp_f32 v179, v179
  v_cvt_pk_bf16_f32 v192, v176, v177
  v_mfma_f32_16x16x32_bf16 v[172:175], v[100:103], v[80:83], v[216:219]
  ds_read_b128 v[96:99], v224 offset:24576
  v_exp_f32 v180, v180
  v_mfma_f32_16x16x32_bf16 v[160:163], v[104:107], v[68:71], v[160:163]
  v_exp_f32 v181, v181
  v_cvt_pk_bf16_f32 v193, v178, v179
  v_mfma_f32_16x16x32_bf16 v[168:171], v[104:107], v[84:87], v[168:171]
  ds_read_b128 v[100:103], v224 offset:28672
  v_exp_f32 v182, v182
  v_mfma_f32_16x16x32_bf16 v[164:167], v[108:111], v[68:71], v[164:167]
  v_exp_f32 v183, v183
  v_cvt_pk_bf16_f32 v194, v180, v181
  v_mfma_f32_16x16x32_bf16 v[172:175], v[108:111], v[84:87], v[172:175]
  ds_read_b128 v[104:107], v225 offset:24576
  v_exp_f32 v184, v184
  v_mfma_f32_16x16x32_bf16 v[160:163], v[112:115], v[72:75], v[160:163]
  v_exp_f32 v185, v185
  v_cvt_pk_bf16_f32 v195, v182, v183
  v_mfma_f32_16x16x32_bf16 v[168:171], v[112:115], v[88:91], v[168:171]
  ds_read_b128 v[108:111], v225 offset:28672
  v_exp_f32 v186, v186
  s_waitcnt lgkmcnt(15)
  v_mfma_f32_16x16x32_bf16 v[164:167], v[116:119], v[72:75], v[164:167]
  v_exp_f32 v187, v187
  v_cvt_pk_bf16_f32 v196, v184, v185
  v_mfma_f32_16x16x32_bf16 v[172:175], v[116:119], v[88:91], v[172:175]
  ds_read_b128 v[112:115], v226 offset:24576
  v_exp_f32 v188, v188
  v_mfma_f32_16x16x32_bf16 v[160:163], v[120:123], v[76:79], v[160:163]
  v_exp_f32 v189, v189
  v_cvt_pk_bf16_f32 v197, v186, v187
  v_mfma_f32_16x16x32_bf16 v[168:171], v[120:123], v[92:95], v[168:171]
  ds_read_b128 v[116:119], v226 offset:28672
  v_exp_f32 v190, v190
  v_mfma_f32_16x16x32_bf16 v[164:167], v[124:127], v[76:79], v[164:167]
  v_exp_f32 v191, v191
  v_cvt_pk_bf16_f32 v198, v188, v189
  v_mfma_f32_16x16x32_bf16 v[172:175], v[124:127], v[92:95], v[172:175]
  ds_read_b128 v[120:123], v227 offset:24576
  v_cvt_pk_bf16_f32 v199, v190, v191
  ds_read_b128 v[236:239], v220
  v_mfma_f32_16x16x32_bf16 v[240:243], v[248:251], v[192:195], v[240:243]
  v_mfma_f32_16x16x32_bf16 v[244:247], v[248:251], v[196:199], v[244:247]
  ds_read_b128 v[124:127], v227 offset:28672
  v_mfma_f32_16x16x32_bf16 v[0:3], v[128:131], v[192:195], v[0:3]
  v_mfma_f32_16x16x32_bf16 v[32:35], v[128:131], v[196:199], v[32:35]
  v_mfma_f32_16x16x32_bf16 v[4:7], v[132:135], v[192:195], v[4:7]
  s_waitcnt lgkmcnt(0)
  v_mov_b32 v254, 7
  v_min3_u32 v255, v236, v237, v238
  s_mov_b32 s91, 8
  s_mov_b64 exec, 1
  ds_write_b32 v221, v254
  s_mov_b64 exec, -1
  v_min_u32 v255, v255, v239
  v_cmp_gt_u32 vcc, s91, v255
  s_cbranch_vccz L_fok_12
  s_call_b64 s[50:51], L_cspin
L_fok_12:
  v_mfma_f32_16x16x32_bf16 v[36:39], v[132:135], v[196:199], v[36:39]
  ds_read_b64_tr_b16 v[128:129], v228 offset:0
  ds_read_b64_tr_b16 v[130:131], v228 offset:4096
  v_mfma_f32_16x16x32_bf16 v[8:11], v[136:139], v[192:195], v[8:11]
  v_max3_f32 v252, v160, v161, v162
  v_mfma_f32_16x16x32_bf16 v[40:43], v[136:139], v[196:199], v[40:43]
  ds_read_b64_tr_b16 v[132:133], v229 offset:0
  ds_read_b64_tr_b16 v[134:135], v229 offset:4096
  v_max3_f32 v253, v163, v164, v165
  v_mfma_f32_16x16x32_bf16 v[12:15], v[140:143], v[192:195], v[12:15]
  v_mfma_f32_16x16x32_bf16 v[44:47], v[140:143], v[196:199], v[44:47]
  ds_read_b64_tr_b16 v[136:137], v230 offset:0
  ds_read_b64_tr_b16 v[138:139], v230 offset:4096
  v_max3_f32 v252, v252, v166, v167
  v_mfma_f32_16x16x32_bf16 v[16:19], v[144:147], v[192:195], v[16:19]
  v_max3_f32 v253, v253, v168, v169
  v_mfma_f32_16x16x32_bf16 v[48:51], v[144:147], v[196:199], v[48:51]
  ds_read_b64_tr_b16 v[140:141], v231 offset:0
  ds_read_b64_tr_b16 v[142:143], v231 offset:4096
  v_mfma_f32_16x16x32_bf16 v[20:23], v[148:151], v[192:195], v[20:23]
  v_max3_f32 v252, v252, v170, v171
  v_mfma_f32_16x16x32_bf16 v[52:55], v[148:151], v[196:199], v[52:55]
  ds_read_b64_tr_b16 v[144:145], v232 offset:0
  ds_read_b64_tr_b16 v[146:147], v232 offset:4096
  v_max3_f32 v253, v253, v172, v173
  v_mfma_f32_16x16x32_bf16 v[24:27], v[152:155], v[192:195], v[24:27]
  v_mfma_f32_16x16x32_bf16 v[56:59], v[152:155], v[196:199], v[56:59]
  ds_read_b64_tr_b16 v[148:149], v233 offset:0
  ds_read_b64_tr_b16 v[150:151], v233 offset:4096
  v_max3_f32 v252, v252, v174, v175
  v_mfma_f32_16x16x32_bf16 v[28:31], v[156:159], v[192:195], v[28:31]
  v_max_f32 v252, v252, v253
  v_mfma_f32_16x16x32_bf16 v[60:63], v[156:159], v[196:199], v[60:63]
  ds_read_b64_tr_b16 v[152:153], v234 offset:0
  ds_read_b64_tr_b16 v[154:155], v234 offset:4096
  v_cmp_lt_f32 vcc, s40, v252
  s_cbranch_vccz L_nr_12
  s_call_b64 s[50:51], L_rescale0
L_nr_12:
  v_mfma_f32_16x16x32_bf16 v[176:179], v[96:99], v[64:67], v[212:215]
  v_exp_f32 v160, v160
  v_exp_f32 v161, v161
  v_mfma_f32_16x16x32_bf16 v[184:187], v[96:99], v[80:83], v[216:219]
  ds_read_b64_tr_b16 v[156:157], v235 offset:0
  ds_read_b64_tr_b16 v[158:159], v235 offset:4096
  v_exp_f32 v162, v162
  v_mfma_f32_16x16x32_bf16 v[180:183], v[100:103], v[64:67], v[212:215]
  v_exp_f32 v163, v163
  v_cvt_pk_bf16_f32 v192, v160, v161
  v_mfma_f32_16x16x32_bf16 v[188:191], v[100:103], v[80:83], v[216:219]
  ds_read_b128 v[96:99], v224 offset:40960
  v_exp_f32 v164, v164
  v_mfma_f32_16x16x32_bf16 v[176:179], v[104:107], v[68:71], v[176:179]
  v_exp_f32 v165, v165
  v_cvt_pk_bf16_f32 v193, v162, v163
  v_mfma_f32_16x16x32_bf16 v[184:187], v[104:107], v[84:87], v[184:187]
  ds_read_b128 v[100:103], v224 offset:45056
  v_exp_f32 v166, v166
  v_mfma_f32_16x16x32_bf16 v[180:183], v[108:111], v[68:71], v[180:183]
  v_exp_f32 v167, v167
  v_cvt_pk_bf16_f32 v194, v164, v165
  v_mfma_f32_16x16x32_bf16 v[188:191], v[108:111], v[84:87], v[188:191]
  ds_read_b128 v[104:107], v225 offset:40960
  v_exp_f32 v168, v168
  v_mfma_f32_16x16x32_bf16 v[176:179], v[112:115], v[72:75], v[176:179]
  v_exp_f32 v169, v169
  v_cvt_pk_bf16_f32 v195, v166, v167
  v_mfma_f32_16x16x32_bf16 v[184:187], v[112:115], v[88:91], v[184:187]
  ds_read_b128 v[108:111], v225 offset:45056
  v_exp_f32 v170, v170
  v_mfma_f32_16x16x32_bf16 v[180:183], v[116:119], v[72:75], v[180:183]
  v_exp_f32 v171, v171
  v_cvt_pk_bf16_f32 v196, v168, v169
  v_mfma_f32_16x16x32_bf16 v[188:191], v[116:119], v[88:91], v[188:191]
  ds_read_b128 v[112:115], v226 offset:40960
  v_exp_f32 v172, v172
  v_mfma_f32_16x16x32_bf16 v[176:179], v[120:123], v[76:79], v[176:179]
  v_exp_f32 v173, v173
  v_cvt_pk_bf16_f32 v197, v170, v171
  v_mfma_f32_16x16x32_bf16 v[184:187], v[120:123], v[92:95], v[184:187]
  ds_read_b128 v[116:119], v226 offset:45056
  v_exp_f32 v174, v174
  v_mfma_f32_16x16x32_bf16 v[180:183], v[124:127], v[76:79], v[180:183]
  v_exp_f32 v175, v175
  v_cvt_pk_bf16_f32 v198, v172, v173
  v_mfma_f32_16x16x32_bf16 v[188:191], v[124:127], v[92:95], v[188:191]
  ds_read_b128 v[120:123], v227 offset:40960
  v_cvt_pk_bf16_f32 v199, v174, v175
  v_mfma_f32_16x16x32_bf16 v[240:243], v[248:251], v[192:195], v[240:243]
  s_nop 0
  v_mfma_f32_16x16x32_bf16 v[244:247], v[248:251], v[196:199], v[244:247]
  ds_read_b128 v[124:127], v227 offset:45056
  s_waitcnt lgkmcnt(15)
  v_mfma_f32_16x16x32_bf16 v[0:3], v[128:131], v[192:195], v[0:3]
  v_mfma_f32_16x16x32_bf16 v[32:35], v[128:131], v[196:199], v[32:35]
  v_mfma_f32_16x16x32_bf16 v[4:7], v[132:135], v[192:195], v[4:7]
  v_mfma_f32_16x16x32_bf16 v[36:39], v[132:135], v[196:199], v[36:39]
  ds_read_b64_tr_b16 v[128:129], v228 offset:16384
  ds_read_b64_tr_b16 v[130:131], v228 offset:20480
  v_mfma_f32_16x16x32_bf16 v[8:11], v[136:139], v[192:195], v[8:11]
  v_max3_f32 v252, v176, v177, v178
  v_mfma_f32_16x16x32_bf16 v[40:43], v[136:139], v[196:199], v[40:43]
  ds_read_b64_tr_b16 v[132:133], v229 offset:16384
  ds_read_b64_tr_b16 v[134:135], v229 offset:20480
  v_max3_f32 v253, v179, v180, v181
  v_mfma_f32_16x16x32_bf16 v[12:15], v[140:143], v[192:195], v[12:15]
  v_mfma_f32_16x16x32_bf16 v[44:47], v[140:143], v[196:199], v[44:47]
  ds_read_b64_tr_b16 v[136:137], v230 offset:16384
  ds_read_b64_tr_b16 v[138:139], v230 offset:20480
  v_max3_f32 v252, v252, v182, v183
  s_waitcnt lgkmcnt(15)
  v_mfma_f32_16x16x32_bf16 v[16:19], v[144:147], v[192:195], v[16:19]
  v_max3_f32 v253, v253, v184, v185
  v_mfma_f32_16x16x32_bf16 v[48:51], v[144:147], v[196:199], v[48:51]
  ds_read_b64_tr_b16 v[140:141], v231 offset:16384
  ds_read_b64_tr_b16 v[142:143], v231 offset:20480
  v_mfma_f32_16x16x32_bf16 v[20:23], v[148:151], v[192:195], v[20:23]
  v_max3_f32 v252, v252, v186, v187
  v_mfma_f32_16x16x32_bf16 v[52:55], v[148:151], v[196:199], v[52:55]
  ds_read_b64_tr_b16 v[144:145], v232 offset:16384
  ds_read_b64_tr_b16 v[146:147], v232 offset:20480
  v_max3_f32 v253, v253, v188, v189
  v_mfma_f32_16x16x32_bf16 v[24:27], v[152:155], v[192:195], v[24:27]
  v_mfma_f32_16x16x32_bf16 v[56:59], v[152:155], v[196:199], v[56:59]
  ds_read_b64_tr_b16 v[148:149], v233 offset:16384
  ds_read_b64_tr_b16 v[150:151], v233 offset:20480
  v_max3_f32 v252, v252, v190, v191
  s_waitcnt lgkmcnt(15)
  v_mfma_f32_16x16x32_bf16 v[28:31], v[156:159], v[192:195], v[28:31]
  v_max_f32 v252, v252, v253
  v_mfma_f32_16x16x32_bf16 v[60:63], v[156:159], v[196:199], v[60:63]
  ds_read_b64_tr_b16 v[152:153], v234 offset:16384
  ds_read_b64_tr_b16 v[154:155], v234 offset:20480
  v_cmp_lt_f32 vcc, s40, v252
  s_cbranch_vccz L_nr_13
  s_call_b64 s[50:51], L_rescale1
L_nr_13:
  v_mfma_f32_16x16x32_bf16 v[160:163], v[96:99], v[64:67], v[212:215]
  v_exp_f32 v176, v176
  v_exp_f32 v177, v177
  v_mfma_f32_16x16x32_bf16 v[168:171], v[96:99], v[80:83], v[216:219]
  ds_read_b64_tr_b16 v[156:157], v235 offset:16384
  ds_read_b64_tr_b16 v[158:159], v235 offset:20480
  v_exp_f32 v178, v178
  v_mfma_f32_16x16x32_bf16 v[164:167], v[100:103], v[64:67], v[212:215]
  v_exp_f32 v179, v179
  v_cvt_pk_bf16_f32 v192, v176, v177
  v_mfma_f32_16x16x32_bf16 v[172:175], v[100:103], v[80:83], v[216:219]
  ds_read_b128 v[96:99], v224 offset:57344
  v_exp_f32 v180, v180
  v_mfma_f32_16x16x32_bf16 v[160:163], v[104:107], v[68:71], v[160:163]
  v_exp_f32 v181, v181
  v_cvt_pk_bf16_f32 v193, v178, v179
  v_mfma_f32_16x16x32_bf16 v[168:171], v[104:107], v[84:87], v[168:171]
  ds_read_b128 v[100:103], v224 offset:61440
  v_exp_f32 v182, v182
  v_mfma_f32_16x16x32_bf16 v[164:167], v[108:111], v[68:71], v[164:167]
  v_exp_f32 v183, v183
  v_cvt_pk_bf16_f32 v194, v180, v181
  v_mfma_f32_16x16x32_bf16 v[172:175], v[108:111], v[84:87], v[172:175]
  ds_read_b128 v[104:107], v225 offset:57344
  v_exp_f32 v184, v184
  v_mfma_f32_16x16x32_bf16 v[160:163], v[112:115], v[72:75], v[160:163]
  v_exp_f32 v185, v185
  v_cvt_pk_bf16_f32 v195, v182, v183
  v_mfma_f32_16x16x32_bf16 v[168:171], v[112:115], v[88:91], v[168:171]
  ds_read_b128 v[108:111], v225 offset:61440
  v_exp_f32 v186, v186
  s_waitcnt lgkmcnt(15)
  v_mfma_f32_16x16x32_bf16 v[164:167], v[116:119], v[72:75], v[164:167]
  v_exp_f32 v187, v187
  v_cvt_pk_bf16_f32 v196, v184, v185
  v_mfma_f32_16x16x32_bf16 v[172:175], v[116:119], v[88:91], v[172:175]
  ds_read_b128 v[112:115], v226 offset:57344
  v_exp_f32 v188, v188
  v_mfma_f32_16x16x32_bf16 v[160:163], v[120:123], v[76:79], v[160:163]
  v_exp_f32 v189, v189
  v_cvt_pk_bf16_f32 v197, v186, v187
  v_mfma_f32_16x16x32_bf16 v[168:171], v[120:123], v[92:95], v[168:171]
  ds_read_b128 v[116:119], v226 offset:61440
  v_exp_f32 v190, v190
  v_mfma_f32_16x16x32_bf16 v[164:167], v[124:127], v[76:79], v[164:167]
  v_exp_f32 v191, v191
  v_cvt_pk_bf16_f32 v198, v188, v189
  v_mfma_f32_16x16x32_bf16 v[172:175], v[124:127], v[92:95], v[172:175]
  ds_read_b128 v[120:123], v227 offset:57344
  v_cvt_pk_bf16_f32 v199, v190, v191
  ds_read_b128 v[236:239], v220
  v_mfma_f32_16x16x32_bf16 v[240:243], v[248:251], v[192:195], v[240:243]
  v_mfma_f32_16x16x32_bf16 v[244:247], v[248:251], v[196:199], v[244:247]
  ds_read_b128 v[124:127], v227 offset:61440
  v_mfma_f32_16x16x32_bf16 v[0:3], v[128:131], v[192:195], v[0:3]
  v_mfma_f32_16x16x32_bf16 v[32:35], v[128:131], v[196:199], v[32:35]
  v_mfma_f32_16x16x32_bf16 v[4:7], v[132:135], v[192:195], v[4:7]
  s_waitcnt lgkmcnt(0)
  v_mov_b32 v254, 8
  v_min3_u32 v255, v236, v237, v238
  s_mov_b32 s91, 9
  s_mov_b64 exec, 1
  ds_write_b32 v221, v254
  s_mov_b64 exec, -1
  v_min_u32 v255, v255, v239
  v_cmp_gt_u32 vcc, s91, v255
  s_cbranch_vccz L_fok_14
  s_call_b64 s[50:51], L_cspin
L_fok_14:
  v_mfma_f32_16x16x32_bf16 v[36:39], v[132:135], v[196:199], v[36:39]
  ds_read_b64_tr_b16 v[128:129], v228 offset:32768
  ds_read_b64_tr_b16 v[130:131], v228 offset:36864
  v_mfma_f32_16x16x32_bf16 v[8:11], v[136:139], v[192:195], v[8:11]
  v_max3_f32 v252, v160, v161, v162
  v_mfma_f32_16x16x32_bf16 v[40:43], v[136:139], v[196:199], v[40:43]
  ds_read_b64_tr_b16 v[132:133], v229 offset:32768
  ds_read_b64_tr_b16 v[134:135], v229 offset:36864
  v_max3_f32 v253, v163, v164, v165
  v_mfma_f32_16x16x32_bf16 v[12:15], v[140:143], v[192:195], v[12:15]
  v_mfma_f32_16x16x32_bf16 v[44:47], v[140:143], v[196:199], v[44:47]
  ds_read_b64_tr_b16 v[136:137], v230 offset:32768
  ds_read_b64_tr_b16 v[138:139], v230 offset:36864
  v_max3_f32 v252, v252, v166, v167
  v_mfma_f32_16x16x32_bf16 v[16:19], v[144:147], v[192:195], v[16:19]
  v_max3_f32 v253, v253, v168, v169
  v_mfma_f32_16x16x32_bf16 v[48:51], v[144:147], v[196:199], v[48:51]
  ds_read_b64_tr_b16 v[140:141], v231 offset:32768
  ds_read_b64_tr_b16 v[142:143], v231 offset:36864
  v_mfma_f32_16x16x32_bf16 v[20:23], v[148:151], v[192:195], v[20:23]
  v_max3_f32 v252, v252, v170, v171
  v_mfma_f32_16x16x32_bf16 v[52:55], v[148:151], v[196:199], v[52:55]
  ds_read_b64_tr_b16 v[144:145], v232 offset:32768
  ds_read_b64_tr_b16 v[146:147], v232 offset:36864
  v_max3_f32 v253, v253, v172, v173
  v_mfma_f32_16x16x32_bf16 v[24:27], v[152:155], v[192:195], v[24:27]
  v_mfma_f32_16x16x32_bf16 v[56:59], v[152:155], v[196:199], v[56:59]
  ds_read_b64_tr_b16 v[148:149], v233 offset:32768
  ds_read_b64_tr_b16 v[150:151], v233 offset:36864
  v_max3_f32 v252, v252, v174, v175
  v_mfma_f32_16x16x32_bf16 v[28:31], v[156:159], v[192:195], v[28:31]
  v_max_f32 v252, v252, v253
  v_mfma_f32_16x16x32_bf16 v[60:63], v[156:159], v[196:199], v[60:63]
  ds_read_b64_tr_b16 v[152:153], v234 offset:32768
  ds_read_b64_tr_b16 v[154:155], v234 offset:36864
  v_cmp_lt_f32 vcc, s40, v252
  s_cbranch_vccz L_nr_14
  s_call_b64 s[50:51], L_rescale0
L_nr_14:
  v_mfma_f32_16x16x32_bf16 v[176:179], v[96:99], v[64:67], v[212:215]
  v_exp_f32 v160, v160
  v_exp_f32 v161, v161
  v_mfma_f32_16x16x32_bf16 v[184:187], v[96:99], v[80:83], v[216:219]
  ds_read_b64_tr_b16 v[156:157], v235 offset:32768
  ds_read_b64_tr_b16 v[158:159], v235 offset:36864
  v_exp_f32 v162, v162
  v_mfma_f32_16x16x32_bf16 v[180:183], v[100:103], v[64:67], v[212:215]
  v_exp_f32 v163, v163
  v_cvt_pk_bf16_f32 v192, v160, v161
  v_mfma_f32_16x16x32_bf16 v[188:191], v[100:103], v[80:83], v[216:219]
  ds_read_b128 v[96:99], v200 offset:8192
  v_exp_f32 v164, v164
  v_mfma_f32_16x16x32_bf16 v[176:179], v[104:107], v[68:71], v[176:179]
  v_exp_f32 v165, v165
  v_cvt_pk_bf16_f32 v193, v162, v163
  v_mfma_f32_16x16x32_bf16 v[184:187], v[104:107], v[84:87], v[184:187]
  ds_read_b128 v[100:103], v200 offset:12288
  v_exp_f32 v166, v166
  v_mfma_f32_16x16x32_bf16 v[180:183], v[108:111], v[68:71], v[180:183]
  v_exp_f32 v167, v167
  v_cvt_pk_bf16_f32 v194, v164, v165
  v_mfma_f32_16x16x32_bf16 v[188:191], v[108:111], v[84:87], v[188:191]
  ds_read_b128 v[104:107], v201 offset:8192
  v_exp_f32 v168, v168
  v_mfma_f32_16x16x32_bf16 v[176:179], v[112:115], v[72:75], v[176:179]
  v_exp_f32 v169, v169
  v_cvt_pk_bf16_f32 v195, v166, v167
  v_mfma_f32_16x16x32_bf16 v[184:187], v[112:115], v[88:91], v[184:187]
  ds_read_b128 v[108:111], v201 offset:12288
  v_exp_f32 v170, v170
  v_mfma_f32_16x16x32_bf16 v[180:183], v[116:119], v[72:75], v[180:183]
  v_exp_f32 v171, v171
  v_cvt_pk_bf16_f32 v196, v168, v169
  v_mfma_f32_16x16x32_bf16 v[188:191], v[116:119], v[88:91], v[188:191]
  ds_read_b128 v[112:115], v202 offset:8192
  v_exp_f32 v172, v172
  v_mfma_f32_16x16x32_bf16 v[176:179], v[120:123], v[76:79], v[176:179]
  v_exp_f32 v173, v173
  v_cvt_pk_bf16_f32 v197, v170, v171
  v_mfma_f32_16x16x32_bf16 v[184:187], v[120:123], v[92:95], v[184:187]
  ds_read_b128 v[116:119], v202 offset:12288
  v_exp_f32 v174, v174
  v_mfma_f32_16x16x32_bf16 v[180:183], v[124:127], v[76:79], v[180:183]
  v_exp_f32 v175, v175
  v_cvt_pk_bf16_f32 v198, v172, v173
  v_mfma_f32_16x16x32_bf16 v[188:191], v[124:127], v[92:95], v[188:191]
  ds_read_b128 v[120:123], v203 offset:8192
  v_cvt_pk_bf16_f32 v199, v174, v175
  v_mfma_f32_16x16x32_bf16 v[240:243], v[248:251], v[192:195], v[240:243]
  s_nop 0
  v_mfma_f32_16x16x32_bf16 v[244:247], v[248:251], v[196:199], v[244:247]
  ds_read_b128 v[124:127], v203 offset:12288
  s_waitcnt lgkmcnt(15)
  v_mfma_f32_16x16x32_bf16 v[0:3], v[128:131], v[192:195], v[0:3]
  v_mfma_f32_16x16x32_bf16 v[32:35], v[128:131], v[196:199], v[32:35]
  v_mfma_f32_16x16x32_bf16 v[4:7], v[132:135], v[192:195], v[4:7]
  v_mfma_f32_16x16x32_bf16 v[36:39], v[132:135], v[196:199], v[36:39]
  ds_read_b64_tr_b16 v[128:129], v228 offset:49152
  ds_read_b64_tr_b16 v[130:131], v228 offset:53248
  v_mfma_f32_16x16x32_bf16 v[8:11], v[136:139], v[192:195], v[8:11]
  v_max3_f32 v252, v176, v177, v178
  v_mfma_f32_16x16x32_bf16 v[40:43], v[136:139], v[196:199], v[40:43]
  ds_read_b64_tr_b16 v[132:133], v229 offset:49152
  ds_read_b64_tr_b16 v[134:135], v229 offset:53248
  v_max3_f32 v253, v179, v180, v181
  v_mfma_f32_16x16x32_bf16 v[12:15], v[140:143], v[192:195], v[12:15]
  v_mfma_f32_16x16x32_bf16 v[44:47], v[140:143], v[196:199], v[44:47]
  ds_read_b64_tr_b16 v[136:137], v230 offset:49152
  ds_read_b64_tr_b16 v[138:139], v230 offset:53248
  v_max3_f32 v252, v252, v182, v183
  s_waitcnt lgkmcnt(15)
  v_mfma_f32_16x16x32_bf16 v[16:19], v[144:147], v[192:195], v[16:19]
  v_max3_f32 v253, v253, v184, v185
  v_mfma_f32_16x16x32_bf16 v[48:51], v[144:147], v[196:199], v[48:51]
  ds_read_b64_tr_b16 v[140:141], v231 offset:49152
  ds_read_b64_tr_b16 v[142:143], v231 offset:53248
  v_mfma_f32_16x16x32_bf16 v[20:23], v[148:151], v[192:195], v[20:23]
  v_max3_f32 v252, v252, v186, v187
  v_mfma_f32_16x16x32_bf16 v[52:55], v[148:151], v[196:199], v[52:55]
  ds_read_b64_tr_b16 v[144:145], v232 offset:49152
  ds_read_b64_tr_b16 v[146:147], v232 offset:53248
  v_max3_f32 v253, v253, v188, v189
  v_mfma_f32_16x16x32_bf16 v[24:27], v[152:155], v[192:195], v[24:27]
  v_mfma_f32_16x16x32_bf16 v[56:59], v[152:155], v[196:199], v[56:59]
  ds_read_b64_tr_b16 v[148:149], v233 offset:49152
  ds_read_b64_tr_b16 v[150:151], v233 offset:53248
  v_max3_f32 v252, v252, v190, v191
  s_waitcnt lgkmcnt(15)
  v_mfma_f32_16x16x32_bf16 v[28:31], v[156:159], v[192:195], v[28:31]
  v_max_f32 v252, v252, v253
  v_mfma_f32_16x16x32_bf16 v[60:63], v[156:159], v[196:199], v[60:63]
  ds_read_b64_tr_b16 v[152:153], v234 offset:49152
  ds_read_b64_tr_b16 v[154:155], v234 offset:53248
  v_cmp_lt_f32 vcc, s40, v252
  s_cbranch_vccz L_nr_15
  s_call_b64 s[50:51], L_rescale1
L_nr_15:
  v_mfma_f32_16x16x32_bf16 v[160:163], v[96:99], v[64:67], v[212:215]
  v_exp_f32 v176, v176
  v_exp_f32 v177, v177
  v_mfma_f32_16x16x32_bf16 v[168:171], v[96:99], v[80:83], v[216:219]
  ds_read_b64_tr_b16 v[156:157], v235 offset:49152
  ds_read_b64_tr_b16 v[158:159], v235 offset:53248
  v_exp_f32 v178, v178
  v_mfma_f32_16x16x32_bf16 v[164:167], v[100:103], v[64:67], v[212:215]
  v_exp_f32 v179, v179
  v_cvt_pk_bf16_f32 v192, v176, v177
  v_mfma_f32_16x16x32_bf16 v[172:175], v[100:103], v[80:83], v[216:219]
  ds_read_b128 v[96:99], v200 offset:24576
  v_exp_f32 v180, v180
  v_mfma_f32_16x16x32_bf16 v[160:163], v[104:107], v[68:71], v[160:163]
  v_exp_f32 v181, v181
  v_cvt_pk_bf16_f32 v193, v178, v179
  v_mfma_f32_16x16x32_bf16 v[168:171], v[104:107], v[84:87], v[168:171]
  ds_read_b128 v[100:103], v200 offset:28672
  v_exp_f32 v182, v182
  v_mfma_f32_16x16x32_bf16 v[164:167], v[108:111], v[68:71], v[164:167]
  v_exp_f32 v183, v183
  v_cvt_pk_bf16_f32 v194, v180, v181
  v_mfma_f32_16x16x32_bf16 v[172:175], v[108:111], v[84:87], v[172:175]
  ds_read_b128 v[104:107], v201 offset:24576
  v_exp_f32 v184, v184
  v_mfma_f32_16x16x32_bf16 v[160:163], v[112:115], v[72:75], v[160:163]
  v_exp_f32 v185, v185
  v_cvt_pk_bf16_f32 v195, v182, v183
  v_mfma_f32_16x16x32_bf16 v[168:171], v[112:115], v[88:91], v[168:171]
  ds_read_b128 v[108:111], v201 offset:28672
  v_exp_f32 v186, v186
  s_waitcnt lgkmcnt(15)
  v_mfma_f32_16x16x32_bf16 v[164:167], v[116:119], v[72:75], v[164:167]
  v_exp_f32 v187, v187
  v_cvt_pk_bf16_f32 v196, v184, v185
  v_mfma_f32_16x16x32_bf16 v[172:175], v[116:119], v[88:91], v[172:175]
  ds_read_b128 v[112:115], v202 offset:24576
  v_exp_f32 v188, v188
  v_mfma_f32_16x16x32_bf16 v[160:163], v[120:123], v[76:79], v[160:163]
  v_exp_f32 v189, v189
  v_cvt_pk_bf16_f32 v197, v186, v187
  v_mfma_f32_16x16x32_bf16 v[168:171], v[120:123], v[92:95], v[168:171]
  ds_read_b128 v[116:119], v202 offset:28672
  v_exp_f32 v190, v190
  v_mfma_f32_16x16x32_bf16 v[164:167], v[124:127], v[76:79], v[164:167]
  v_exp_f32 v191, v191
  v_cvt_pk_bf16_f32 v198, v188, v189
  v_mfma_f32_16x16x32_bf16 v[172:175], v[124:127], v[92:95], v[172:175]
  ds_read_b128 v[120:123], v203 offset:24576
  v_cvt_pk_bf16_f32 v199, v190, v191
  ds_read_b128 v[236:239], v220
  v_mfma_f32_16x16x32_bf16 v[240:243], v[248:251], v[192:195], v[240:243]
  v_mfma_f32_16x16x32_bf16 v[244:247], v[248:251], v[196:199], v[244:247]
  ds_read_b128 v[124:127], v203 offset:28672
  v_mfma_f32_16x16x32_bf16 v[0:3], v[128:131], v[192:195], v[0:3]
  v_mfma_f32_16x16x32_bf16 v[32:35], v[128:131], v[196:199], v[32:35]
  v_mfma_f32_16x16x32_bf16 v[4:7], v[132:135], v[192:195], v[4:7]
  s_waitcnt lgkmcnt(0)
  v_mov_b32 v254, 9
  v_min3_u32 v255, v236, v237, v238
  s_mov_b32 s91, 10
  s_mov_b64 exec, 1
  ds_write_b32 v221, v254
  s_mov_b64 exec, -1
  v_min_u32 v255, v255, v239
  v_cmp_gt_u32 vcc, s91, v255
  s_cbranch_vccz L_fok_16
  s_call_b64 s[50:51], L_cspin
L_fok_16:
  v_mfma_f32_16x16x32_bf16 v[36:39], v[132:135], v[196:199], v[36:39]
  ds_read_b64_tr_b16 v[128:129], v204 offset:0
  ds_read_b64_tr_b16 v[130:131], v204 offset:4096
  v_mfma_f32_16x16x32_bf16 v[8:11], v[136:139], v[192:195], v[8:11]
  v_max3_f32 v252, v160, v161, v162
  v_mfma_f32_16x16x32_bf16 v[40:43], v[136:139], v[196:199], v[40:43]
  ds_read_b64_tr_b16 v[132:133], v205 offset:0
  ds_read_b64_tr_b16 v[134:135], v205 offset:4096
  v_max3_f32 v253, v163, v164, v165
  v_mfma_f32_16x16x32_bf16 v[12:15], v[140:143], v[192:195], v[12:15]
  v_mfma_f32_16x16x32_bf16 v[44:47], v[140:143], v[196:199], v[44:47]
  ds_read_b64_tr_b16 v[136:137], v206 offset:0
  ds_read_b64_tr_b16 v[138:139], v206 offset:4096
  v_max3_f32 v252, v252, v166, v167
  v_mfma_f32_16x16x32_bf16 v[16:19], v[144:147], v[192:195], v[16:19]
  v_max3_f32 v253, v253, v168, v169
  v_mfma_f32_16x16x32_bf16 v[48:51], v[144:147], v[196:199], v[48:51]
  ds_read_b64_tr_b16 v[140:141], v207 offset:0
  ds_read_b64_tr_b16 v[142:143], v207 offset:4096
  v_mfma_f32_16x16x32_bf16 v[20:23], v[148:151], v[192:195], v[20:23]
  v_max3_f32 v252, v252, v170, v171
  v_mfma_f32_16x16x32_bf16 v[52:55], v[148:151], v[196:199], v[52:55]
  ds_read_b64_tr_b16 v[144:145], v208 offset:0
  ds_read_b64_tr_b16 v[146:147], v208 offset:4096
  v_max3_f32 v253, v253, v172, v173
  v_mfma_f32_16x16x32_bf16 v[24:27], v[152:155], v[192:195], v[24:27]
  v_mfma_f32_16x16x32_bf16 v[56:59], v[152:155], v[196:199], v[56:59]
  ds_read_b64_tr_b16 v[148:149], v209 offset:0
  ds_read_b64_tr_b16 v[150:151], v209 offset:4096
  v_max3_f32 v252, v252, v174, v175
  v_mfma_f32_16x16x32_bf16 v[28:31], v[156:159], v[192:195], v[28:31]
  v_max_f32 v252, v252, v253
  v_mfma_f32_16x16x32_bf16 v[60:63], v[156:159], v[196:199], v[60:63]
  ds_read_b64_tr_b16 v[152:153], v210 offset:0
  ds_read_b64_tr_b16 v[154:155], v210 offset:4096
  v_cmp_lt_f32 vcc, s40, v252
  s_cbranch_vccz L_nr_16
  s_call_b64 s[50:51], L_rescale0
L_nr_16:
  v_mfma_f32_16x16x32_bf16 v[176:179], v[96:99], v[64:67], v[212:215]
  v_exp_f32 v160, v160
  v_exp_f32 v161, v161
  v_mfma_f32_16x16x32_bf16 v[184:187], v[96:99], v[80:83], v[216:219]
  ds_read_b64_tr_b16 v[156:157], v211 offset:0
  ds_read_b64_tr_b16 v[158:159], v211 offset:4096
  v_exp_f32 v162, v162
  v_mfma_f32_16x16x32_bf16 v[180:183], v[100:103], v[64:67], v[212:215]
  v_exp_f32 v163, v163
  v_cvt_pk_bf16_f32 v192, v160, v161
  v_mfma_f32_16x16x32_bf16 v[188:191], v[100:103], v[80:83], v[216:219]
  ds_read_b128 v[96:99], v200 offset:40960
  v_exp_f32 v164, v164
  v_mfma_f32_16x16x32_bf16 v[176:179], v[104:107], v[68:71], v[176:179]
  v_exp_f32 v165, v165
  v_cvt_pk_bf16_f32 v193, v162, v163
  v_mfma_f32_16x16x32_bf16 v[184:187], v[104:107], v[84:87], v[184:187]
  ds_read_b128 v[100:103], v200 offset:45056
  v_exp_f32 v166, v166
  v_mfma_f32_16x16x32_bf16 v[180:183], v[108:111], v[68:71], v[180:183]
  v_exp_f32 v167, v167
  v_cvt_pk_bf16_f32 v194, v164, v165
  v_mfma_f32_16x16x32_bf16 v[188:191], v[108:111], v[84:87], v[188:191]
  ds_read_b128 v[104:107], v201 offset:40960
  v_exp_f32 v168, v168
  v_mfma_f32_16x16x32_bf16 v[176:179], v[112:115], v[72:75], v[176:179]
  v_exp_f32 v169, v169
  v_cvt_pk_bf16_f32 v195, v166, v167
  v_mfma_f32_16x16x32_bf16 v[184:187], v[112:115], v[88:91], v[184:187]
  ds_read_b128 v[108:111], v201 offset:45056
  v_exp_f32 v170, v170
  v_mfma_f32_16x16x32_bf16 v[180:183], v[116:119], v[72:75], v[180:183]
  v_exp_f32 v171, v171
  v_cvt_pk_bf16_f32 v196, v168, v169
  v_mfma_f32_16x16x32_bf16 v[188:191], v[116:119], v[88:91], v[188:191]
  ds_read_b128 v[112:115], v202 offset:40960
  v_exp_f32 v172, v172
  v_mfma_f32_16x16x32_bf16 v[176:179], v[120:123], v[76:79], v[176:179]
  v_exp_f32 v173, v173
  v_cvt_pk_bf16_f32 v197, v170, v171
  v_mfma_f32_16x16x32_bf16 v[184:187], v[120:123], v[92:95], v[184:187]
  ds_read_b128 v[116:119], v202 offset:45056
  v_exp_f32 v174, v174
  v_mfma_f32_16x16x32_bf16 v[180:183], v[124:127], v[76:79], v[180:183]
  v_exp_f32 v175, v175
  v_cvt_pk_bf16_f32 v198, v172, v173
  v_mfma_f32_16x16x32_bf16 v[188:191], v[124:127], v[92:95], v[188:191]
  ds_read_b128 v[120:123], v203 offset:40960
  v_cvt_pk_bf16_f32 v199, v174, v175
  v_mfma_f32_16x16x32_bf16 v[240:243], v[248:251], v[192:195], v[240:243]
  s_nop 0
  v_mfma_f32_16x16x32_bf16 v[244:247], v[248:251], v[196:199], v[244:247]
  ds_read_b128 v[124:127], v203 offset:45056
  s_waitcnt lgkmcnt(15)
  v_mfma_f32_16x16x32_bf16 v[0:3], v[128:131], v[192:195], v[0:3]
  v_mfma_f32_16x16x32_bf16 v[32:35], v[128:131], v[196:199], v[32:35]
  v_mfma_f32_16x16x32_bf16 v[4:7], v[132:135], v[192:195], v[4:7]
  v_mfma_f32_16x16x32_bf16 v[36:39], v[132:135], v[196:199], v[36:39]
  ds_read_b64_tr_b16 v[128:129], v204 offset:16384
  ds_read_b64_tr_b16 v[130:131], v204 offset:20480
  v_mfma_f32_16x16x32_bf16 v[8:11], v[136:139], v[192:195], v[8:11]
  v_max3_f32 v252, v176, v177, v178
  v_mfma_f32_16x16x32_bf16 v[40:43], v[136:139], v[196:199], v[40:43]
  ds_read_b64_tr_b16 v[132:133], v205 offset:16384
  ds_read_b64_tr_b16 v[134:135], v205 offset:20480
  v_max3_f32 v253, v179, v180, v181
  v_mfma_f32_16x16x32_bf16 v[12:15], v[140:143], v[192:195], v[12:15]
  v_mfma_f32_16x16x32_bf16 v[44:47], v[140:143], v[196:199], v[44:47]
  ds_read_b64_tr_b16 v[136:137], v206 offset:16384
  ds_read_b64_tr_b16 v[138:139], v206 offset:20480
  v_max3_f32 v252, v252, v182, v183
  s_waitcnt lgkmcnt(15)
  v_mfma_f32_16x16x32_bf16 v[16:19], v[144:147], v[192:195], v[16:19]
  v_max3_f32 v253, v253, v184, v185
  v_mfma_f32_16x16x32_bf16 v[48:51], v[144:147], v[196:199], v[48:51]
  ds_read_b64_tr_b16 v[140:141], v207 offset:16384
  ds_read_b64_tr_b16 v[142:143], v207 offset:20480
  v_mfma_f32_16x16x32_bf16 v[20:23], v[148:151], v[192:195], v[20:23]
  v_max3_f32 v252, v252, v186, v187
  v_mfma_f32_16x16x32_bf16 v[52:55], v[148:151], v[196:199], v[52:55]
  ds_read_b64_tr_b16 v[144:145], v208 offset:16384
  ds_read_b64_tr_b16 v[146:147], v208 offset:20480
  v_max3_f32 v253, v253, v188, v189
  v_mfma_f32_16x16x32_bf16 v[24:27], v[152:155], v[192:195], v[24:27]
  v_mfma_f32_16x16x32_bf16 v[56:59], v[152:155], v[196:199], v[56:59]
  ds_read_b64_tr_b16 v[148:149], v209 offset:16384
  ds_read_b64_tr_b16 v[150:151], v209 offset:20480
  v_max3_f32 v252, v252, v190, v191
  s_waitcnt lgkmcnt(15)
  v_mfma_f32_16x16x32_bf16 v[28:31], v[156:159], v[192:195], v[28:31]
  v_max_f32 v252, v252, v253
  v_mfma_f32_16x16x32_bf16 v[60:63], v[156:159], v[196:199], v[60:63]
  ds_read_b64_tr_b16 v[152:153], v210 offset:16384
  ds_read_b64_tr_b16 v[154:155], v210 offset:20480
  v_cmp_lt_f32 vcc, s40, v252
  s_cbranch_vccz L_nr_17
  s_call_b64 s[50:51], L_rescale1
L_nr_17:
  v_mfma_f32_16x16x32_bf16 v[160:163], v[96:99], v[64:67], v[212:215]
  v_exp_f32 v176, v176
  v_exp_f32 v177, v177
  v_mfma_f32_16x16x32_bf16 v[168:171], v[96:99], v[80:83], v[216:219]
  ds_read_b64_tr_b16 v[156:157], v211 offset:16384
  ds_read_b64_tr_b16 v[158:159], v211 offset:20480
  v_exp_f32 v178, v178
  v_mfma_f32_16x16x32_bf16 v[164:167], v[100:103], v[64:67], v[212:215]
  v_exp_f32 v179, v179
  v_cvt_pk_bf16_f32 v192, v176, v177
  v_mfma_f32_16x16x32_bf16 v[172:175], v[100:103], v[80:83], v[216:219]
  ds_read_b128 v[96:99], v200 offset:57344
  v_exp_f32 v180, v180
  v_mfma_f32_16x16x32_bf16 v[160:163], v[104:107], v[68:71], v[160:163]
  v_exp_f32 v181, v181
  v_cvt_pk_bf16_f32 v193, v178, v179
  v_mfma_f32_16x16x32_bf16 v[168:171], v[104:107], v[84:87], v[168:171]
  ds_read_b128 v[100:103], v200 offset:61440
  v_exp_f32 v182, v182
  v_mfma_f32_16x16x32_bf16 v[164:167], v[108:111], v[68:71], v[164:167]
  v_exp_f32 v183, v183
  v_cvt_pk_bf16_f32 v194, v180, v181
  v_mfma_f32_16x16x32_bf16 v[172:175], v[108:111], v[84:87], v[172:175]
  ds_read_b128 v[104:107], v201 offset:57344
  v_exp_f32 v184, v184
  v_mfma_f32_16x16x32_bf16 v[160:163], v[112:115], v[72:75], v[160:163]
  v_exp_f32 v185, v185
  v_cvt_pk_bf16_f32 v195, v182, v183
  v_mfma_f32_16x16x32_bf16 v[168:171], v[112:115], v[88:91], v[168:171]
  ds_read_b128 v[108:111], v201 offset:61440
  v_exp_f32 v186, v186
  s_waitcnt lgkmcnt(15)
  v_mfma_f32_16x16x32_bf16 v[164:167], v[116:119], v[72:75], v[164:167]
  v_exp_f32 v187, v187
  v_cvt_pk_bf16_f32 v196, v184, v185
  v_mfma_f32_16x16x32_bf16 v[172:175], v[116:119], v[88:91], v[172:175]
  ds_read_b128 v[112:115], v202 offset:57344
  v_exp_f32 v188, v188
  v_mfma_f32_16x16x32_bf16 v[160:163], v[120:123], v[76:79], v[160:163]
  v_exp_f32 v189, v189
  v_cvt_pk_bf16_f32 v197, v186, v187
  v_mfma_f32_16x16x32_bf16 v[168:171], v[120:123], v[92:95], v[168:171]
  ds_read_b128 v[116:119], v202 offset:61440
  v_exp_f32 v190, v190
  v_mfma_f32_16x16x32_bf16 v[164:167], v[124:127], v[76:79], v[164:167]
  v_exp_f32 v191, v191
  v_cvt_pk_bf16_f32 v198, v188, v189
  v_mfma_f32_16x16x32_bf16 v[172:175], v[124:127], v[92:95], v[172:175]
  ds_read_b128 v[120:123], v203 offset:57344
  v_cvt_pk_bf16_f32 v199, v190, v191
  ds_read_b128 v[236:239], v220
  v_mfma_f32_16x16x32_bf16 v[240:243], v[248:251], v[192:195], v[240:243]
  v_mfma_f32_16x16x32_bf16 v[244:247], v[248:251], v[196:199], v[244:247]
  ds_read_b128 v[124:127], v203 offset:61440
  v_mfma_f32_16x16x32_bf16 v[0:3], v[128:131], v[192:195], v[0:3]
  v_mfma_f32_16x16x32_bf16 v[32:35], v[128:131], v[196:199], v[32:35]
  v_mfma_f32_16x16x32_bf16 v[4:7], v[132:135], v[192:195], v[4:7]
  s_waitcnt lgkmcnt(0)
  v_mov_b32 v254, 10
  v_min3_u32 v255, v236, v237, v238
  s_mov_b32 s91, 11
  s_mov_b64 exec, 1
  ds_write_b32 v221, v254
  s_mov_b64 exec, -1
  v_min_u32 v255, v255, v239
  v_cmp_gt_u32 vcc, s91, v255
  s_cbranch_vccz L_fok_18
  s_call_b64 s[50:51], L_cspin
L_fok_18:
  v_mfma_f32_16x16x32_bf16 v[36:39], v[132:135], v[196:199], v[36:39]
  ds_read_b64_tr_b16 v[128:129], v204 offset:32768
  ds_read_b64_tr_b16 v[130:131], v204 offset:36864
  v_mfma_f32_16x16x32_bf16 v[8:11], v[136:139], v[192:195], v[8:11]
  v_max3_f32 v252, v160, v161, v162
  v_mfma_f32_16x16x32_bf16 v[40:43], v[136:139], v[196:199], v[40:43]
  ds_read_b64_tr_b16 v[132:133], v205 offset:32768
  ds_read_b64_tr_b16 v[134:135], v205 offset:36864
  v_max3_f32 v253, v163, v164, v165
  v_mfma_f32_16x16x32_bf16 v[12:15], v[140:143], v[192:195], v[12:15]
  v_mfma_f32_16x16x32_bf16 v[44:47], v[140:143], v[196:199], v[44:47]
  ds_read_b64_tr_b16 v[136:137], v206 offset:32768
  ds_read_b64_tr_b16 v[138:139], v206 offset:36864
  v_max3_f32 v252, v252, v166, v167
  v_mfma_f32_16x16x32_bf16 v[16:19], v[144:147], v[192:195], v[16:19]
  v_max3_f32 v253, v253, v168, v169
  v_mfma_f32_16x16x32_bf16 v[48:51], v[144:147], v[196:199], v[48:51]
  ds_read_b64_tr_b16 v[140:141], v207 offset:32768
  ds_read_b64_tr_b16 v[142:143], v207 offset:36864
  v_mfma_f32_16x16x32_bf16 v[20:23], v[148:151], v[192:195], v[20:23]
  v_max3_f32 v252, v252, v170, v171
  v_mfma_f32_16x16x32_bf16 v[52:55], v[148:151], v[196:199], v[52:55]
  ds_read_b64_tr_b16 v[144:145], v208 offset:32768
  ds_read_b64_tr_b16 v[146:147], v208 offset:36864
  v_max3_f32 v253, v253, v172, v173
  v_mfma_f32_16x16x32_bf16 v[24:27], v[152:155], v[192:195], v[24:27]
  v_mfma_f32_16x16x32_bf16 v[56:59], v[152:155], v[196:199], v[56:59]
  ds_read_b64_tr_b16 v[148:149], v209 offset:32768
  ds_read_b64_tr_b16 v[150:151], v209 offset:36864
  v_max3_f32 v252, v252, v174, v175
  v_mfma_f32_16x16x32_bf16 v[28:31], v[156:159], v[192:195], v[28:31]
  v_max_f32 v252, v252, v253
  v_mfma_f32_16x16x32_bf16 v[60:63], v[156:159], v[196:199], v[60:63]
  ds_read_b64_tr_b16 v[152:153], v210 offset:32768
  ds_read_b64_tr_b16 v[154:155], v210 offset:36864
  v_cmp_lt_f32 vcc, s40, v252
  s_cbranch_vccz L_nr_18
  s_call_b64 s[50:51], L_rescale0
L_nr_18:
  v_mfma_f32_16x16x32_bf16 v[176:179], v[96:99], v[64:67], v[212:215]
  v_exp_f32 v160, v160
  v_exp_f32 v161, v161
  v_mfma_f32_16x16x32_bf16 v[184:187], v[96:99], v[80:83], v[216:219]
  ds_read_b64_tr_b16 v[156:157], v211 offset:32768
  ds_read_b64_tr_b16 v[158:159], v211 offset:36864
  v_exp_f32 v162, v162
  v_mfma_f32_16x16x32_bf16 v[180:183], v[100:103], v[64:67], v[212:215]
  v_exp_f32 v163, v163
  v_cvt_pk_bf16_f32 v192, v160, v161
  v_mfma_f32_16x16x32_bf16 v[188:191], v[100:103], v[80:83], v[216:219]
  ds_read_b128 v[96:99], v224 offset:8192
  v_exp_f32 v164, v164
  v_mfma_f32_16x16x32_bf16 v[176:179], v[104:107], v[68:71], v[176:179]
  v_exp_f32 v165, v165
  v_cvt_pk_bf16_f32 v193, v162, v163
  v_mfma_f32_16x16x32_bf16 v[184:187], v[104:107], v[84:87], v[184:187]
  ds_read_b128 v[100:103], v224 offset:12288
  v_exp_f32 v166, v166
  v_mfma_f32_16x16x32_bf16 v[180:183], v[108:111], v[68:71], v[180:183]
  v_exp_f32 v167, v167
  v_cvt_pk_bf16_f32 v194, v164, v165
  v_mfma_f32_16x16x32_bf16 v[188:191], v[108:111], v[84:87], v[188:191]
  ds_read_b128 v[104:107], v225 offset:8192
  v_exp_f32 v168, v168
  v_mfma_f32_16x16x32_bf16 v[176:179], v[112:115], v[72:75], v[176:179]
  v_exp_f32 v169, v169
  v_cvt_pk_bf16_f32 v195, v166, v167
  v_mfma_f32_16x16x32_bf16 v[184:187], v[112:115], v[88:91], v[184:187]
  ds_read_b128 v[108:111], v225 offset:12288
  v_exp_f32 v170, v170
  v_mfma_f32_16x16x32_bf16 v[180:183], v[116:119], v[72:75], v[180:183]
  v_exp_f32 v171, v171
  v_cvt_pk_bf16_f32 v196, v168, v169
  v_mfma_f32_16x16x32_bf16 v[188:191], v[116:119], v[88:91], v[188:191]
  ds_read_b128 v[112:115], v226 offset:8192
  v_exp_f32 v172, v172
  v_mfma_f32_16x16x32_bf16 v[176:179], v[120:123], v[76:79], v[176:179]
  v_exp_f32 v173, v173
  v_cvt_pk_bf16_f32 v197, v170, v171
  v_mfma_f32_16x16x32_bf16 v[184:187], v[120:123], v[92:95], v[184:187]
  ds_read_b128 v[116:119], v226 offset:12288
  v_exp_f32 v174, v174
  v_mfma_f32_16x16x32_bf16 v[180:183], v[124:127], v[76:79], v[180:183]
  v_exp_f32 v175, v175
  v_cvt_pk_bf16_f32 v198, v172, v173
  v_mfma_f32_16x16x32_bf16 v[188:191], v[124:127], v[92:95], v[188:191]
  ds_read_b128 v[120:123], v227 offset:8192
  v_cvt_pk_bf16_f32 v199, v174, v175
  v_mfma_f32_16x16x32_bf16 v[240:243], v[248:251], v[192:195], v[240:243]
  s_nop 0
  v_mfma_f32_16x16x32_bf16 v[244:247], v[248:251], v[196:199], v[244:247]
  ds_read_b128 v[124:127], v227 offset:12288
  s_waitcnt lgkmcnt(15)
  v_mfma_f32_16x16x32_bf16 v[0:3], v[128:131], v[192:195], v[0:3]
  v_mfma_f32_16x16x32_bf16 v[32:35], v[128:131], v[196:199], v[32:35]
  v_mfma_f32_16x16x32_bf16 v[4:7], v[132:135], v[192:195], v[4:7]
  v_mfma_f32_16x16x32_bf16 v[36:39], v[132:135], v[196:199], v[36:39]
  ds_read_b64_tr_b16 v[128:129], v204 offset:49152
  ds_read_b64_tr_b16 v[130:131], v204 offset:53248
  v_mfma_f32_16x16x32_bf16 v[8:11], v[136:139], v[192:195], v[8:11]
  v_max3_f32 v252, v176, v177, v178
  v_mfma_f32_16x16x32_bf16 v[40:43], v[136:139], v[196:199], v[40:43]
  ds_read_b64_tr_b16 v[132:133], v205 offset:49152
  ds_read_b64_tr_b16 v[134:135], v205 offset:53248
  v_max3_f32 v253, v179, v180, v181
  v_mfma_f32_16x16x32_bf16 v[12:15], v[140:143], v[192:195], v[12:15]
  v_mfma_f32_16x16x32_bf16 v[44:47], v[140:143], v[196:199], v[44:47]
  ds_read_b64_tr_b16 v[136:137], v206 offset:49152
  ds_read_b64_tr_b16 v[138:139], v206 offset:53248
  v_max3_f32 v252, v252, v182, v183
  s_waitcnt lgkmcnt(15)
  v_mfma_f32_16x16x32_bf16 v[16:19], v[144:147], v[192:195], v[16:19]
  v_max3_f32 v253, v253, v184, v185
  v_mfma_f32_16x16x32_bf16 v[48:51], v[144:147], v[196:199], v[48:51]
  ds_read_b64_tr_b16 v[140:141], v207 offset:49152
  ds_read_b64_tr_b16 v[142:143], v207 offset:53248
  v_mfma_f32_16x16x32_bf16 v[20:23], v[148:151], v[192:195], v[20:23]
  v_max3_f32 v252, v252, v186, v187
  v_mfma_f32_16x16x32_bf16 v[52:55], v[148:151], v[196:199], v[52:55]
  ds_read_b64_tr_b16 v[144:145], v208 offset:49152
  ds_read_b64_tr_b16 v[146:147], v208 offset:53248
  v_max3_f32 v253, v253, v188, v189
  v_mfma_f32_16x16x32_bf16 v[24:27], v[152:155], v[192:195], v[24:27]
  v_mfma_f32_16x16x32_bf16 v[56:59], v[152:155], v[196:199], v[56:59]
  ds_read_b64_tr_b16 v[148:149], v209 offset:49152
  ds_read_b64_tr_b16 v[150:151], v209 offset:53248
  v_max3_f32 v252, v252, v190, v191
  s_waitcnt lgkmcnt(15)
  v_mfma_f32_16x16x32_bf16 v[28:31], v[156:159], v[192:195], v[28:31]
  v_max_f32 v252, v252, v253
  v_mfma_f32_16x16x32_bf16 v[60:63], v[156:159], v[196:199], v[60:63]
  ds_read_b64_tr_b16 v[152:153], v210 offset:49152
  ds_read_b64_tr_b16 v[154:155], v210 offset:53248
  v_cmp_lt_f32 vcc, s40, v252
  s_cbranch_vccz L_nr_19
  s_call_b64 s[50:51], L_rescale1
L_nr_19:
  v_mfma_f32_16x16x32_bf16 v[160:163], v[96:99], v[64:67], v[212:215]
  v_exp_f32 v176, v176
  v_exp_f32 v177, v177
  v_mfma_f32_16x16x32_bf16 v[168:171], v[96:99], v[80:83], v[216:219]
  ds_read_b64_tr_b16 v[156:157], v211 offset:49152
  ds_read_b64_tr_b16 v[158:159], v211 offset:53248
  v_exp_f32 v178, v178
  v_mfma_f32_16x16x32_bf16 v[164:167], v[100:103], v[64:67], v[212:215]
  v_exp_f32 v179, v179
  v_cvt_pk_bf16_f32 v192, v176, v177
  v_mfma_f32_16x16x32_bf16 v[172:175], v[100:103], v[80:83], v[216:219]
  ds_read_b128 v[96:99], v224 offset:24576
  v_exp_f32 v180, v180
  v_mfma_f32_16x16x32_bf16 v[160:163], v[104:107], v[68:71], v[160:163]
  v_exp_f32 v181, v181
  v_cvt_pk_bf16_f32 v193, v178, v179
  v_mfma_f32_16x16x32_bf16 v[168:171], v[104:107], v[84:87], v[168:171]
  ds_read_b128 v[100:103], v224 offset:28672
  v_exp_f32 v182, v182
  v_mfma_f32_16x16x32_bf16 v[164:167], v[108:111], v[68:71], v[164:167]
  v_exp_f32 v183, v183
  v_cvt_pk_bf16_f32 v194, v180, v181
  v_mfma_f32_16x16x32_bf16 v[172:175], v[108:111], v[84:87], v[172:175]
  ds_read_b128 v[104:107], v225 offset:24576
  v_exp_f32 v184, v184
  v_mfma_f32_16x16x32_bf16 v[160:163], v[112:115], v[72:75], v[160:163]
  v_exp_f32 v185, v185
  v_cvt_pk_bf16_f32 v195, v182, v183
  v_mfma_f32_16x16x32_bf16 v[168:171], v[112:115], v[88:91], v[168:171]
  ds_read_b128 v[108:111], v225 offset:28672
  v_exp_f32 v186, v186
  s_waitcnt lgkmcnt(15)
  v_mfma_f32_16x16x32_bf16 v[164:167], v[116:119], v[72:75], v[164:167]
  v_exp_f32 v187, v187
  v_cvt_pk_bf16_f32 v196, v184, v185
  v_mfma_f32_16x16x32_bf16 v[172:175], v[116:119], v[88:91], v[172:175]
  ds_read_b128 v[112:115], v226 offset:24576
  v_exp_f32 v188, v188
  v_mfma_f32_16x16x32_bf16 v[160:163], v[120:123], v[76:79], v[160:163]
  v_exp_f32 v189, v189
  v_cvt_pk_bf16_f32 v197, v186, v187
  v_mfma_f32_16x16x32_bf16 v[168:171], v[120:123], v[92:95], v[168:171]
  ds_read_b128 v[116:119], v226 offset:28672
  v_exp_f32 v190, v190
  v_mfma_f32_16x16x32_bf16 v[164:167], v[124:127], v[76:79], v[164:167]
  v_exp_f32 v191, v191
  v_cvt_pk_bf16_f32 v198, v188, v189
  v_mfma_f32_16x16x32_bf16 v[172:175], v[124:127], v[92:95], v[172:175]
  ds_read_b128 v[120:123], v227 offset:24576
  v_cvt_pk_bf16_f32 v199, v190, v191
  ds_read_b128 v[236:239], v220
  v_mfma_f32_16x16x32_bf16 v[240:243], v[248:251], v[192:195], v[240:243]
  v_mfma_f32_16x16x32_bf16 v[244:247], v[248:251], v[196:199], v[244:247]
  ds_read_b128 v[124:127], v227 offset:28672
  v_mfma_f32_16x16x32_bf16 v[0:3], v[128:131], v[192:195], v[0:3]
  v_mfma_f32_16x16x32_bf16 v[32:35], v[128:131], v[196:199], v[32:35]
  v_mfma_f32_16x16x32_bf16 v[4:7], v[132:135], v[192:195], v[4:7]
  s_waitcnt lgkmcnt(0)
  v_mov_b32 v254, 11
  v_min3_u32 v255, v236, v237, v238
  s_mov_b32 s91, 12
  s_mov_b64 exec, 1
  ds_write_b32 v221, v254
  s_mov_b64 exec, -1
  v_min_u32 v255, v255, v239
  v_cmp_gt_u32 vcc, s91, v255
  s_cbranch_vccz L_fok_20
  s_call_b64 s[50:51], L_cspin
L_fok_20:
  v_mfma_f32_16x16x32_bf16 v[36:39], v[132:135], v[196:199], v[36:39]
  ds_read_b64_tr_b16 v[128:129], v228 offset:0
  ds_read_b64_tr_b16 v[130:131], v228 offset:4096
  v_mfma_f32_16x16x32_bf16 v[8:11], v[136:139], v[192:195], v[8:11]
  v_max3_f32 v252, v160, v161, v162
  v_mfma_f32_16x16x32_bf16 v[40:43], v[136:139], v[196:199], v[40:43]
  ds_read_b64_tr_b16 v[132:133], v229 offset:0
  ds_read_b64_tr_b16 v[134:135], v229 offset:4096
  v_max3_f32 v253, v163, v164, v165
  v_mfma_f32_16x16x32_bf16 v[12:15], v[140:143], v[192:195], v[12:15]
  v_mfma_f32_16x16x32_bf16 v[44:47], v[140:143], v[196:199], v[44:47]
  ds_read_b64_tr_b16 v[136:137], v230 offset:0
  ds_read_b64_tr_b16 v[138:139], v230 offset:4096
  v_max3_f32 v252, v252, v166, v167
  v_mfma_f32_16x16x32_bf16 v[16:19], v[144:147], v[192:195], v[16:19]
  v_max3_f32 v253, v253, v168, v169
  v_mfma_f32_16x16x32_bf16 v[48:51], v[144:147], v[196:199], v[48:51]
  ds_read_b64_tr_b16 v[140:141], v231 offset:0
  ds_read_b64_tr_b16 v[142:143], v231 offset:4096
  v_mfma_f32_16x16x32_bf16 v[20:23], v[148:151], v[192:195], v[20:23]
  v_max3_f32 v252, v252, v170, v171
  v_mfma_f32_16x16x32_bf16 v[52:55], v[148:151], v[196:199], v[52:55]
  ds_read_b64_tr_b16 v[144:145], v232 offset:0
  ds_read_b64_tr_b16 v[146:147], v232 offset:4096
  v_max3_f32 v253, v253, v172, v173
  v_mfma_f32_16x16x32_bf16 v[24:27], v[152:155], v[192:195], v[24:27]
  v_mfma_f32_16x16x32_bf16 v[56:59], v[152:155], v[196:199], v[56:59]
  ds_read_b64_tr_b16 v[148:149], v233 offset:0
  ds_read_b64_tr_b16 v[150:151], v233 offset:4096
  v_max3_f32 v252, v252, v174, v175
  v_mfma_f32_16x16x32_bf16 v[28:31], v[156:159], v[192:195], v[28:31]
  v_max_f32 v252, v252, v253
  v_mfma_f32_16x16x32_bf16 v[60:63], v[156:159], v[196:199], v[60:63]
  ds_read_b64_tr_b16 v[152:153], v234 offset:0
  ds_read_b64_tr_b16 v[154:155], v234 offset:4096
  v_cmp_lt_f32 vcc, s40, v252
  s_cbranch_vccz L_nr_20
  s_call_b64 s[50:51], L_rescale0
L_nr_20:
  v_mfma_f32_16x16x32_bf16 v[176:179], v[96:99], v[64:67], v[212:215]
  v_exp_f32 v160, v160
  v_exp_f32 v161, v161
  v_mfma_f32_16x16x32_bf16 v[184:187], v[96:99], v[80:83], v[216:219]
  ds_read_b64_tr_b16 v[156:157], v235 offset:0
  ds_read_b64_tr_b16 v[158:159], v235 offset:4096
  v_exp_f32 v162, v162
  v_mfma_f32_16x16x32_bf16 v[180:183], v[100:103], v[64:67], v[212:215]
  v_exp_f32 v163, v163
  v_cvt_pk_bf16_f32 v192, v160, v161
  v_mfma_f32_16x16x32_bf16 v[188:191], v[100:103], v[80:83], v[216:219]
  ds_read_b128 v[96:99], v224 offset:40960
  v_exp_f32 v164, v164
  v_mfma_f32_16x16x32_bf16 v[176:179], v[104:107], v[68:71], v[176:179]
  v_exp_f32 v165, v165
  v_cvt_pk_bf16_f32 v193, v162, v163
  v_mfma_f32_16x16x32_bf16 v[184:187], v[104:107], v[84:87], v[184:187]
  ds_read_b128 v[100:103], v224 offset:45056
  v_exp_f32 v166, v166
  v_mfma_f32_16x16x32_bf16 v[180:183], v[108:111], v[68:71], v[180:183]
  v_exp_f32 v167, v167
  v_cvt_pk_bf16_f32 v194, v164, v165
  v_mfma_f32_16x16x32_bf16 v[188:191], v[108:111], v[84:87], v[188:191]
  ds_read_b128 v[104:107], v225 offset:40960
  v_exp_f32 v168, v168
  v_mfma_f32_16x16x32_bf16 v[176:179], v[112:115], v[72:75], v[176:179]
  v_exp_f32 v169, v169
  v_cvt_pk_bf16_f32 v195, v166, v167
  v_mfma_f32_16x16x32_bf16 v[184:187], v[112:115], v[88:91], v[184:187]
  ds_read_b128 v[108:111], v225 offset:45056
  v_exp_f32 v170, v170
  v_mfma_f32_16x16x32_bf16 v[180:183], v[116:119], v[72:75], v[180:183]
  v_exp_f32 v171, v171
  v_cvt_pk_bf16_f32 v196, v168, v169
  v_mfma_f32_16x16x32_bf16 v[188:191], v[116:119], v[88:91], v[188:191]
  ds_read_b128 v[112:115], v226 offset:40960
  v_exp_f32 v172, v172
  v_mfma_f32_16x16x32_bf16 v[176:179], v[120:123], v[76:79], v[176:179]
  v_exp_f32 v173, v173
  v_cvt_pk_bf16_f32 v197, v170, v171
  v_mfma_f32_16x16x32_bf16 v[184:187], v[120:123], v[92:95], v[184:187]
  ds_read_b128 v[116:119], v226 offset:45056
  v_exp_f32 v174, v174
  v_mfma_f32_16x16x32_bf16 v[180:183], v[124:127], v[76:79], v[180:183]
  v_exp_f32 v175, v175
  v_cvt_pk_bf16_f32 v198, v172, v173
  v_mfma_f32_16x16x32_bf16 v[188:191], v[124:127], v[92:95], v[188:191]
  ds_read_b128 v[120:123], v227 offset:40960
  v_cvt_pk_bf16_f32 v199, v174, v175
  v_mfma_f32_16x16x32_bf16 v[240:243], v[248:251], v[192:195], v[240:243]
  s_nop 0
  v_mfma_f32_16x16x32_bf16 v[244:247], v[248:251], v[196:199], v[244:247]
  ds_read_b128 v[124:127], v227 offset:45056
  s_waitcnt lgkmcnt(15)
  v_mfma_f32_16x16x32_bf16 v[0:3], v[128:131], v[192:195], v[0:3]
  v_mfma_f32_16x16x32_bf16 v[32:35], v[128:131], v[196:199], v[32:35]
  v_mfma_f32_16x16x32_bf16 v[4:7], v[132:135], v[192:195], v[4:7]
  v_mfma_f32_16x16x32_bf16 v[36:39], v[132:135], v[196:199], v[36:39]
  ds_read_b64_tr_b16 v[128:129], v228 offset:16384
  ds_read_b64_tr_b16 v[130:131], v228 offset:20480
  v_mfma_f32_16x16x32_bf16 v[8:11], v[136:139], v[192:195], v[8:11]
  v_max3_f32 v252, v176, v177, v178
  v_mfma_f32_16x16x32_bf16 v[40:43], v[136:139], v[196:199], v[40:43]
  ds_read_b64_tr_b16 v[132:133], v229 offset:16384
  ds_read_b64_tr_b16 v[134:135], v229 offset:20480
  v_max3_f32 v253, v179, v180, v181
  v_mfma_f32_16x16x32_bf16 v[12:15], v[140:143], v[192:195], v[12:15]
  v_mfma_f32_16x16x32_bf16 v[44:47], v[140:143], v[196:199], v[44:47]
  ds_read_b64_tr_b16 v[136:137], v230 offset:16384
  ds_read_b64_tr_b16 v[138:139], v230 offset:20480
  v_max3_f32 v252, v252, v182, v183
  s_waitcnt lgkmcnt(15)
  v_mfma_f32_16x16x32_bf16 v[16:19], v[144:147], v[192:195], v[16:19]
  v_max3_f32 v253, v253, v184, v185
  v_mfma_f32_16x16x32_bf16 v[48:51], v[144:147], v[196:199], v[48:51]
  ds_read_b64_tr_b16 v[140:141], v231 offset:16384
  ds_read_b64_tr_b16 v[142:143], v231 offset:20480
  v_mfma_f32_16x16x32_bf16 v[20:23], v[148:151], v[192:195], v[20:23]
  v_max3_f32 v252, v252, v186, v187
  v_mfma_f32_16x16x32_bf16 v[52:55], v[148:151], v[196:199], v[52:55]
  ds_read_b64_tr_b16 v[144:145], v232 offset:16384
  ds_read_b64_tr_b16 v[146:147], v232 offset:20480
  v_max3_f32 v253, v253, v188, v189
  v_mfma_f32_16x16x32_bf16 v[24:27], v[152:155], v[192:195], v[24:27]
  v_mfma_f32_16x16x32_bf16 v[56:59], v[152:155], v[196:199], v[56:59]
  ds_read_b64_tr_b16 v[148:149], v233 offset:16384
  ds_read_b64_tr_b16 v[150:151], v233 offset:20480
  v_max3_f32 v252, v252, v190, v191
  s_waitcnt lgkmcnt(15)
  v_mfma_f32_16x16x32_bf16 v[28:31], v[156:159], v[192:195], v[28:31]
  v_max_f32 v252, v252, v253
  v_mfma_f32_16x16x32_bf16 v[60:63], v[156:159], v[196:199], v[60:63]
  ds_read_b64_tr_b16 v[152:153], v234 offset:16384
  ds_read_b64_tr_b16 v[154:155], v234 offset:20480
  v_cmp_lt_f32 vcc, s40, v252
  s_cbranch_vccz L_nr_21
  s_call_b64 s[50:51], L_rescale1
L_nr_21:
  v_mfma_f32_16x16x32_bf16 v[160:163], v[96:99], v[64:67], v[212:215]
  v_exp_f32 v176, v176
  v_exp_f32 v177, v177
  v_mfma_f32_16x16x32_bf16 v[168:171], v[96:99], v[80:83], v[216:219]
  ds_read_b64_tr_b16 v[156:157], v235 offset:16384
  ds_read_b64_tr_b16 v[158:159], v235 offset:20480
  v_exp_f32 v178, v178
  v_mfma_f32_16x16x32_bf16 v[164:167], v[100:103], v[64:67], v[212:215]
  v_exp_f32 v179, v179
  v_cvt_pk_bf16_f32 v192, v176, v177
  v_mfma_f32_16x16x32_bf16 v[172:175], v[100:103], v[80:83], v[216:219]
  ds_read_b128 v[96:99], v224 offset:57344
  v_exp_f32 v180, v180
  v_mfma_f32_16x16x32_bf16 v[160:163], v[104:107], v[68:71], v[160:163]
  v_exp_f32 v181, v181
  v_cvt_pk_bf16_f32 v193, v178, v179
  v_mfma_f32_16x16x32_bf16 v[168:171], v[104:107], v[84:87], v[168:171]
  ds_read_b128 v[100:103], v224 offset:61440
  v_exp_f32 v182, v182
  v_mfma_f32_16x16x32_bf16 v[164:167], v[108:111], v[68:71], v[164:167]
  v_exp_f32 v183, v183
  v_cvt_pk_bf16_f32 v194, v180, v181
  v_mfma_f32_16x16x32_bf16 v[172:175], v[108:111], v[84:87], v[172:175]
  ds_read_b128 v[104:107], v225 offset:57344
  v_exp_f32 v184, v184
  v_mfma_f32_16x16x32_bf16 v[160:163], v[112:115], v[72:75], v[160:163]
  v_exp_f32 v185, v185
  v_cvt_pk_bf16_f32 v195, v182, v183
  v_mfma_f32_16x16x32_bf16 v[168:171], v[112:115], v[88:91], v[168:171]
  ds_read_b128 v[108:111], v225 offset:61440
  v_exp_f32 v186, v186
  s_waitcnt lgkmcnt(15)
  v_mfma_f32_16x16x32_bf16 v[164:167], v[116:119], v[72:75], v[164:167]
  v_exp_f32 v187, v187
  v_cvt_pk_bf16_f32 v196, v184, v185
  v_mfma_f32_16x16x32_bf16 v[172:175], v[116:119], v[88:91], v[172:175]
  ds_read_b128 v[112:115], v226 offset:57344
  v_exp_f32 v188, v188
  v_mfma_f32_16x16x32_bf16 v[160:163], v[120:123], v[76:79], v[160:163]
  v_exp_f32 v189, v189
  v_cvt_pk_bf16_f32 v197, v186, v187
  v_mfma_f32_16x16x32_bf16 v[168:171], v[120:123], v[92:95], v[168:171]
  ds_read_b128 v[116:119], v226 offset:61440
  v_exp_f32 v190, v190
  v_mfma_f32_16x16x32_bf16 v[164:167], v[124:127], v[76:79], v[164:167]
  v_exp_f32 v191, v191
  v_cvt_pk_bf16_f32 v198, v188, v189
  v_mfma_f32_16x16x32_bf16 v[172:175], v[124:127], v[92:95], v[172:175]
  ds_read_b128 v[120:123], v227 offset:57344
  v_cvt_pk_bf16_f32 v199, v190, v191
  ds_read_b128 v[236:239], v220
  v_mfma_f32_16x16x32_bf16 v[240:243], v[248:251], v[192:195], v[240:243]
  v_mfma_f32_16x16x32_bf16 v[244:247], v[248:251], v[196:199], v[244:247]
  ds_read_b128 v[124:127], v227 offset:61440
  v_mfma_f32_16x16x32_bf16 v[0:3], v[128:131], v[192:195], v[0:3]
  v_mfma_f32_16x16x32_bf16 v[32:35], v[128:131], v[196:199], v[32:35]
  v_mfma_f32_16x16x32_bf16 v[4:7], v[132:135], v[192:195], v[4:7]
  s_waitcnt lgkmcnt(0)
  v_mov_b32 v254, 12
  v_min3_u32 v255, v236, v237, v238
  s_mov_b32 s91, 13
  s_mov_b64 exec, 1
  ds_write_b32 v221, v254
  s_mov_b64 exec, -1
  v_min_u32 v255, v255, v239
  v_cmp_gt_u32 vcc, s91, v255
  s_cbranch_vccz L_fok_22
  s_call_b64 s[50:51], L_cspin
L_fok_22:
  v_mfma_f32_16x16x32_bf16 v[36:39], v[132:135], v[196:199], v[36:39]
  ds_read_b64_tr_b16 v[128:129], v228 offset:32768
  ds_read_b64_tr_b16 v[130:131], v228 offset:36864
  v_mfma_f32_16x16x32_bf16 v[8:11], v[136:139], v[192:195], v[8:11]
  v_max3_f32 v252, v160, v161, v162
  v_mfma_f32_16x16x32_bf16 v[40:43], v[136:139], v[196:199], v[40:43]
  ds_read_b64_tr_b16 v[132:133], v229 offset:32768
  ds_read_b64_tr_b16 v[134:135], v229 offset:36864
  v_max3_f32 v253, v163, v164, v165
  v_mfma_f32_16x16x32_bf16 v[12:15], v[140:143], v[192:195], v[12:15]
  v_mfma_f32_16x16x32_bf16 v[44:47], v[140:143], v[196:199], v[44:47]
  ds_read_b64_tr_b16 v[136:137], v230 offset:32768
  ds_read_b64_tr_b16 v[138:139], v230 offset:36864
  v_max3_f32 v252, v252, v166, v167
  v_mfma_f32_16x16x32_bf16 v[16:19], v[144:147], v[192:195], v[16:19]
  v_max3_f32 v253, v253, v168, v169
  v_mfma_f32_16x16x32_bf16 v[48:51], v[144:147], v[196:199], v[48:51]
  ds_read_b64_tr_b16 v[140:141], v231 offset:32768
  ds_read_b64_tr_b16 v[142:143], v231 offset:36864
  v_mfma_f32_16x16x32_bf16 v[20:23], v[148:151], v[192:195], v[20:23]
  v_max3_f32 v252, v252, v170, v171
  v_mfma_f32_16x16x32_bf16 v[52:55], v[148:151], v[196:199], v[52:55]
  ds_read_b64_tr_b16 v[144:145], v232 offset:32768
  ds_read_b64_tr_b16 v[146:147], v232 offset:36864
  v_max3_f32 v253, v253, v172, v173
  v_mfma_f32_16x16x32_bf16 v[24:27], v[152:155], v[192:195], v[24:27]
  v_mfma_f32_16x16x32_bf16 v[56:59], v[152:155], v[196:199], v[56:59]
  ds_read_b64_tr_b16 v[148:149], v233 offset:32768
  ds_read_b64_tr_b16 v[150:151], v233 offset:36864
  v_max3_f32 v252, v252, v174, v175
  v_mfma_f32_16x16x32_bf16 v[28:31], v[156:159], v[192:195], v[28:31]
  v_max_f32 v252, v252, v253
  v_mfma_f32_16x16x32_bf16 v[60:63], v[156:159], v[196:199], v[60:63]
  ds_read_b64_tr_b16 v[152:153], v234 offset:32768
  ds_read_b64_tr_b16 v[154:155], v234 offset:36864
  v_cmp_lt_f32 vcc, s40, v252
  s_cbranch_vccz L_nr_22
  s_call_b64 s[50:51], L_rescale0
L_nr_22:
  v_mfma_f32_16x16x32_bf16 v[176:179], v[96:99], v[64:67], v[212:215]
  v_exp_f32 v160, v160
  v_exp_f32 v161, v161
  v_mfma_f32_16x16x32_bf16 v[184:187], v[96:99], v[80:83], v[216:219]
  ds_read_b64_tr_b16 v[156:157], v235 offset:32768
  ds_read_b64_tr_b16 v[158:159], v235 offset:36864
  v_exp_f32 v162, v162
  v_mfma_f32_16x16x32_bf16 v[180:183], v[100:103], v[64:67], v[212:215]
  v_exp_f32 v163, v163
  v_cvt_pk_bf16_f32 v192, v160, v161
  v_mfma_f32_16x16x32_bf16 v[188:191], v[100:103], v[80:83], v[216:219]
  ds_read_b128 v[96:99], v200 offset:8192
  v_exp_f32 v164, v164
  v_mfma_f32_16x16x32_bf16 v[176:179], v[104:107], v[68:71], v[176:179]
  v_exp_f32 v165, v165
  v_cvt_pk_bf16_f32 v193, v162, v163
  v_mfma_f32_16x16x32_bf16 v[184:187], v[104:107], v[84:87], v[184:187]
  ds_read_b128 v[100:103], v200 offset:12288
  v_exp_f32 v166, v166
  v_mfma_f32_16x16x32_bf16 v[180:183], v[108:111], v[68:71], v[180:183]
  v_exp_f32 v167, v167
  v_cvt_pk_bf16_f32 v194, v164, v165
  v_mfma_f32_16x16x32_bf16 v[188:191], v[108:111], v[84:87], v[188:191]
  ds_read_b128 v[104:107], v201 offset:8192
  v_exp_f32 v168, v168
  v_mfma_f32_16x16x32_bf16 v[176:179], v[112:115], v[72:75], v[176:179]
  v_exp_f32 v169, v169
  v_cvt_pk_bf16_f32 v195, v166, v167
  v_mfma_f32_16x16x32_bf16 v[184:187], v[112:115], v[88:91], v[184:187]
  ds_read_b128 v[108:111], v201 offset:12288
  v_exp_f32 v170, v170
  v_mfma_f32_16x16x32_bf16 v[180:183], v[116:119], v[72:75], v[180:183]
  v_exp_f32 v171, v171
  v_cvt_pk_bf16_f32 v196, v168, v169
  v_mfma_f32_16x16x32_bf16 v[188:191], v[116:119], v[88:91], v[188:191]
  ds_read_b128 v[112:115], v202 offset:8192
  v_exp_f32 v172, v172
  v_mfma_f32_16x16x32_bf16 v[176:179], v[120:123], v[76:79], v[176:179]
  v_exp_f32 v173, v173
  v_cvt_pk_bf16_f32 v197, v170, v171
  v_mfma_f32_16x16x32_bf16 v[184:187], v[120:123], v[92:95], v[184:187]
  ds_read_b128 v[116:119], v202 offset:12288
  v_exp_f32 v174, v174
  v_mfma_f32_16x16x32_bf16 v[180:183], v[124:127], v[76:79], v[180:183]
  v_exp_f32 v175, v175
  v_cvt_pk_bf16_f32 v198, v172, v173
  v_mfma_f32_16x16x32_bf16 v[188:191], v[124:127], v[92:95], v[188:191]
  ds_read_b128 v[120:123], v203 offset:8192
  v_cvt_pk_bf16_f32 v199, v174, v175
  v_mfma_f32_16x16x32_bf16 v[240:243], v[248:251], v[192:195], v[240:243]
  s_nop 0
  v_mfma_f32_16x16x32_bf16 v[244:247], v[248:251], v[196:199], v[244:247]
  ds_read_b128 v[124:127], v203 offset:12288
  s_waitcnt lgkmcnt(15)
  v_mfma_f32_16x16x32_bf16 v[0:3], v[128:131], v[192:195], v[0:3]
  v_mfma_f32_16x16x32_bf16 v[32:35], v[128:131], v[196:199], v[32:35]
  v_mfma_f32_16x16x32_bf16 v[4:7], v[132:135], v[192:195], v[4:7]
  v_mfma_f32_16x16x32_bf16 v[36:39], v[132:135], v[196:199], v[36:39]
  ds_read_b64_tr_b16 v[128:129], v228 offset:49152
  ds_read_b64_tr_b16 v[130:131], v228 offset:53248
  v_mfma_f32_16x16x32_bf16 v[8:11], v[136:139], v[192:195], v[8:11]
  v_max3_f32 v252, v176, v177, v178
  v_mfma_f32_16x16x32_bf16 v[40:43], v[136:139], v[196:199], v[40:43]
  ds_read_b64_tr_b16 v[132:133], v229 offset:49152
  ds_read_b64_tr_b16 v[134:135], v229 offset:53248
  v_max3_f32 v253, v179, v180, v181
  v_mfma_f32_16x16x32_bf16 v[12:15], v[140:143], v[192:195], v[12:15]
  v_mfma_f32_16x16x32_bf16 v[44:47], v[140:143], v[196:199], v[44:47]
  ds_read_b64_tr_b16 v[136:137], v230 offset:49152
  ds_read_b64_tr_b16 v[138:139], v230 offset:53248
  v_max3_f32 v252, v252, v182, v183
  s_waitcnt lgkmcnt(15)
  v_mfma_f32_16x16x32_bf16 v[16:19], v[144:147], v[192:195], v[16:19]
  v_max3_f32 v253, v253, v184, v185
  v_mfma_f32_16x16x32_bf16 v[48:51], v[144:147], v[196:199], v[48:51]
  ds_read_b64_tr_b16 v[140:141], v231 offset:49152
  ds_read_b64_tr_b16 v[142:143], v231 offset:53248
  v_mfma_f32_16x16x32_bf16 v[20:23], v[148:151], v[192:195], v[20:23]
  v_max3_f32 v252, v252, v186, v187
  v_mfma_f32_16x16x32_bf16 v[52:55], v[148:151], v[196:199], v[52:55]
  ds_read_b64_tr_b16 v[144:145], v232 offset:49152
  ds_read_b64_tr_b16 v[146:147], v232 offset:53248
  v_max3_f32 v253, v253, v188, v189
  v_mfma_f32_16x16x32_bf16 v[24:27], v[152:155], v[192:195], v[24:27]
  v_mfma_f32_16x16x32_bf16 v[56:59], v[152:155], v[196:199], v[56:59]
  ds_read_b64_tr_b16 v[148:149], v233 offset:49152
  ds_read_b64_tr_b16 v[150:151], v233 offset:53248
  v_max3_f32 v252, v252, v190, v191
  s_waitcnt lgkmcnt(15)
  v_mfma_f32_16x16x32_bf16 v[28:31], v[156:159], v[192:195], v[28:31]
  v_max_f32 v252, v252, v253
  v_mfma_f32_16x16x32_bf16 v[60:63], v[156:159], v[196:199], v[60:63]
  ds_read_b64_tr_b16 v[152:153], v234 offset:49152
  ds_read_b64_tr_b16 v[154:155], v234 offset:53248
  v_cmp_lt_f32 vcc, s40, v252
  s_cbranch_vccz L_nr_23
  s_call_b64 s[50:51], L_rescale1
L_nr_23:
  v_mfma_f32_16x16x32_bf16 v[160:163], v[96:99], v[64:67], v[212:215]
  v_exp_f32 v176, v176
  v_exp_f32 v177, v177
  v_mfma_f32_16x16x32_bf16 v[168:171], v[96:99], v[80:83], v[216:219]
  ds_read_b64_tr_b16 v[156:157], v235 offset:49152
  ds_read_b64_tr_b16 v[158:159], v235 offset:53248
  v_exp_f32 v178, v178
  v_mfma_f32_16x16x32_bf16 v[164:167], v[100:103], v[64:67], v[212:215]
  v_exp_f32 v179, v179
  v_cvt_pk_bf16_f32 v192, v176, v177
  v_mfma_f32_16x16x32_bf16 v[172:175], v[100:103], v[80:83], v[216:219]
  ds_read_b128 v[96:99], v200 offset:24576
  v_exp_f32 v180, v180
  v_mfma_f32_16x16x32_bf16 v[160:163], v[104:107], v[68:71], v[160:163]
  v_exp_f32 v181, v181
  v_cvt_pk_bf16_f32 v193, v178, v179
  v_mfma_f32_16x16x32_bf16 v[168:171], v[104:107], v[84:87], v[168:171]
  ds_read_b128 v[100:103], v200 offset:28672
  v_exp_f32 v182, v182
  v_mfma_f32_16x16x32_bf16 v[164:167], v[108:111], v[68:71], v[164:167]
  v_exp_f32 v183, v183
  v_cvt_pk_bf16_f32 v194, v180, v181
  v_mfma_f32_16x16x32_bf16 v[172:175], v[108:111], v[84:87], v[172:175]
  ds_read_b128 v[104:107], v201 offset:24576
  v_exp_f32 v184, v184
  v_mfma_f32_16x16x32_bf16 v[160:163], v[112:115], v[72:75], v[160:163]
  v_exp_f32 v185, v185
  v_cvt_pk_bf16_f32 v195, v182, v183
  v_mfma_f32_16x16x32_bf16 v[168:171], v[112:115], v[88:91], v[168:171]
  ds_read_b128 v[108:111], v201 offset:28672
  v_exp_f32 v186, v186
  s_waitcnt lgkmcnt(15)
  v_mfma_f32_16x16x32_bf16 v[164:167], v[116:119], v[72:75], v[164:167]
  v_exp_f32 v187, v187
  v_cvt_pk_bf16_f32 v196, v184, v185
  v_mfma_f32_16x16x32_bf16 v[172:175], v[116:119], v[88:91], v[172:175]
  ds_read_b128 v[112:115], v202 offset:24576
  v_exp_f32 v188, v188
  v_mfma_f32_16x16x32_bf16 v[160:163], v[120:123], v[76:79], v[160:163]
  v_exp_f32 v189, v189
  v_cvt_pk_bf16_f32 v197, v186, v187
  v_mfma_f32_16x16x32_bf16 v[168:171], v[120:123], v[92:95], v[168:171]
  ds_read_b128 v[116:119], v202 offset:28672
  v_exp_f32 v190, v190
  v_mfma_f32_16x16x32_bf16 v[164:167], v[124:127], v[76:79], v[164:167]
  v_exp_f32 v191, v191
  v_cvt_pk_bf16_f32 v198, v188, v189
  v_mfma_f32_16x16x32_bf16 v[172:175], v[124:127], v[92:95], v[172:175]
  ds_read_b128 v[120:123], v203 offset:24576
  v_cvt_pk_bf16_f32 v199, v190, v191
  ds_read_b128 v[236:239], v220
  v_mfma_f32_16x16x32_bf16 v[240:243], v[248:251], v[192:195], v[240:243]
  v_mfma_f32_16x16x32_bf16 v[244:247], v[248:251], v[196:199], v[244:247]
  ds_read_b128 v[124:127], v203 offset:28672
  v_mfma_f32_16x16x32_bf16 v[0:3], v[128:131], v[192:195], v[0:3]
  v_mfma_f32_16x16x32_bf16 v[32:35], v[128:131], v[196:199], v[32:35]
  v_mfma_f32_16x16x32_bf16 v[4:7], v[132:135], v[192:195], v[4:7]
  s_waitcnt lgkmcnt(0)
  v_mov_b32 v254, 13
  v_min3_u32 v255, v236, v237, v238
  s_mov_b32 s91, 14
  s_mov_b64 exec, 1
  ds_write_b32 v221, v254
  s_mov_b64 exec, -1
  v_min_u32 v255, v255, v239
  v_cmp_gt_u32 vcc, s91, v255
  s_cbranch_vccz L_fok_24
  s_call_b64 s[50:51], L_cspin
L_fok_24:
  v_mfma_f32_16x16x32_bf16 v[36:39], v[132:135], v[196:199], v[36:39]
  ds_read_b64_tr_b16 v[128:129], v204 offset:0
  ds_read_b64_tr_b16 v[130:131], v204 offset:4096
  v_mfma_f32_16x16x32_bf16 v[8:11], v[136:139], v[192:195], v[8:11]
  v_max3_f32 v252, v160, v161, v162
  v_mfma_f32_16x16x32_bf16 v[40:43], v[136:139], v[196:199], v[40:43]
  ds_read_b64_tr_b16 v[132:133], v205 offset:0
  ds_read_b64_tr_b16 v[134:135], v205 offset:4096
  v_max3_f32 v253, v163, v164, v165
  v_mfma_f32_16x16x32_bf16 v[12:15], v[140:143], v[192:195], v[12:15]
  v_mfma_f32_16x16x32_bf16 v[44:47], v[140:143], v[196:199], v[44:47]
  ds_read_b64_tr_b16 v[136:137], v206 offset:0
  ds_read_b64_tr_b16 v[138:139], v206 offset:4096
  v_max3_f32 v252, v252, v166, v167
  v_mfma_f32_16x16x32_bf16 v[16:19], v[144:147], v[192:195], v[16:19]
  v_max3_f32 v253, v253, v168, v169
  v_mfma_f32_16x16x32_bf16 v[48:51], v[144:147], v[196:199], v[48:51]
  ds_read_b64_tr_b16 v[140:141], v207 offset:0
  ds_read_b64_tr_b16 v[142:143], v207 offset:4096
  v_mfma_f32_16x16x32_bf16 v[20:23], v[148:151], v[192:195], v[20:23]
  v_max3_f32 v252, v252, v170, v171
  v_mfma_f32_16x16x32_bf16 v[52:55], v[148:151], v[196:199], v[52:55]
  ds_read_b64_tr_b16 v[144:145], v208 offset:0
  ds_read_b64_tr_b16 v[146:147], v208 offset:4096
  v_max3_f32 v253, v253, v172, v173
  v_mfma_f32_16x16x32_bf16 v[24:27], v[152:155], v[192:195], v[24:27]
  v_mfma_f32_16x16x32_bf16 v[56:59], v[152:155], v[196:199], v[56:59]
  ds_read_b64_tr_b16 v[148:149], v209 offset:0
  ds_read_b64_tr_b16 v[150:151], v209 offset:4096
  v_max3_f32 v252, v252, v174, v175
  v_mfma_f32_16x16x32_bf16 v[28:31], v[156:159], v[192:195], v[28:31]
  v_max_f32 v252, v252, v253
  v_mfma_f32_16x16x32_bf16 v[60:63], v[156:159], v[196:199], v[60:63]
  ds_read_b64_tr_b16 v[152:153], v210 offset:0
  ds_read_b64_tr_b16 v[154:155], v210 offset:4096
  v_cmp_lt_f32 vcc, s40, v252
  s_cbranch_vccz L_nr_24
  s_call_b64 s[50:51], L_rescale0
L_nr_24:
  v_mfma_f32_16x16x32_bf16 v[176:179], v[96:99], v[64:67], v[212:215]
  v_exp_f32 v160, v160
  v_exp_f32 v161, v161
  v_mfma_f32_16x16x32_bf16 v[184:187], v[96:99], v[80:83], v[216:219]
  ds_read_b64_tr_b16 v[156:157], v211 offset:0
  ds_read_b64_tr_b16 v[158:159], v211 offset:4096
  v_exp_f32 v162, v162
  v_mfma_f32_16x16x32_bf16 v[180:183], v[100:103], v[64:67], v[212:215]
  v_exp_f32 v163, v163
  v_cvt_pk_bf16_f32 v192, v160, v161
  v_mfma_f32_16x16x32_bf16 v[188:191], v[100:103], v[80:83], v[216:219]
  ds_read_b128 v[96:99], v200 offset:40960
  v_exp_f32 v164, v164
  v_mfma_f32_16x16x32_bf16 v[176:179], v[104:107], v[68:71], v[176:179]
  v_exp_f32 v165, v165
  v_cvt_pk_bf16_f32 v193, v162, v163
  v_mfma_f32_16x16x32_bf16 v[184:187], v[104:107], v[84:87], v[184:187]
  ds_read_b128 v[100:103], v200 offset:45056
  v_exp_f32 v166, v166
  v_mfma_f32_16x16x32_bf16 v[180:183], v[108:111], v[68:71], v[180:183]
  v_exp_f32 v167, v167
  v_cvt_pk_bf16_f32 v194, v164, v165
  v_mfma_f32_16x16x32_bf16 v[188:191], v[108:111], v[84:87], v[188:191]
  ds_read_b128 v[104:107], v201 offset:40960
  v_exp_f32 v168, v168
  v_mfma_f32_16x16x32_bf16 v[176:179], v[112:115], v[72:75], v[176:179]
  v_exp_f32 v169, v169
  v_cvt_pk_bf16_f32 v195, v166, v167
  v_mfma_f32_16x16x32_bf16 v[184:187], v[112:115], v[88:91], v[184:187]
  ds_read_b128 v[108:111], v201 offset:45056
  v_exp_f32 v170, v170
  v_mfma_f32_16x16x32_bf16 v[180:183], v[116:119], v[72:75], v[180:183]
  v_exp_f32 v171, v171
  v_cvt_pk_bf16_f32 v196, v168, v169
  v_mfma_f32_16x16x32_bf16 v[188:191], v[116:119], v[88:91], v[188:191]
  ds_read_b128 v[112:115], v202 offset:40960
  v_exp_f32 v172, v172
  v_mfma_f32_16x16x32_bf16 v[176:179], v[120:123], v[76:79], v[176:179]
  v_exp_f32 v173, v173
  v_cvt_pk_bf16_f32 v197, v170, v171
  v_mfma_f32_16x16x32_bf16 v[184:187], v[120:123], v[92:95], v[184:187]
  ds_read_b128 v[116:119], v202 offset:45056
  v_exp_f32 v174, v174
  v_mfma_f32_16x16x32_bf16 v[180:183], v[124:127], v[76:79], v[180:183]
  v_exp_f32 v175, v175
  v_cvt_pk_bf16_f32 v198, v172, v173
  v_mfma_f32_16x16x32_bf16 v[188:191], v[124:127], v[92:95], v[188:191]
  ds_read_b128 v[120:123], v203 offset:40960
  v_cvt_pk_bf16_f32 v199, v174, v175
  v_mfma_f32_16x16x32_bf16 v[240:243], v[248:251], v[192:195], v[240:243]
  s_nop 0
  v_mfma_f32_16x16x32_bf16 v[244:247], v[248:251], v[196:199], v[244:247]
  ds_read_b128 v[124:127], v203 offset:45056
  s_waitcnt lgkmcnt(15)
  v_mfma_f32_16x16x32_bf16 v[0:3], v[128:131], v[192:195], v[0:3]
  v_mfma_f32_16x16x32_bf16 v[32:35], v[128:131], v[196:199], v[32:35]
  v_mfma_f32_16x16x32_bf16 v[4:7], v[132:135], v[192:195], v[4:7]
  v_mfma_f32_16x16x32_bf16 v[36:39], v[132:135], v[196:199], v[36:39]
  ds_read_b64_tr_b16 v[128:129], v204 offset:16384
  ds_read_b64_tr_b16 v[130:131], v204 offset:20480
  v_mfma_f32_16x16x32_bf16 v[8:11], v[136:139], v[192:195], v[8:11]
  v_max3_f32 v252, v176, v177, v178
  v_mfma_f32_16x16x32_bf16 v[40:43], v[136:139], v[196:199], v[40:43]
  ds_read_b64_tr_b16 v[132:133], v205 offset:16384
  ds_read_b64_tr_b16 v[134:135], v205 offset:20480
  v_max3_f32 v253, v179, v180, v181
  v_mfma_f32_16x16x32_bf16 v[12:15], v[140:143], v[192:195], v[12:15]
  v_mfma_f32_16x16x32_bf16 v[44:47], v[140:143], v[196:199], v[44:47]
  ds_read_b64_tr_b16 v[136:137], v206 offset:16384
  ds_read_b64_tr_b16 v[138:139], v206 offset:20480
  v_max3_f32 v252, v252, v182, v183
  s_waitcnt lgkmcnt(15)
  v_mfma_f32_16x16x32_bf16 v[16:19], v[144:147], v[192:195], v[16:19]
  v_max3_f32 v253, v253, v184, v185
  v_mfma_f32_16x16x32_bf16 v[48:51], v[144:147], v[196:199], v[48:51]
  ds_read_b64_tr_b16 v[140:141], v207 offset:16384
  ds_read_b64_tr_b16 v[142:143], v207 offset:20480
  v_mfma_f32_16x16x32_bf16 v[20:23], v[148:151], v[192:195], v[20:23]
  v_max3_f32 v252, v252, v186, v187
  v_mfma_f32_16x16x32_bf16 v[52:55], v[148:151], v[196:199], v[52:55]
  ds_read_b64_tr_b16 v[144:145], v208 offset:16384
  ds_read_b64_tr_b16 v[146:147], v208 offset:20480
  v_max3_f32 v253, v253, v188, v189
  v_mfma_f32_16x16x32_bf16 v[24:27], v[152:155], v[192:195], v[24:27]
  v_mfma_f32_16x16x32_bf16 v[56:59], v[152:155], v[196:199], v[56:59]
  ds_read_b64_tr_b16 v[148:149], v209 offset:16384
  ds_read_b64_tr_b16 v[150:151], v209 offset:20480
  v_max3_f32 v252, v252, v190, v191
  s_waitcnt lgkmcnt(15)
  v_mfma_f32_16x16x32_bf16 v[28:31], v[156:159], v[192:195], v[28:31]
  v_max_f32 v252, v252, v253
  v_mfma_f32_16x16x32_bf16 v[60:63], v[156:159], v[196:199], v[60:63]
  ds_read_b64_tr_b16 v[152:153], v210 offset:16384
  ds_read_b64_tr_b16 v[154:155], v210 offset:20480
  v_cmp_lt_f32 vcc, s40, v252
  s_cbranch_vccz L_nr_25
  s_call_b64 s[50:51], L_rescale1
L_nr_25:
  v_mfma_f32_16x16x32_bf16 v[160:163], v[96:99], v[64:67], v[212:215]
  v_exp_f32 v176, v176
  v_exp_f32 v177, v177
  v_mfma_f32_16x16x32_bf16 v[168:171], v[96:99], v[80:83], v[216:219]
  ds_read_b64_tr_b16 v[156:157], v211 offset:16384
  ds_read_b64_tr_b16 v[158:159], v211 offset:20480
  v_exp_f32 v178, v178
  v_mfma_f32_16x16x32_bf16 v[164:167], v[100:103], v[64:67], v[212:215]
  v_exp_f32 v179, v179
  v_cvt_pk_bf16_f32 v192, v176, v177
  v_mfma_f32_16x16x32_bf16 v[172:175], v[100:103], v[80:83], v[216:219]
  ds_read_b128 v[96:99], v200 offset:57344
  v_exp_f32 v180, v180
  v_mfma_f32_16x16x32_bf16 v[160:163], v[104:107], v[68:71], v[160:163]
  v_exp_f32 v181, v181
  v_cvt_pk_bf16_f32 v193, v178, v179
  v_mfma_f32_16x16x32_bf16 v[168:171], v[104:107], v[84:87], v[168:171]
  ds_read_b128 v[100:103], v200 offset:61440
  v_exp_f32 v182, v182
  v_mfma_f32_16x16x32_bf16 v[164:167], v[108:111], v[68:71], v[164:167]
  v_exp_f32 v183, v183
  v_cvt_pk_bf16_f32 v194, v180, v181
  v_mfma_f32_16x16x32_bf16 v[172:175], v[108:111], v[84:87], v[172:175]
  ds_read_b128 v[104:107], v201 offset:57344
  v_exp_f32 v184, v184
  v_mfma_f32_16x16x32_bf16 v[160:163], v[112:115], v[72:75], v[160:163]
  v_exp_f32 v185, v185
  v_cvt_pk_bf16_f32 v195, v182, v183
  v_mfma_f32_16x16x32_bf16 v[168:171], v[112:115], v[88:91], v[168:171]
  ds_read_b128 v[108:111], v201 offset:61440
  v_exp_f32 v186, v186
  s_waitcnt lgkmcnt(15)
  v_mfma_f32_16x16x32_bf16 v[164:167], v[116:119], v[72:75], v[164:167]
  v_exp_f32 v187, v187
  v_cvt_pk_bf16_f32 v196, v184, v185
  v_mfma_f32_16x16x32_bf16 v[172:175], v[116:119], v[88:91], v[172:175]
  ds_read_b128 v[112:115], v202 offset:57344
  v_exp_f32 v188, v188
  v_mfma_f32_16x16x32_bf16 v[160:163], v[120:123], v[76:79], v[160:163]
  v_exp_f32 v189, v189
  v_cvt_pk_bf16_f32 v197, v186, v187
  v_mfma_f32_16x16x32_bf16 v[168:171], v[120:123], v[92:95], v[168:171]
  ds_read_b128 v[116:119], v202 offset:61440
  v_exp_f32 v190, v190
  v_mfma_f32_16x16x32_bf16 v[164:167], v[124:127], v[76:79], v[164:167]
  v_exp_f32 v191, v191
  v_cvt_pk_bf16_f32 v198, v188, v189
  v_mfma_f32_16x16x32_bf16 v[172:175], v[124:127], v[92:95], v[172:175]
  ds_read_b128 v[120:123], v203 offset:57344
  v_cvt_pk_bf16_f32 v199, v190, v191
  ds_read_b128 v[236:239], v220
  v_mfma_f32_16x16x32_bf16 v[240:243], v[248:251], v[192:195], v[240:243]
  v_mfma_f32_16x16x32_bf16 v[244:247], v[248:251], v[196:199], v[244:247]
  ds_read_b128 v[124:127], v203 offset:61440
  v_mfma_f32_16x16x32_bf16 v[0:3], v[128:131], v[192:195], v[0:3]
  v_mfma_f32_16x16x32_bf16 v[32:35], v[128:131], v[196:199], v[32:35]
  v_mfma_f32_16x16x32_bf16 v[4:7], v[132:135], v[192:195], v[4:7]
  s_waitcnt lgkmcnt(0)
  v_mov_b32 v254, 14
  v_min3_u32 v255, v236, v237, v238
  s_mov_b32 s91, 15
  s_mov_b64 exec, 1
  ds_write_b32 v221, v254
  s_mov_b64 exec, -1
  v_min_u32 v255, v255, v239
  v_cmp_gt_u32 vcc, s91, v255
  s_cbranch_vccz L_fok_26
  s_call_b64 s[50:51], L_cspin
L_fok_26:
  v_mfma_f32_16x16x32_bf16 v[36:39], v[132:135], v[196:199], v[36:39]
  ds_read_b64_tr_b16 v[128:129], v204 offset:32768
  ds_read_b64_tr_b16 v[130:131], v204 offset:36864
  v_mfma_f32_16x16x32_bf16 v[8:11], v[136:139], v[192:195], v[8:11]
  v_max3_f32 v252, v160, v161, v162
  v_mfma_f32_16x16x32_bf16 v[40:43], v[136:139], v[196:199], v[40:43]
  ds_read_b64_tr_b16 v[132:133], v205 offset:32768
  ds_read_b64_tr_b16 v[134:135], v205 offset:36864
  v_max3_f32 v253, v163, v164, v165
  v_mfma_f32_16x16x32_bf16 v[12:15], v[140:143], v[192:195], v[12:15]
  v_mfma_f32_16x16x32_bf16 v[44:47], v[140:143], v[196:199], v[44:47]
  ds_read_b64_tr_b16 v[136:137], v206 offset:32768
  ds_read_b64_tr_b16 v[138:139], v206 offset:36864
  v_max3_f32 v252, v252, v166, v167
  v_mfma_f32_16x16x32_bf16 v[16:19], v[144:147], v[192:195], v[16:19]
  v_max3_f32 v253, v253, v168, v169
  v_mfma_f32_16x16x32_bf16 v[48:51], v[144:147], v[196:199], v[48:51]
  ds_read_b64_tr_b16 v[140:141], v207 offset:32768
  ds_read_b64_tr_b16 v[142:143], v207 offset:36864
  v_mfma_f32_16x16x32_bf16 v[20:23], v[148:151], v[192:195], v[20:23]
  v_max3_f32 v252, v252, v170, v171
  v_mfma_f32_16x16x32_bf16 v[52:55], v[148:151], v[196:199], v[52:55]
  ds_read_b64_tr_b16 v[144:145], v208 offset:32768
  ds_read_b64_tr_b16 v[146:147], v208 offset:36864
  v_max3_f32 v253, v253, v172, v173
  v_mfma_f32_16x16x32_bf16 v[24:27], v[152:155], v[192:195], v[24:27]
  v_mfma_f32_16x16x32_bf16 v[56:59], v[152:155], v[196:199], v[56:59]
  ds_read_b64_tr_b16 v[148:149], v209 offset:32768
  ds_read_b64_tr_b16 v[150:151], v209 offset:36864
  v_max3_f32 v252, v252, v174, v175
  v_mfma_f32_16x16x32_bf16 v[28:31], v[156:159], v[192:195], v[28:31]
  v_max_f32 v252, v252, v253
  v_mfma_f32_16x16x32_bf16 v[60:63], v[156:159], v[196:199], v[60:63]
  ds_read_b64_tr_b16 v[152:153], v210 offset:32768
  ds_read_b64_tr_b16 v[154:155], v210 offset:36864
  v_cmp_lt_f32 vcc, s40, v252
  s_cbranch_vccz L_nr_26
  s_call_b64 s[50:51], L_rescale0
L_nr_26:
  v_mfma_f32_16x16x32_bf16 v[176:179], v[96:99], v[64:67], v[212:215]
  v_exp_f32 v160, v160
  v_exp_f32 v161, v161
  v_mfma_f32_16x16x32_bf16 v[184:187], v[96:99], v[80:83], v[216:219]
  ds_read_b64_tr_b16 v[156:157], v211 offset:32768
  ds_read_b64_tr_b16 v[158:159], v211 offset:36864
  v_exp_f32 v162, v162
  v_mfma_f32_16x16x32_bf16 v[180:183], v[100:103], v[64:67], v[212:215]
  v_exp_f32 v163, v163
  v_cvt_pk_bf16_f32 v192, v160, v161
  v_mfma_f32_16x16x32_bf16 v[188:191], v[100:103], v[80:83], v[216:219]
  ds_read_b128 v[96:99], v224 offset:8192
  v_exp_f32 v164, v164
  v_mfma_f32_16x16x32_bf16 v[176:179], v[104:107], v[68:71], v[176:179]
  v_exp_f32 v165, v165
  v_cvt_pk_bf16_f32 v193, v162, v163
  v_mfma_f32_16x16x32_bf16 v[184:187], v[104:107], v[84:87], v[184:187]
  ds_read_b128 v[100:103], v224 offset:12288
  v_exp_f32 v166, v166
  v_mfma_f32_16x16x32_bf16 v[180:183], v[108:111], v[68:71], v[180:183]
  v_exp_f32 v167, v167
  v_cvt_pk_bf16_f32 v194, v164, v165
  v_mfma_f32_16x16x32_bf16 v[188:191], v[108:111], v[84:87], v[188:191]
  ds_read_b128 v[104:107], v225 offset:8192
  v_exp_f32 v168, v168
  v_mfma_f32_16x16x32_bf16 v[176:179], v[112:115], v[72:75], v[176:179]
  v_exp_f32 v169, v169
  v_cvt_pk_bf16_f32 v195, v166, v167
  v_mfma_f32_16x16x32_bf16 v[184:187], v[112:115], v[88:91], v[184:187]
  ds_read_b128 v[108:111], v225 offset:12288
  v_exp_f32 v170, v170
  v_mfma_f32_16x16x32_bf16 v[180:183], v[116:119], v[72:75], v[180:183]
  v_exp_f32 v171, v171
  v_cvt_pk_bf16_f32 v196, v168, v169
  v_mfma_f32_16x16x32_bf16 v[188:191], v[116:119], v[88:91], v[188:191]
  ds_read_b128 v[112:115], v226 offset:8192
  v_exp_f32 v172, v172
  v_mfma_f32_16x16x32_bf16 v[176:179], v[120:123], v[76:79], v[176:179]
  v_exp_f32 v173, v173
  v_cvt_pk_bf16_f32 v197, v170, v171
  v_mfma_f32_16x16x32_bf16 v[184:187], v[120:123], v[92:95], v[184:187]
  ds_read_b128 v[116:119], v226 offset:12288
  v_exp_f32 v174, v174
  v_mfma_f32_16x16x32_bf16 v[180:183], v[124:127], v[76:79], v[180:183]
  v_exp_f32 v175, v175
  v_cvt_pk_bf16_f32 v198, v172, v173
  v_mfma_f32_16x16x32_bf16 v[188:191], v[124:127], v[92:95], v[188:191]
  ds_read_b128 v[120:123], v227 offset:8192
  v_cvt_pk_bf16_f32 v199, v174, v175
  v_mfma_f32_16x16x32_bf16 v[240:243], v[248:251], v[192:195], v[240:243]
  s_nop 0
  v_mfma_f32_16x16x32_bf16 v[244:247], v[248:251], v[196:199], v[244:247]
  ds_read_b128 v[124:127], v227 offset:12288
  s_waitcnt lgkmcnt(15)
  v_mfma_f32_16x16x32_bf16 v[0:3], v[128:131], v[192:195], v[0:3]
  v_mfma_f32_16x16x32_bf16 v[32:35], v[128:131], v[196:199], v[32:35]
  v_mfma_f32_16x16x32_bf16 v[4:7], v[132:135], v[192:195], v[4:7]
  v_mfma_f32_16x16x32_bf16 v[36:39], v[132:135], v[196:199], v[36:39]
  ds_read_b64_tr_b16 v[128:129], v204 offset:49152
  ds_read_b64_tr_b16 v[130:131], v204 offset:53248
  v_mfma_f32_16x16x32_bf16 v[8:11], v[136:139], v[192:195], v[8:11]
  v_max3_f32 v252, v176, v177, v178
  v_mfma_f32_16x16x32_bf16 v[40:43], v[136:139], v[196:199], v[40:43]
  ds_read_b64_tr_b16 v[132:133], v205 offset:49152
  ds_read_b64_tr_b16 v[134:135], v205 offset:53248
  v_max3_f32 v253, v179, v180, v181
  v_mfma_f32_16x16x32_bf16 v[12:15], v[140:143], v[192:195], v[12:15]
  v_mfma_f32_16x16x32_bf16 v[44:47], v[140:143], v[196:199], v[44:47]
  ds_read_b64_tr_b16 v[136:137], v206 offset:49152
  ds_read_b64_tr_b16 v[138:139], v206 offset:53248
  v_max3_f32 v252, v252, v182, v183
  s_waitcnt lgkmcnt(15)
  v_mfma_f32_16x16x32_bf16 v[16:19], v[144:147], v[192:195], v[16:19]
  v_max3_f32 v253, v253, v184, v185
  v_mfma_f32_16x16x32_bf16 v[48:51], v[144:147], v[196:199], v[48:51]
  ds_read_b64_tr_b16 v[140:141], v207 offset:49152
  ds_read_b64_tr_b16 v[142:143], v207 offset:53248
  v_mfma_f32_16x16x32_bf16 v[20:23], v[148:151], v[192:195], v[20:23]
  v_max3_f32 v252, v252, v186, v187
  v_mfma_f32_16x16x32_bf16 v[52:55], v[148:151], v[196:199], v[52:55]
  ds_read_b64_tr_b16 v[144:145], v208 offset:49152
  ds_read_b64_tr_b16 v[146:147], v208 offset:53248
  v_max3_f32 v253, v253, v188, v189
  v_mfma_f32_16x16x32_bf16 v[24:27], v[152:155], v[192:195], v[24:27]
  v_mfma_f32_16x16x32_bf16 v[56:59], v[152:155], v[196:199], v[56:59]
  ds_read_b64_tr_b16 v[148:149], v209 offset:49152
  ds_read_b64_tr_b16 v[150:151], v209 offset:53248
  v_max3_f32 v252, v252, v190, v191
  s_waitcnt lgkmcnt(15)
  v_mfma_f32_16x16x32_bf16 v[28:31], v[156:159], v[192:195], v[28:31]
  v_max_f32 v252, v252, v253
  v_mfma_f32_16x16x32_bf16 v[60:63], v[156:159], v[196:199], v[60:63]
  ds_read_b64_tr_b16 v[152:153], v210 offset:49152
  ds_read_b64_tr_b16 v[154:155], v210 offset:53248
  v_cmp_lt_f32 vcc, s40, v252
  s_cbranch_vccz L_nr_27
  s_call_b64 s[50:51], L_rescale1
L_nr_27:
  v_mfma_f32_16x16x32_bf16 v[160:163], v[96:99], v[64:67], v[212:215]
  v_exp_f32 v176, v176
  v_exp_f32 v177, v177
  v_mfma_f32_16x16x32_bf16 v[168:171], v[96:99], v[80:83], v[216:219]
  ds_read_b64_tr_b16 v[156:157], v211 offset:49152
  ds_read_b64_tr_b16 v[158:159], v211 offset:53248
  v_exp_f32 v178, v178
  v_mfma_f32_16x16x32_bf16 v[164:167], v[100:103], v[64:67], v[212:215]
  v_exp_f32 v179, v179
  v_cvt_pk_bf16_f32 v192, v176, v177
  v_mfma_f32_16x16x32_bf16 v[172:175], v[100:103], v[80:83], v[216:219]
  ds_read_b128 v[96:99], v224 offset:24576
  v_exp_f32 v180, v180
  v_mfma_f32_16x16x32_bf16 v[160:163], v[104:107], v[68:71], v[160:163]
  v_exp_f32 v181, v181
  v_cvt_pk_bf16_f32 v193, v178, v179
  v_mfma_f32_16x16x32_bf16 v[168:171], v[104:107], v[84:87], v[168:171]
  ds_read_b128 v[100:103], v224 offset:28672
  v_exp_f32 v182, v182
  v_mfma_f32_16x16x32_bf16 v[164:167], v[108:111], v[68:71], v[164:167]
  v_exp_f32 v183, v183
  v_cvt_pk_bf16_f32 v194, v180, v181
  v_mfma_f32_16x16x32_bf16 v[172:175], v[108:111], v[84:87], v[172:175]
  ds_read_b128 v[104:107], v225 offset:24576
  v_exp_f32 v184, v184
  v_mfma_f32_16x16x32_bf16 v[160:163], v[112:115], v[72:75], v[160:163]
  v_exp_f32 v185, v185
  v_cvt_pk_bf16_f32 v195, v182, v183
  v_mfma_f32_16x16x32_bf16 v[168:171], v[112:115], v[88:91], v[168:171]
  ds_read_b128 v[108:111], v225 offset:28672
  v_exp_f32 v186, v186
  s_waitcnt lgkmcnt(15)
  v_mfma_f32_16x16x32_bf16 v[164:167], v[116:119], v[72:75], v[164:167]
  v_exp_f32 v187, v187
  v_cvt_pk_bf16_f32 v196, v184, v185
  v_mfma_f32_16x16x32_bf16 v[172:175], v[116:119], v[88:91], v[172:175]
  ds_read_b128 v[112:115], v226 offset:24576
  v_exp_f32 v188, v188
  v_mfma_f32_16x16x32_bf16 v[160:163], v[120:123], v[76:79], v[160:163]
  v_exp_f32 v189, v189
  v_cvt_pk_bf16_f32 v197, v186, v187
  v_mfma_f32_16x16x32_bf16 v[168:171], v[120:123], v[92:95], v[168:171]
  ds_read_b128 v[116:119], v226 offset:28672
  v_exp_f32 v190, v190
  v_mfma_f32_16x16x32_bf16 v[164:167], v[124:127], v[76:79], v[164:167]
  v_exp_f32 v191, v191
  v_cvt_pk_bf16_f32 v198, v188, v189
  v_mfma_f32_16x16x32_bf16 v[172:175], v[124:127], v[92:95], v[172:175]
  ds_read_b128 v[120:123], v227 offset:24576
  v_cvt_pk_bf16_f32 v199, v190, v191
  ds_read_b128 v[236:239], v220
  v_mfma_f32_16x16x32_bf16 v[240:243], v[248:251], v[192:195], v[240:243]
  v_mfma_f32_16x16x32_bf16 v[244:247], v[248:251], v[196:199], v[244:247]
  ds_read_b128 v[124:127], v227 offset:28672
  v_mfma_f32_16x16x32_bf16 v[0:3], v[128:131], v[192:195], v[0:3]
  v_mfma_f32_16x16x32_bf16 v[32:35], v[128:131], v[196:199], v[32:35]
  v_mfma_f32_16x16x32_bf16 v[4:7], v[132:135], v[192:195], v[4:7]
  s_waitcnt lgkmcnt(0)
  v_mov_b32 v254, 15
  v_min3_u32 v255, v236, v237, v238
  s_mov_b32 s91, 16
  s_mov_b64 exec, 1
  ds_write_b32 v221, v254
  s_mov_b64 exec, -1
  v_min_u32 v255, v255, v239
  v_cmp_gt_u32 vcc, s91, v255
  s_cbranch_vccz L_fok_28
  s_call_b64 s[50:51], L_cspin
L_fok_28:
  v_mfma_f32_16x16x32_bf16 v[36:39], v[132:135], v[196:199], v[36:39]
  ds_read_b64_tr_b16 v[128:129], v228 offset:0
  ds_read_b64_tr_b16 v[130:131], v228 offset:4096
  v_mfma_f32_16x16x32_bf16 v[8:11], v[136:139], v[192:195], v[8:11]
  v_max3_f32 v252, v160, v161, v162
  v_mfma_f32_16x16x32_bf16 v[40:43], v[136:139], v[196:199], v[40:43]
  ds_read_b64_tr_b16 v[132:133], v229 offset:0
  ds_read_b64_tr_b16 v[134:135], v229 offset:4096
  v_max3_f32 v253, v163, v164, v165
  v_mfma_f32_16x16x32_bf16 v[12:15], v[140:143], v[192:195], v[12:15]
  v_mfma_f32_16x16x32_bf16 v[44:47], v[140:143], v[196:199], v[44:47]
  ds_read_b64_tr_b16 v[136:137], v230 offset:0
  ds_read_b64_tr_b16 v[138:139], v230 offset:4096
  v_max3_f32 v252, v252, v166, v167
  v_mfma_f32_16x16x32_bf16 v[16:19], v[144:147], v[192:195], v[16:19]
  v_max3_f32 v253, v253, v168, v169
  v_mfma_f32_16x16x32_bf16 v[48:51], v[144:147], v[196:199], v[48:51]
  ds_read_b64_tr_b16 v[140:141], v231 offset:0
  ds_read_b64_tr_b16 v[142:143], v231 offset:4096
  v_mfma_f32_16x16x32_bf16 v[20:23], v[148:151], v[192:195], v[20:23]
  v_max3_f32 v252, v252, v170, v171
  v_mfma_f32_16x16x32_bf16 v[52:55], v[148:151], v[196:199], v[52:55]
  ds_read_b64_tr_b16 v[144:145], v232 offset:0
  ds_read_b64_tr_b16 v[146:147], v232 offset:4096
  v_max3_f32 v253, v253, v172, v173
  v_mfma_f32_16x16x32_bf16 v[24:27], v[152:155], v[192:195], v[24:27]
  v_mfma_f32_16x16x32_bf16 v[56:59], v[152:155], v[196:199], v[56:59]
  ds_read_b64_tr_b16 v[148:149], v233 offset:0
  ds_read_b64_tr_b16 v[150:151], v233 offset:4096
  v_max3_f32 v252, v252, v174, v175
  v_mfma_f32_16x16x32_bf16 v[28:31], v[156:159], v[192:195], v[28:31]
  v_max_f32 v252, v252, v253
  v_mfma_f32_16x16x32_bf16 v[60:63], v[156:159], v[196:199], v[60:63]
  ds_read_b64_tr_b16 v[152:153], v234 offset:0
  ds_read_b64_tr_b16 v[154:155], v234 offset:4096
  v_cmp_lt_f32 vcc, s40, v252
  s_cbranch_vccz L_nr_28
  s_call_b64 s[50:51], L_rescale0
L_nr_28:
  v_mfma_f32_16x16x32_bf16 v[176:179], v[96:99], v[64:67], v[212:215]
  v_exp_f32 v160, v160
  v_exp_f32 v161, v161
  v_mfma_f32_16x16x32_bf16 v[184:187], v[96:99], v[80:83], v[216:219]
  ds_read_b64_tr_b16 v[156:157], v235 offset:0
  ds_read_b64_tr_b16 v[158:159], v235 offset:4096
  v_exp_f32 v162, v162
  v_mfma_f32_16x16x32_bf16 v[180:183], v[100:103], v[64:67], v[212:215]
  v_exp_f32 v163, v163
  v_cvt_pk_bf16_f32 v192, v160, v161
  v_mfma_f32_16x16x32_bf16 v[188:191], v[100:103], v[80:83], v[216:219]
  ds_read_b128 v[96:99], v224 offset:40960
  v_exp_f32 v164, v164
  v_mfma_f32_16x16x32_bf16 v[176:179], v[104:107], v[68:71], v[176:179]
  v_exp_f32 v165, v165
  v_cvt_pk_bf16_f32 v193, v162, v163
  v_mfma_f32_16x16x32_bf16 v[184:187], v[104:107], v[84:87], v[184:187]
  ds_read_b128 v[100:103], v224 offset:45056
  v_exp_f32 v166, v166
  v_mfma_f32_16x16x32_bf16 v[180:183], v[108:111], v[68:71], v[180:183]
  v_exp_f32 v167, v167
  v_cvt_pk_bf16_f32 v194, v164, v165
  v_mfma_f32_16x16x32_bf16 v[188:191], v[108:111], v[84:87], v[188:191]
  ds_read_b128 v[104:107], v225 offset:40960
  v_exp_f32 v168, v168
  v_mfma_f32_16x16x32_bf16 v[176:179], v[112:115], v[72:75], v[176:179]
  v_exp_f32 v169, v169
  v_cvt_pk_bf16_f32 v195, v166, v167
  v_mfma_f32_16x16x32_bf16 v[184:187], v[112:115], v[88:91], v[184:187]
  ds_read_b128 v[108:111], v225 offset:45056
  v_exp_f32 v170, v170
  v_mfma_f32_16x16x32_bf16 v[180:183], v[116:119], v[72:75], v[180:183]
  v_exp_f32 v171, v171
  v_cvt_pk_bf16_f32 v196, v168, v169
  v_mfma_f32_16x16x32_bf16 v[188:191], v[116:119], v[88:91], v[188:191]
  ds_read_b128 v[112:115], v226 offset:40960
  v_exp_f32 v172, v172
  v_mfma_f32_16x16x32_bf16 v[176:179], v[120:123], v[76:79], v[176:179]
  v_exp_f32 v173, v173
  v_cvt_pk_bf16_f32 v197, v170, v171
  v_mfma_f32_16x16x32_bf16 v[184:187], v[120:123], v[92:95], v[184:187]
  ds_read_b128 v[116:119], v226 offset:45056
  v_exp_f32 v174, v174
  v_mfma_f32_16x16x32_bf16 v[180:183], v[124:127], v[76:79], v[180:183]
  v_exp_f32 v175, v175
  v_cvt_pk_bf16_f32 v198, v172, v173
  v_mfma_f32_16x16x32_bf16 v[188:191], v[124:127], v[92:95], v[188:191]
  ds_read_b128 v[120:123], v227 offset:40960
  v_cvt_pk_bf16_f32 v199, v174, v175
  v_mfma_f32_16x16x32_bf16 v[240:243], v[248:251], v[192:195], v[240:243]
  s_nop 0
  v_mfma_f32_16x16x32_bf16 v[244:247], v[248:251], v[196:199], v[244:247]
  ds_read_b128 v[124:127], v227 offset:45056
  s_waitcnt lgkmcnt(15)
  v_mfma_f32_16x16x32_bf16 v[0:3], v[128:131], v[192:195], v[0:3]
  v_mfma_f32_16x16x32_bf16 v[32:35], v[128:131], v[196:199], v[32:35]
  v_mfma_f32_16x16x32_bf16 v[4:7], v[132:135], v[192:195], v[4:7]
  v_mfma_f32_16x16x32_bf16 v[36:39], v[132:135], v[196:199], v[36:39]
  ds_read_b64_tr_b16 v[128:129], v228 offset:16384
  ds_read_b64_tr_b16 v[130:131], v228 offset:20480
  v_mfma_f32_16x16x32_bf16 v[8:11], v[136:139], v[192:195], v[8:11]
  v_max3_f32 v252, v176, v177, v178
  v_mfma_f32_16x16x32_bf16 v[40:43], v[136:139], v[196:199], v[40:43]
  ds_read_b64_tr_b16 v[132:133], v229 offset:16384
  ds_read_b64_tr_b16 v[134:135], v229 offset:20480
  v_max3_f32 v253, v179, v180, v181
  v_mfma_f32_16x16x32_bf16 v[12:15], v[140:143], v[192:195], v[12:15]
  v_mfma_f32_16x16x32_bf16 v[44:47], v[140:143], v[196:199], v[44:47]
  ds_read_b64_tr_b16 v[136:137], v230 offset:16384
  ds_read_b64_tr_b16 v[138:139], v230 offset:20480
  v_max3_f32 v252, v252, v182, v183
  s_waitcnt lgkmcnt(15)
  v_mfma_f32_16x16x32_bf16 v[16:19], v[144:147], v[192:195], v[16:19]
  v_max3_f32 v253, v253, v184, v185
  v_mfma_f32_16x16x32_bf16 v[48:51], v[144:147], v[196:199], v[48:51]
  ds_read_b64_tr_b16 v[140:141], v231 offset:16384
  ds_read_b64_tr_b16 v[142:143], v231 offset:20480
  v_mfma_f32_16x16x32_bf16 v[20:23], v[148:151], v[192:195], v[20:23]
  v_max3_f32 v252, v252, v186, v187
  v_mfma_f32_16x16x32_bf16 v[52:55], v[148:151], v[196:199], v[52:55]
  ds_read_b64_tr_b16 v[144:145], v232 offset:16384
  ds_read_b64_tr_b16 v[146:147], v232 offset:20480
  v_max3_f32 v253, v253, v188, v189
  v_mfma_f32_16x16x32_bf16 v[24:27], v[152:155], v[192:195], v[24:27]
  v_mfma_f32_16x16x32_bf16 v[56:59], v[152:155], v[196:199], v[56:59]
  ds_read_b64_tr_b16 v[148:149], v233 offset:16384
  ds_read_b64_tr_b16 v[150:151], v233 offset:20480
  v_max3_f32 v252, v252, v190, v191
  s_waitcnt lgkmcnt(15)
  v_mfma_f32_16x16x32_bf16 v[28:31], v[156:159], v[192:195], v[28:31]
  v_max_f32 v252, v252, v253
  v_mfma_f32_16x16x32_bf16 v[60:63], v[156:159], v[196:199], v[60:63]
  ds_read_b64_tr_b16 v[152:153], v234 offset:16384
  ds_read_b64_tr_b16 v[154:155], v234 offset:20480
  v_cmp_lt_f32 vcc, s40, v252
  s_cbranch_vccz L_nr_29
  s_call_b64 s[50:51], L_rescale1
L_nr_29:
  v_mfma_f32_16x16x32_bf16 v[160:163], v[96:99], v[64:67], v[212:215]
  v_exp_f32 v176, v176
  v_exp_f32 v177, v177
  v_mfma_f32_16x16x32_bf16 v[168:171], v[96:99], v[80:83], v[216:219]
  ds_read_b64_tr_b16 v[156:157], v235 offset:16384
  ds_read_b64_tr_b16 v[158:159], v235 offset:20480
  v_exp_f32 v178, v178
  v_mfma_f32_16x16x32_bf16 v[164:167], v[100:103], v[64:67], v[212:215]
  v_exp_f32 v179, v179
  v_cvt_pk_bf16_f32 v192, v176, v177
  v_mfma_f32_16x16x32_bf16 v[172:175], v[100:103], v[80:83], v[216:219]
  ds_read_b128 v[96:99], v224 offset:57344
  v_exp_f32 v180, v180
  v_mfma_f32_16x16x32_bf16 v[160:163], v[104:107], v[68:71], v[160:163]
  v_exp_f32 v181, v181
  v_cvt_pk_bf16_f32 v193, v178, v179
  v_mfma_f32_16x16x32_bf16 v[168:171], v[104:107], v[84:87], v[168:171]
  ds_read_b128 v[100:103], v224 offset:61440
  v_exp_f32 v182, v182
  v_mfma_f32_16x16x32_bf16 v[164:167], v[108:111], v[68:71], v[164:167]
  v_exp_f32 v183, v183
  v_cvt_pk_bf16_f32 v194, v180, v181
  v_mfma_f32_16x16x32_bf16 v[172:175], v[108:111], v[84:87], v[172:175]
  ds_read_b128 v[104:107], v225 offset:57344
  v_exp_f32 v184, v184
  v_mfma_f32_16x16x32_bf16 v[160:163], v[112:115], v[72:75], v[160:163]
  v_exp_f32 v185, v185
  v_cvt_pk_bf16_f32 v195, v182, v183
  v_mfma_f32_16x16x32_bf16 v[168:171], v[112:115], v[88:91], v[168:171]
  ds_read_b128 v[108:111], v225 offset:61440
  v_exp_f32 v186, v186
  s_waitcnt lgkmcnt(15)
  v_mfma_f32_16x16x32_bf16 v[164:167], v[116:119], v[72:75], v[164:167]
  v_exp_f32 v187, v187
  v_cvt_pk_bf16_f32 v196, v184, v185
  v_mfma_f32_16x16x32_bf16 v[172:175], v[116:119], v[88:91], v[172:175]
  ds_read_b128 v[112:115], v226 offset:57344
  v_exp_f32 v188, v188
  v_mfma_f32_16x16x32_bf16 v[160:163], v[120:123], v[76:79], v[160:163]
  v_exp_f32 v189, v189
  v_cvt_pk_bf16_f32 v197, v186, v187
  v_mfma_f32_16x16x32_bf16 v[168:171], v[120:123], v[92:95], v[168:171]
  ds_read_b128 v[116:119], v226 offset:61440
  v_exp_f32 v190, v190
  v_mfma_f32_16x16x32_bf16 v[164:167], v[124:127], v[76:79], v[164:167]
  v_exp_f32 v191, v191
  v_cvt_pk_bf16_f32 v198, v188, v189
  v_mfma_f32_16x16x32_bf16 v[172:175], v[124:127], v[92:95], v[172:175]
  ds_read_b128 v[120:123], v227 offset:57344
  v_cvt_pk_bf16_f32 v199, v190, v191
  ds_read_b128 v[236:239], v220
  v_mfma_f32_16x16x32_bf16 v[240:243], v[248:251], v[192:195], v[240:243]
  v_mfma_f32_16x16x32_bf16 v[244:247], v[248:251], v[196:199], v[244:247]
  ds_read_b128 v[124:127], v227 offset:61440
  v_mfma_f32_16x16x32_bf16 v[0:3], v[128:131], v[192:195], v[0:3]
  v_mfma_f32_16x16x32_bf16 v[32:35], v[128:131], v[196:199], v[32:35]
  v_mfma_f32_16x16x32_bf16 v[4:7], v[132:135], v[192:195], v[4:7]
  s_waitcnt lgkmcnt(0)
  v_mov_b32 v254, 16
  v_min3_u32 v255, v236, v237, v238
  s_mov_b32 s91, 17
  s_mov_b64 exec, 1
  ds_write_b32 v221, v254
  s_mov_b64 exec, -1
  v_min_u32 v255, v255, v239
  v_cmp_gt_u32 vcc, s91, v255
  s_cbranch_vccz L_fok_30
  s_call_b64 s[50:51], L_cspin
L_fok_30:
  v_mfma_f32_16x16x32_bf16 v[36:39], v[132:135], v[196:199], v[36:39]
  ds_read_b64_tr_b16 v[128:129], v228 offset:32768
  ds_read_b64_tr_b16 v[130:131], v228 offset:36864
  v_mfma_f32_16x16x32_bf16 v[8:11], v[136:139], v[192:195], v[8:11]
  v_max3_f32 v252, v160, v161, v162
  v_mfma_f32_16x16x32_bf16 v[40:43], v[136:139], v[196:199], v[40:43]
  ds_read_b64_tr_b16 v[132:133], v229 offset:32768
  ds_read_b64_tr_b16 v[134:135], v229 offset:36864
  v_max3_f32 v253, v163, v164, v165
  v_mfma_f32_16x16x32_bf16 v[12:15], v[140:143], v[192:195], v[12:15]
  v_mfma_f32_16x16x32_bf16 v[44:47], v[140:143], v[196:199], v[44:47]
  ds_read_b64_tr_b16 v[136:137], v230 offset:32768
  ds_read_b64_tr_b16 v[138:139], v230 offset:36864
  v_max3_f32 v252, v252, v166, v167
  v_mfma_f32_16x16x32_bf16 v[16:19], v[144:147], v[192:195], v[16:19]
  v_max3_f32 v253, v253, v168, v169
  v_mfma_f32_16x16x32_bf16 v[48:51], v[144:147], v[196:199], v[48:51]
  ds_read_b64_tr_b16 v[140:141], v231 offset:32768
  ds_read_b64_tr_b16 v[142:143], v231 offset:36864
  v_mfma_f32_16x16x32_bf16 v[20:23], v[148:151], v[192:195], v[20:23]
  v_max3_f32 v252, v252, v170, v171
  v_mfma_f32_16x16x32_bf16 v[52:55], v[148:151], v[196:199], v[52:55]
  ds_read_b64_tr_b16 v[144:145], v232 offset:32768
  ds_read_b64_tr_b16 v[146:147], v232 offset:36864
  v_max3_f32 v253, v253, v172, v173
  v_mfma_f32_16x16x32_bf16 v[24:27], v[152:155], v[192:195], v[24:27]
  v_mfma_f32_16x16x32_bf16 v[56:59], v[152:155], v[196:199], v[56:59]
  ds_read_b64_tr_b16 v[148:149], v233 offset:32768
  ds_read_b64_tr_b16 v[150:151], v233 offset:36864
  v_max3_f32 v252, v252, v174, v175
  v_mfma_f32_16x16x32_bf16 v[28:31], v[156:159], v[192:195], v[28:31]
  v_max_f32 v252, v252, v253
  v_mfma_f32_16x16x32_bf16 v[60:63], v[156:159], v[196:199], v[60:63]
  ds_read_b64_tr_b16 v[152:153], v234 offset:32768
  ds_read_b64_tr_b16 v[154:155], v234 offset:36864
  v_cmp_lt_f32 vcc, s40, v252
  s_cbranch_vccz L_nr_30
  s_call_b64 s[50:51], L_rescale0
L_nr_30:
  v_mfma_f32_16x16x32_bf16 v[176:179], v[96:99], v[64:67], v[212:215]
  v_exp_f32 v160, v160
  v_exp_f32 v161, v161
  v_mfma_f32_16x16x32_bf16 v[184:187], v[96:99], v[80:83], v[216:219]
  ds_read_b64_tr_b16 v[156:157], v235 offset:32768
  ds_read_b64_tr_b16 v[158:159], v235 offset:36864
  v_exp_f32 v162, v162
  v_mfma_f32_16x16x32_bf16 v[180:183], v[100:103], v[64:67], v[212:215]
  v_exp_f32 v163, v163
  v_cvt_pk_bf16_f32 v192, v160, v161
  v_mfma_f32_16x16x32_bf16 v[188:191], v[100:103], v[80:83], v[216:219]
  v_exp_f32 v164, v164
  v_mfma_f32_16x16x32_bf16 v[176:179], v[104:107], v[68:71], v[176:179]
  v_exp_f32 v165, v165
  v_cvt_pk_bf16_f32 v193, v162, v163
  v_mfma_f32_16x16x32_bf16 v[184:187], v[104:107], v[84:87], v[184:187]
  v_exp_f32 v166, v166
  v_mfma_f32_16x16x32_bf16 v[180:183], v[108:111], v[68:71], v[180:183]
  v_exp_f32 v167, v167
  v_cvt_pk_bf16_f32 v194, v164, v165
  v_mfma_f32_16x16x32_bf16 v[188:191], v[108:111], v[84:87], v[188:191]
  v_exp_f32 v168, v168
  v_mfma_f32_16x16x32_bf16 v[176:179], v[112:115], v[72:75], v[176:179]
  v_exp_f32 v169, v169
  v_cvt_pk_bf16_f32 v195, v166, v167
  v_mfma_f32_16x16x32_bf16 v[184:187], v[112:115], v[88:91], v[184:187]
  v_exp_f32 v170, v170
  v_mfma_f32_16x16x32_bf16 v[180:183], v[116:119], v[72:75], v[180:183]
  v_exp_f32 v171, v171
  v_cvt_pk_bf16_f32 v196, v168, v169
  v_mfma_f32_16x16x32_bf16 v[188:191], v[116:119], v[88:91], v[188:191]
  v_exp_f32 v172, v172
  v_mfma_f32_16x16x32_bf16 v[176:179], v[120:123], v[76:79], v[176:179]
  v_exp_f32 v173, v173
  v_cvt_pk_bf16_f32 v197, v170, v171
  v_mfma_f32_16x16x32_bf16 v[184:187], v[120:123], v[92:95], v[184:187]
  v_exp_f32 v174, v174
  v_mfma_f32_16x16x32_bf16 v[180:183], v[124:127], v[76:79], v[180:183]
  v_exp_f32 v175, v175
  v_cvt_pk_bf16_f32 v198, v172, v173
  v_mfma_f32_16x16x32_bf16 v[188:191], v[124:127], v[92:95], v[188:191]
  v_cvt_pk_bf16_f32 v199, v174, v175
  v_mfma_f32_16x16x32_bf16 v[240:243], v[248:251], v[192:195], v[240:243]
  s_nop 0
  v_mfma_f32_16x16x32_bf16 v[244:247], v[248:251], v[196:199], v[244:247]
  s_waitcnt lgkmcnt(14)
  v_mfma_f32_16x16x32_bf16 v[0:3], v[128:131], v[192:195], v[0:3]
  v_mfma_f32_16x16x32_bf16 v[32:35], v[128:131], v[196:199], v[32:35]
  s_waitcnt lgkmcnt(12)
  v_mfma_f32_16x16x32_bf16 v[4:7], v[132:135], v[192:195], v[4:7]
  v_mfma_f32_16x16x32_bf16 v[36:39], v[132:135], v[196:199], v[36:39]
  ds_read_b64_tr_b16 v[128:129], v228 offset:49152
  ds_read_b64_tr_b16 v[130:131], v228 offset:53248
  s_waitcnt lgkmcnt(12)
  v_mfma_f32_16x16x32_bf16 v[8:11], v[136:139], v[192:195], v[8:11]
  v_max3_f32 v252, v176, v177, v178
  v_mfma_f32_16x16x32_bf16 v[40:43], v[136:139], v[196:199], v[40:43]
  ds_read_b64_tr_b16 v[132:133], v229 offset:49152
  ds_read_b64_tr_b16 v[134:135], v229 offset:53248
  v_max3_f32 v253, v179, v180, v181
  s_waitcnt lgkmcnt(12)
  v_mfma_f32_16x16x32_bf16 v[12:15], v[140:143], v[192:195], v[12:15]
  v_mfma_f32_16x16x32_bf16 v[44:47], v[140:143], v[196:199], v[44:47]
  ds_read_b64_tr_b16 v[136:137], v230 offset:49152
  ds_read_b64_tr_b16 v[138:139], v230 offset:53248
  v_max3_f32 v252, v252, v182, v183
  s_waitcnt lgkmcnt(12)
  v_mfma_f32_16x16x32_bf16 v[16:19], v[144:147], v[192:195], v[16:19]
  v_max3_f32 v253, v253, v184, v185
  v_mfma_f32_16x16x32_bf16 v[48:51], v[144:147], v[196:199], v[48:51]
  ds_read_b64_tr_b16 v[140:141], v231 offset:49152
  ds_read_b64_tr_b16 v[142:143], v231 offset:53248
  s_waitcnt lgkmcnt(12)
  v_mfma_f32_16x16x32_bf16 v[20:23], v[148:151], v[192:195], v[20:23]
  v_max3_f32 v252, v252, v186, v187
  v_mfma_f32_16x16x32_bf16 v[52:55], v[148:151], v[196:199], v[52:55]
  ds_read_b64_tr_b16 v[144:145], v232 offset:49152
  ds_read_b64_tr_b16 v[146:147], v232 offset:53248
  v_max3_f32 v253, v253, v188, v189
  s_waitcnt lgkmcnt(12)
  v_mfma_f32_16x16x32_bf16 v[24:27], v[152:155], v[192:195], v[24:27]
  v_mfma_f32_16x16x32_bf16 v[56:59], v[152:155], v[196:199], v[56:59]
  ds_read_b64_tr_b16 v[148:149], v233 offset:49152
  ds_read_b64_tr_b16 v[150:151], v233 offset:53248
  v_max3_f32 v252, v252, v190, v191
  s_waitcnt lgkmcnt(12)
  v_mfma_f32_16x16x32_bf16 v[28:31], v[156:159], v[192:195], v[28:31]
  v_max_f32 v252, v252, v253
  v_mfma_f32_16x16x32_bf16 v[60:63], v[156:159], v[196:199], v[60:63]
  ds_read_b64_tr_b16 v[152:153], v234 offset:49152
  ds_read_b64_tr_b16 v[154:155], v234 offset:53248
  v_cmp_lt_f32 vcc, s40, v252
  s_cbranch_vccz L_nr_31
  s_call_b64 s[50:51], L_rescale1
L_nr_31:
  v_exp_f32 v176, v176
  v_exp_f32 v177, v177
  ds_read_b64_tr_b16 v[156:157], v235 offset:49152
  ds_read_b64_tr_b16 v[158:159], v235 offset:53248
  v_exp_f32 v178, v178
  v_exp_f32 v179, v179
  v_cvt_pk_bf16_f32 v192, v176, v177
  v_exp_f32 v180, v180
  v_exp_f32 v181, v181
  v_cvt_pk_bf16_f32 v193, v178, v179
  v_exp_f32 v182, v182
  v_exp_f32 v183, v183
  v_cvt_pk_bf16_f32 v194, v180, v181
  v_exp_f32 v184, v184
  v_exp_f32 v185, v185
  v_cvt_pk_bf16_f32 v195, v182, v183
  v_exp_f32 v186, v186
  v_exp_f32 v187, v187
  v_cvt_pk_bf16_f32 v196, v184, v185
  v_exp_f32 v188, v188
  v_exp_f32 v189, v189
  v_cvt_pk_bf16_f32 v197, v186, v187
  v_exp_f32 v190, v190
  v_exp_f32 v191, v191
  v_cvt_pk_bf16_f32 v198, v188, v189
  v_cvt_pk_bf16_f32 v199, v190, v191
  v_mfma_f32_16x16x32_bf16 v[240:243], v[248:251], v[192:195], v[240:243]
  s_nop 0
  v_mfma_f32_16x16x32_bf16 v[244:247], v[248:251], v[196:199], v[244:247]
  s_waitcnt lgkmcnt(14)
  v_mfma_f32_16x16x32_bf16 v[0:3], v[128:131], v[192:195], v[0:3]
  v_mfma_f32_16x16x32_bf16 v[32:35], v[128:131], v[196:199], v[32:35]
  s_waitcnt lgkmcnt(12)
  v_mfma_f32_16x16x32_bf16 v[4:7], v[132:135], v[192:195], v[4:7]
  v_mfma_f32_16x16x32_bf16 v[36:39], v[132:135], v[196:199], v[36:39]
  s_waitcnt lgkmcnt(10)
  v_mfma_f32_16x16x32_bf16 v[8:11], v[136:139], v[192:195], v[8:11]
  v_mfma_f32_16x16x32_bf16 v[40:43], v[136:139], v[196:199], v[40:43]
  s_waitcnt lgkmcnt(8)
  v_mfma_f32_16x16x32_bf16 v[12:15], v[140:143], v[192:195], v[12:15]
  v_mfma_f32_16x16x32_bf16 v[44:47], v[140:143], v[196:199], v[44:47]
  s_waitcnt lgkmcnt(6)
  v_mfma_f32_16x16x32_bf16 v[16:19], v[144:147], v[192:195], v[16:19]
  v_mfma_f32_16x16x32_bf16 v[48:51], v[144:147], v[196:199], v[48:51]
  s_waitcnt lgkmcnt(4)
  v_mfma_f32_16x16x32_bf16 v[20:23], v[148:151], v[192:195], v[20:23]
  v_mfma_f32_16x16x32_bf16 v[52:55], v[148:151], v[196:199], v[52:55]
  s_waitcnt lgkmcnt(2)
  v_mfma_f32_16x16x32_bf16 v[24:27], v[152:155], v[192:195], v[24:27]
  v_mfma_f32_16x16x32_bf16 v[56:59], v[152:155], v[196:199], v[56:59]
  s_waitcnt lgkmcnt(0)
  v_mfma_f32_16x16x32_bf16 v[28:31], v[156:159], v[192:195], v[28:31]
  v_mfma_f32_16x16x32_bf16 v[60:63], v[156:159], v[196:199], v[60:63]
  v_mov_b32 v252, 64
  s_mov_b64 exec, 1
  ds_write_b32 v221, v252 offset:0
  s_mov_b64 exec, -1
  v_mov_b32 v200, v212
  v_mov_b32 v202, v216
  v_mov_b32 v201, v240
  v_mov_b32 v203, v244
  v_rcp_f32 v204, v201
  v_rcp_f32 v205, v203
  v_mbcnt_lo_u32_b32 v255, -1, 0
  v_mbcnt_hi_u32_b32 v255, -1, v255
  v_lshlrev_b32 v250, 4, v255
  s_lshl_b32 s42, s2, 2
  s_add_u32 s42, s42, s7
  s_mul_i32 s42, s42, 9216
  s_add_u32 s42, s42, 4194304
  s_add_u32 s43, s42, 4096
  s_add_u32 s44, s42, 8192
  s_mov_b32 s75, s42
  v_mul_f32 v64, v0, v204
  v_mul_f32 v65, v1, v204
  v_mul_f32 v66, v2, v204
  v_mul_f32 v67, v3, v204
  v_mul_f32 v68, v4, v204
  v_mul_f32 v69, v5, v204
  v_mul_f32 v70, v6, v204
  v_mul_f32 v71, v7, v204
  v_cvt_pk_bf16_f32 v128, v64, v65
  v_cvt_pk_bf16_f32 v129, v66, v67
  v_cvt_pk_bf16_f32 v130, v68, v69
  v_cvt_pk_bf16_f32 v131, v70, v71
  v_mul_f32 v72, v8, v204
  v_mul_f32 v73, v9, v204
  v_mul_f32 v74, v10, v204
  v_mul_f32 v75, v11, v204
  v_mul_f32 v76, v12, v204
  v_mul_f32 v77, v13, v204
  v_mul_f32 v78, v14, v204
  v_mul_f32 v79, v15, v204
  v_cvt_pk_bf16_f32 v132, v72, v73
  v_cvt_pk_bf16_f32 v133, v74, v75
  v_cvt_pk_bf16_f32 v134, v76, v77
  v_cvt_pk_bf16_f32 v135, v78, v79
  v_mul_f32 v80, v16, v204
  v_mul_f32 v81, v17, v204
  v_mul_f32 v82, v18, v204
  v_mul_f32 v83, v19, v204
  v_mul_f32 v84, v20, v204
  v_mul_f32 v85, v21, v204
  v_mul_f32 v86, v22, v204
  v_mul_f32 v87, v23, v204
  v_cvt_pk_bf16_f32 v136, v80, v81
  v_cvt_pk_bf16_f32 v137, v82, v83
  v_cvt_pk_bf16_f32 v138, v84, v85
  v_cvt_pk_bf16_f32 v139, v86, v87
  v_mul_f32 v88, v24, v204
  v_mul_f32 v89, v25, v204
  v_mul_f32 v90, v26, v204
  v_mul_f32 v91, v27, v204
  v_mul_f32 v92, v28, v204
  v_mul_f32 v93, v29, v204
  v_mul_f32 v94, v30, v204
  v_mul_f32 v95, v31, v204
  v_cvt_pk_bf16_f32 v140, v88, v89
  v_cvt_pk_bf16_f32 v141, v90, v91
  v_cvt_pk_bf16_f32 v142, v92, v93
  v_cvt_pk_bf16_f32 v143, v94, v95
  buffer_store_dwordx4 v[200:203], v250, s[32:35], s44 offen sc1
  buffer_store_dwordx4 v[128:131], v250, s[32:35], s42 offen offset:0 sc1
  buffer_store_dwordx4 v[132:135], v250, s[32:35], s42 offen offset:1024 sc1
  buffer_store_dwordx4 v[136:139], v250, s[32:35], s42 offen offset:2048 sc1
  buffer_store_dwordx4 v[140:143], v250, s[32:35], s42 offen offset:3072 sc1
  v_mul_f32 v96, v32, v205
  v_mul_f32 v97, v33, v205
  v_mul_f32 v98, v34, v205
  v_mul_f32 v99, v35, v205
  v_mul_f32 v100, v36, v205
  v_mul_f32 v101, v37, v205
  v_mul_f32 v102, v38, v205
  v_mul_f32 v103, v39, v205
  v_cvt_pk_bf16_f32 v144, v96, v97
  v_cvt_pk_bf16_f32 v145, v98, v99
  v_cvt_pk_bf16_f32 v146, v100, v101
  v_cvt_pk_bf16_f32 v147, v102, v103
  v_mul_f32 v104, v40, v205
  v_mul_f32 v105, v41, v205
  v_mul_f32 v106, v42, v205
  v_mul_f32 v107, v43, v205
  v_mul_f32 v108, v44, v205
  v_mul_f32 v109, v45, v205
  v_mul_f32 v110, v46, v205
  v_mul_f32 v111, v47, v205
  v_cvt_pk_bf16_f32 v148, v104, v105
  v_cvt_pk_bf16_f32 v149, v106, v107
  v_cvt_pk_bf16_f32 v150, v108, v109
  v_cvt_pk_bf16_f32 v151, v110, v111
  v_mul_f32 v112, v48, v205
  v_mul_f32 v113, v49, v205
  v_mul_f32 v114, v50, v205
  v_mul_f32 v115, v51, v205
  v_mul_f32 v116, v52, v205
  v_mul_f32 v117, v53, v205
  v_mul_f32 v118, v54, v205
  v_mul_f32 v119, v55, v205
  v_cvt_pk_bf16_f32 v152, v112, v113
  v_cvt_pk_bf16_f32 v153, v114, v115
  v_cvt_pk_bf16_f32 v154, v116, v117
  v_cvt_pk_bf16_f32 v155, v118, v119
  v_mul_f32 v120, v56, v205
  v_mul_f32 v121, v57, v205
  v_mul_f32 v122, v58, v205
  v_mul_f32 v123, v59, v205
  v_mul_f32 v124, v60, v205
  v_mul_f32 v125, v61, v205
  v_mul_f32 v126, v62, v205
  v_mul_f32 v127, v63, v205
  v_cvt_pk_bf16_f32 v156, v120, v121
  v_cvt_pk_bf16_f32 v157, v122, v123
  v_cvt_pk_bf16_f32 v158, v124, v125
  v_cvt_pk_bf16_f32 v159, v126, v127
  buffer_store_dwordx4 v[144:147], v250, s[32:35], s43 offen offset:0 sc1
  buffer_store_dwordx4 v[148:151], v250, s[32:35], s43 offen offset:1024 sc1
  buffer_store_dwordx4 v[152:155], v250, s[32:35], s43 offen offset:2048 sc1
  buffer_store_dwordx4 v[156:159], v250, s[32:35], s43 offen offset:3072 sc1
  v_and_b32 v254, 15, v255
  v_lshrrev_b32 v253, 4, v255
  v_and_b32 v252, 31, v255
  v_lshrrev_b32 v251, 5, v255
  s_xor_b32 s45, s2, 8
  s_lshl_b32 s49, s45, 7
  s_lshl_b32 s46, s7, 2
  s_add_u32 s49, s49, s46
  s_add_u32 s49, s49, 25165840
  v_mov_b32 v245, 0
  s_lshl_b32 s46, s45, 2
  s_add_u32 s46, s46, s7
  s_mul_i32 s46, s46, 9216
  s_add_u32 s46, s46, 4194304
  s_add_u32 s47, s46, 4096
  s_add_u32 s48, s46, 8192
  s_lshl_b32 s45, s7, 8
  s_add_u32 s45, s45, 98304
  v_lshl_add_u32 v208, v254, 10, s45
  v_xor_b32 v209, v251, v254
  v_lshl_add_u32 v208, v209, 4, v208
  v_and_b32 v209, 1, v253
  v_lshl_add_u32 v208, v209, 3, v208
  v_mov_b32 v236, 147472
  s_mov_b32 s91, 64
  s_call_b64 s[50:51], L_sspin
  s_waitcnt vmcnt(0) lgkmcnt(0)
  s_mov_b32 s80, 1
  s_lshl_b32 s42, s8, 2
  s_add_u32 s42, s42, s53
  s_add_u32 s42, s42, 0x8000
  v_mov_b32 v240, 1
  v_mov_b32 v241, 0
  s_mov_b64 exec, 1
  buffer_store_dword v240, v241, s[32:35], s42 offen offset:16 sc1
  s_mov_b64 exec, -1
  s_add_u32 s49, s49, 0x8000
  s_mov_b32 s90, 0
  s_mov_b64 exec, 1
L_poll_ohs:
  buffer_load_dword v249, v245, s[32:35], s49 offen sc1
  s_waitcnt vmcnt(0)
  v_cmp_ne_u32 vcc, 1, v249
  s_cbranch_vccz L_pok_ohs
  s_sleep 2
  s_add_u32 s90, s90, 1
  s_cmp_lt_u32 s90, 0x20000
  s_cbranch_scc1 L_poll_ohs
L_pok_ohs:
  s_mov_b64 exec, -1
  s_add_u32 s76, s46, 0
  s_add_u32 s77, s46, 4096
  s_add_u32 s74, s46, 8192
  buffer_load_dwordx4 v[192:195], v250, s[32:35], s74 offen sc1
  buffer_load_dwordx4 v[160:163], v250, s[32:35], s76 offen offset:0 sc1
  buffer_load_dwordx4 v[164:167], v250, s[32:35], s76 offen offset:1024 sc1
  buffer_load_dwordx4 v[168:171], v250, s[32:35], s76 offen offset:2048 sc1
  buffer_load_dwordx4 v[172:175], v250, s[32:35], s76 offen offset:3072 sc1
  buffer_load_dwordx4 v[176:179], v250, s[32:35], s77 offen offset:0 sc1
  buffer_load_dwordx4 v[180:183], v250, s[32:35], s77 offen offset:1024 sc1
  buffer_load_dwordx4 v[184:187], v250, s[32:35], s77 offen offset:2048 sc1
  buffer_load_dwordx4 v[188:191], v250, s[32:35], s77 offen offset:3072 sc1
  s_waitcnt vmcnt(8)
  v_min_f32 v240, v200, v192
  v_sub_f32 v224, v240, v200
  v_sub_f32 v226, v240, v192
  v_exp_f32 v224, v224
  v_exp_f32 v226, v226
  s_nop 0
  v_mul_f32 v226, v226, v193
  v_fma_f32 v240, v201, v224, v226
  v_rcp_f32 v240, v240
  s_nop 0
  v_mul_f32 v224, v224, v240
  v_mul_f32 v226, v226, v240
  v_min_f32 v241, v202, v194
  v_sub_f32 v225, v241, v202
  v_sub_f32 v227, v241, v194
  v_exp_f32 v225, v225
  v_exp_f32 v227, v227
  s_nop 0
  v_mul_f32 v227, v227, v195
  v_fma_f32 v241, v203, v225, v227
  v_rcp_f32 v241, v241
  s_nop 0
  v_mul_f32 v225, v225, v241
  v_mul_f32 v227, v227, v241
  s_waitcnt vmcnt(7)
  v_lshlrev_b32 v64, 16, v160
  v_and_b32 v65, 0xffff0000, v160
  v_mul_f32 v64, v64, v226
  v_mul_f32 v65, v65, v226
  v_fma_f32 v0, v0, v224, v64
  v_fma_f32 v1, v1, v224, v65
  v_lshlrev_b32 v66, 16, v161
  v_and_b32 v67, 0xffff0000, v161
  v_mul_f32 v66, v66, v226
  v_mul_f32 v67, v67, v226
  v_fma_f32 v2, v2, v224, v66
  v_fma_f32 v3, v3, v224, v67
  v_lshlrev_b32 v64, 16, v162
  v_and_b32 v65, 0xffff0000, v162
  v_mul_f32 v64, v64, v226
  v_mul_f32 v65, v65, v226
  v_fma_f32 v4, v4, v224, v64
  v_fma_f32 v5, v5, v224, v65
  v_lshlrev_b32 v66, 16, v163
  v_and_b32 v67, 0xffff0000, v163
  v_mul_f32 v66, v66, v226
  v_mul_f32 v67, v67, v226
  v_fma_f32 v6, v6, v224, v66
  v_fma_f32 v7, v7, v224, v67
  v_cvt_pk_bf16_f32 v68, v0, v1
  v_cvt_pk_bf16_f32 v69, v2, v3
  v_xor_b32 v209, 0, v208
  ds_write_b64 v209, v[68:69] offset:0
  v_cvt_pk_bf16_f32 v70, v4, v5
  v_cvt_pk_bf16_f32 v71, v6, v7
  v_xor_b32 v210, 32, v208
  ds_write_b64 v210, v[70:71] offset:0
  s_waitcnt vmcnt(6)
  v_lshlrev_b32 v64, 16, v164
  v_and_b32 v65, 0xffff0000, v164
  v_mul_f32 v64, v64, v226
  v_mul_f32 v65, v65, v226
  v_fma_f32 v8, v8, v224, v64
  v_fma_f32 v9, v9, v224, v65
  v_lshlrev_b32 v66, 16, v165
  v_and_b32 v67, 0xffff0000, v165
  v_mul_f32 v66, v66, v226
  v_mul_f32 v67, v67, v226
  v_fma_f32 v10, v10, v224, v66
  v_fma_f32 v11, v11, v224, v67
  v_lshlrev_b32 v64, 16, v166
  v_and_b32 v65, 0xffff0000, v166
  v_mul_f32 v64, v64, v226
  v_mul_f32 v65, v65, v226
  v_fma_f32 v12, v12, v224, v64
  v_fma_f32 v13, v13, v224, v65
  v_lshlrev_b32 v66, 16, v167
  v_and_b32 v67, 0xffff0000, v167
  v_mul_f32 v66, v66, v226
  v_mul_f32 v67, v67, v226
  v_fma_f32 v14, v14, v224, v66
  v_fma_f32 v15, v15, v224, v67
  v_cvt_pk_bf16_f32 v72, v8, v9
  v_cvt_pk_bf16_f32 v73, v10, v11
  v_xor_b32 v211, 64, v208
  ds_write_b64 v211, v[72:73] offset:0
  v_cvt_pk_bf16_f32 v74, v12, v13
  v_cvt_pk_bf16_f32 v75, v14, v15
  v_xor_b32 v212, 96, v208
  ds_write_b64 v212, v[74:75] offset:0
  s_waitcnt vmcnt(5)
  v_lshlrev_b32 v64, 16, v168
  v_and_b32 v65, 0xffff0000, v168
  v_mul_f32 v64, v64, v226
  v_mul_f32 v65, v65, v226
  v_fma_f32 v16, v16, v224, v64
  v_fma_f32 v17, v17, v224, v65
  v_lshlrev_b32 v66, 16, v169
  v_and_b32 v67, 0xffff0000, v169
  v_mul_f32 v66, v66, v226
  v_mul_f32 v67, v67, v226
  v_fma_f32 v18, v18, v224, v66
  v_fma_f32 v19, v19, v224, v67
  v_lshlrev_b32 v64, 16, v170
  v_and_b32 v65, 0xffff0000, v170
  v_mul_f32 v64, v64, v226
  v_mul_f32 v65, v65, v226
  v_fma_f32 v20, v20, v224, v64
  v_fma_f32 v21, v21, v224, v65
  v_lshlrev_b32 v66, 16, v171
  v_and_b32 v67, 0xffff0000, v171
  v_mul_f32 v66, v66, v226
  v_mul_f32 v67, v67, v226
  v_fma_f32 v22, v22, v224, v66
  v_fma_f32 v23, v23, v224, v67
  v_cvt_pk_bf16_f32 v68, v16, v17
  v_cvt_pk_bf16_f32 v69, v18, v19
  v_xor_b32 v209, 128, v208
  ds_write_b64 v209, v[68:69] offset:0
  v_cvt_pk_bf16_f32 v70, v20, v21
  v_cvt_pk_bf16_f32 v71, v22, v23
  v_xor_b32 v210, 160, v208
  ds_write_b64 v210, v[70:71] offset:0
  s_waitcnt vmcnt(4)
  v_lshlrev_b32 v64, 16, v172
  v_and_b32 v65, 0xffff0000, v172
  v_mul_f32 v64, v64, v226
  v_mul_f32 v65, v65, v226
  v_fma_f32 v24, v24, v224, v64
  v_fma_f32 v25, v25, v224, v65
  v_lshlrev_b32 v66, 16, v173
  v_and_b32 v67, 0xffff0000, v173
  v_mul_f32 v66, v66, v226
  v_mul_f32 v67, v67, v226
  v_fma_f32 v26, v26, v224, v66
  v_fma_f32 v27, v27, v224, v67
  v_lshlrev_b32 v64, 16, v174
  v_and_b32 v65, 0xffff0000, v174
  v_mul_f32 v64, v64, v226
  v_mul_f32 v65, v65, v226
  v_fma_f32 v28, v28, v224, v64
  v_fma_f32 v29, v29, v224, v65
  v_lshlrev_b32 v66, 16, v175
  v_and_b32 v67, 0xffff0000, v175
  v_mul_f32 v66, v66, v226
  v_mul_f32 v67, v67, v226
  v_fma_f32 v30, v30, v224, v66
  v_fma_f32 v31, v31, v224, v67
  v_cvt_pk_bf16_f32 v72, v24, v25
  v_cvt_pk_bf16_f32 v73, v26, v27
  v_xor_b32 v211, 192, v208
  ds_write_b64 v211, v[72:73] offset:0
  v_cvt_pk_bf16_f32 v74, v28, v29
  v_cvt_pk_bf16_f32 v75, v30, v31
  v_xor_b32 v212, 224, v208
  ds_write_b64 v212, v[74:75] offset:0
  s_waitcnt vmcnt(3)
  v_lshlrev_b32 v64, 16, v176
  v_and_b32 v65, 0xffff0000, v176
  v_mul_f32 v64, v64, v227
  v_mul_f32 v65, v65, v227
  v_fma_f32 v32, v32, v225, v64
  v_fma_f32 v33, v33, v225, v65
  v_lshlrev_b32 v66, 16, v177
  v_and_b32 v67, 0xffff0000, v177
  v_mul_f32 v66, v66, v227
  v_mul_f32 v67, v67, v227
  v_fma_f32 v34, v34, v225, v66
  v_fma_f32 v35, v35, v225, v67
  v_lshlrev_b32 v64, 16, v178
  v_and_b32 v65, 0xffff0000, v178
  v_mul_f32 v64, v64, v227
  v_mul_f32 v65, v65, v227
  v_fma_f32 v36, v36, v225, v64
  v_fma_f32 v37, v37, v225, v65
  v_lshlrev_b32 v66, 16, v179
  v_and_b32 v67, 0xffff0000, v179
  v_mul_f32 v66, v66, v227
  v_mul_f32 v67, v67, v227
  v_fma_f32 v38, v38, v225, v66
  v_fma_f32 v39, v39, v225, v67
  v_cvt_pk_bf16_f32 v68, v32, v33
  v_cvt_pk_bf16_f32 v69, v34, v35
  v_xor_b32 v209, 0, v208
  ds_write_b64 v209, v[68:69] offset:16384
  v_cvt_pk_bf16_f32 v70, v36, v37
  v_cvt_pk_bf16_f32 v71, v38, v39
  v_xor_b32 v210, 32, v208
  ds_write_b64 v210, v[70:71] offset:16384
  s_waitcnt vmcnt(2)
  v_lshlrev_b32 v64, 16, v180
  v_and_b32 v65, 0xffff0000, v180
  v_mul_f32 v64, v64, v227
  v_mul_f32 v65, v65, v227
  v_fma_f32 v40, v40, v225, v64
  v_fma_f32 v41, v41, v225, v65
  v_lshlrev_b32 v66, 16, v181
  v_and_b32 v67, 0xffff0000, v181
  v_mul_f32 v66, v66, v227
  v_mul_f32 v67, v67, v227
  v_fma_f32 v42, v42, v225, v66
  v_fma_f32 v43, v43, v225, v67
  v_lshlrev_b32 v64, 16, v182
  v_and_b32 v65, 0xffff0000, v182
  v_mul_f32 v64, v64, v227
  v_mul_f32 v65, v65, v227
  v_fma_f32 v44, v44, v225, v64
  v_fma_f32 v45, v45, v225, v65
  v_lshlrev_b32 v66, 16, v183
  v_and_b32 v67, 0xffff0000, v183
  v_mul_f32 v66, v66, v227
  v_mul_f32 v67, v67, v227
  v_fma_f32 v46, v46, v225, v66
  v_fma_f32 v47, v47, v225, v67
  v_cvt_pk_bf16_f32 v72, v40, v41
  v_cvt_pk_bf16_f32 v73, v42, v43
  v_xor_b32 v211, 64, v208
  ds_write_b64 v211, v[72:73] offset:16384
  v_cvt_pk_bf16_f32 v74, v44, v45
  v_cvt_pk_bf16_f32 v75, v46, v47
  v_xor_b32 v212, 96, v208
  ds_write_b64 v212, v[74:75] offset:16384
  s_waitcnt vmcnt(1)
  v_lshlrev_b32 v64, 16, v184
  v_and_b32 v65, 0xffff0000, v184
  v_mul_f32 v64, v64, v227
  v_mul_f32 v65, v65, v227
  v_fma_f32 v48, v48, v225, v64
  v_fma_f32 v49, v49, v225, v65
  v_lshlrev_b32 v66, 16, v185
  v_and_b32 v67, 0xffff0000, v185
  v_mul_f32 v66, v66, v227
  v_mul_f32 v67, v67, v227
  v_fma_f32 v50, v50, v225, v66
  v_fma_f32 v51, v51, v225, v67
  v_lshlrev_b32 v64, 16, v186
  v_and_b32 v65, 0xffff0000, v186
  v_mul_f32 v64, v64, v227
  v_mul_f32 v65, v65, v227
  v_fma_f32 v52, v52, v225, v64
  v_fma_f32 v53, v53, v225, v65
  v_lshlrev_b32 v66, 16, v187
  v_and_b32 v67, 0xffff0000, v187
  v_mul_f32 v66, v66, v227
  v_mul_f32 v67, v67, v227
  v_fma_f32 v54, v54, v225, v66
  v_fma_f32 v55, v55, v225, v67
  v_cvt_pk_bf16_f32 v68, v48, v49
  v_cvt_pk_bf16_f32 v69, v50, v51
  v_xor_b32 v209, 128, v208
  ds_write_b64 v209, v[68:69] offset:16384
  v_cvt_pk_bf16_f32 v70, v52, v53
  v_cvt_pk_bf16_f32 v71, v54, v55
  v_xor_b32 v210, 160, v208
  ds_write_b64 v210, v[70:71] offset:16384
  s_waitcnt vmcnt(0)
  v_lshlrev_b32 v64, 16, v188
  v_and_b32 v65, 0xffff0000, v188
  v_mul_f32 v64, v64, v227
  v_mul_f32 v65, v65, v227
  v_fma_f32 v56, v56, v225, v64
  v_fma_f32 v57, v57, v225, v65
  v_lshlrev_b32 v66, 16, v189
  v_and_b32 v67, 0xffff0000, v189
  v_mul_f32 v66, v66, v227
  v_mul_f32 v67, v67, v227
  v_fma_f32 v58, v58, v225, v66
  v_fma_f32 v59, v59, v225, v67
  v_lshlrev_b32 v64, 16, v190
  v_and_b32 v65, 0xffff0000, v190
  v_mul_f32 v64, v64, v227
  v_mul_f32 v65, v65, v227
  v_fma_f32 v60, v60, v225, v64
  v_fma_f32 v61, v61, v225, v65
  v_lshlrev_b32 v66, 16, v191
  v_and_b32 v67, 0xffff0000, v191
  v_mul_f32 v66, v66, v227
  v_mul_f32 v67, v67, v227
  v_fma_f32 v62, v62, v225, v66
  v_fma_f32 v63, v63, v225, v67
  v_cvt_pk_bf16_f32 v72, v56, v57
  v_cvt_pk_bf16_f32 v73, v58, v59
  v_xor_b32 v211, 192, v208
  ds_write_b64 v211, v[72:73] offset:16384
  v_cvt_pk_bf16_f32 v74, v60, v61
  v_cvt_pk_bf16_f32 v75, v62, v63
  v_xor_b32 v212, 224, v208
  ds_write_b64 v212, v[74:75] offset:16384
  s_waitcnt lgkmcnt(0)
  s_barrier
  s_lshl_b32 s46, s2, 15
  s_lshl_b32 s43, s7, 10
  s_add_u32 s46, s46, s43
  s_add_u32 s46, s46, 16777216
  s_lshl_b32 s47, s5, 16
  s_lshl_b32 s43, s4, 10
  s_add_u32 s47, s47, s43
  s_lshl_b32 s43, s6, 9
  s_add_u32 s47, s47, s43
  s_lshl_b32 s43, s89, 6
  s_add_u32 s47, s47, s43
  s_lshl_b32 s43, s7, 4
  s_add_u32 s47, s47, s43
  v_lshlrev_b32 v244, 11, v252
  v_lshl_add_u32 v244, v251, 3, v244
  s_andn2_b32 s42, s2, 7
  s_lshl_b32 s49, s42, 7
  s_lshr_b32 s43, s89, 1
  s_lshl_b32 s43, s43, 2
  s_add_u32 s49, s49, s43
  s_add_u32 s49, s49, 25198624
  v_lshlrev_b32 v245, 7, v255
  s_mov_b32 s91, 1
  v_mov_b32 v236, 147552
  s_call_b64 s[50:51], L_sspin
  s_mov_b32 s90, 0
  s_mov_b64 exec, 0xff
L_poll_c:
  buffer_load_dword v249, v245, s[32:35], s49 offen sc1
  s_waitcnt vmcnt(0)
  v_cmp_ne_u32 vcc, 1, v249
  s_cbranch_vccz L_pok_c
  s_sleep 2
  s_add_u32 s90, s90, 1
  s_cmp_lt_u32 s90, 0x20000
  s_cbranch_scc1 L_poll_c
L_pok_c:
  s_mov_b64 exec, -1
  s_add_u32 s43, s46, 0
  buffer_load_dwordx4 v[0:3], v250, s[32:35], s43 offen sc1
  s_add_u32 s43, s46, 4096
  buffer_load_dwordx4 v[4:7], v250, s[32:35], s43 offen sc1
  s_add_u32 s43, s46, 8192
  buffer_load_dwordx4 v[8:11], v250, s[32:35], s43 offen sc1
  s_add_u32 s43, s46, 12288
  buffer_load_dwordx4 v[12:15], v250, s[32:35], s43 offen sc1
  s_add_u32 s43, s46, 16384
  buffer_load_dwordx4 v[16:19], v250, s[32:35], s43 offen sc1
  s_add_u32 s43, s46, 20480
  buffer_load_dwordx4 v[20:23], v250, s[32:35], s43 offen sc1
  s_add_u32 s43, s46, 24576
  buffer_load_dwordx4 v[24:27], v250, s[32:35], s43 offen sc1
  s_add_u32 s43, s46, 28672
  buffer_load_dwordx4 v[28:31], v250, s[32:35], s43 offen sc1
  s_waitcnt vmcnt(0) lgkmcnt(0)
  v_add_f32 v0, v0, v4
  v_add_f32 v1, v1, v5
  v_add_f32 v2, v2, v6
  v_add_f32 v3, v3, v7
  v_add_f32 v8, v8, v12
  v_add_f32 v9, v9, v13
  v_add_f32 v10, v10, v14
  v_add_f32 v11, v11, v15
  v_add_f32 v16, v16, v20
  v_add_f32 v17, v17, v21
  v_add_f32 v18, v18, v22
  v_add_f32 v19, v19, v23
  v_add_f32 v24, v24, v28
  v_add_f32 v25, v25, v29
  v_add_f32 v26, v26, v30
  v_add_f32 v27, v27, v31
  v_add_f32 v0, v0, v8
  v_add_f32 v1, v1, v9
  v_add_f32 v2, v2, v10
  v_add_f32 v3, v3, v11
  v_add_f32 v16, v16, v24
  v_add_f32 v17, v17, v25
  v_add_f32 v18, v18, v26
  v_add_f32 v19, v19, v27
  v_add_f32 v0, v0, v16
  v_add_f32 v1, v1, v17
  v_add_f32 v2, v2, v18
  v_add_f32 v3, v3, v19
  v_cvt_pk_bf16_f32 v32, v0, v1
  v_cvt_pk_bf16_f32 v33, v2, v3
  buffer_store_dwordx2 v[32:33], v244, s[92:95], s47 offen
  s_branch L_end
L_rescale0:
  s_nop 15
  v_max3_f32 v252, v160, v161, v162
  v_max3_f32 v252, v252, v163, v164
  v_max3_f32 v252, v252, v165, v166
  v_max_f32 v252, v252, v167
  v_mov_b32 v253, v252
  s_nop 1
  v_permlane16_swap_b32 v252, v253
  v_max_f32 v252, v252, v253
  v_mov_b32 v253, v252
  s_nop 1
  v_permlane32_swap_b32 v252, v253
  v_max_f32 v252, v252, v253
  v_max_f32 v252, 0, v252
  v_sub_f32 v253, 0, v252
  v_exp_f32 v253, v253
  v_sub_f32 v212, v212, v252
  v_sub_f32 v213, v213, v252
  v_sub_f32 v214, v214, v252
  v_sub_f32 v215, v215, v252
  v_sub_f32 v160, v160, v252
  v_sub_f32 v161, v161, v252
  v_sub_f32 v162, v162, v252
  v_sub_f32 v163, v163, v252
  v_sub_f32 v164, v164, v252
  v_sub_f32 v165, v165, v252
  v_sub_f32 v166, v166, v252
  v_sub_f32 v167, v167, v252
  v_mul_f32 v0, v0, v253
  v_mul_f32 v1, v1, v253
  v_mul_f32 v2, v2, v253
  v_mul_f32 v3, v3, v253
  v_mul_f32 v4, v4, v253
  v_mul_f32 v5, v5, v253
  v_mul_f32 v6, v6, v253
  v_mul_f32 v7, v7, v253
  v_mul_f32 v8, v8, v253
  v_mul_f32 v9, v9, v253
  v_mul_f32 v10, v10, v253
  v_mul_f32 v11, v11, v253
  v_mul_f32 v12, v12, v253
  v_mul_f32 v13, v13, v253
  v_mul_f32 v14, v14, v253
  v_mul_f32 v15, v15, v253
  v_mul_f32 v16, v16, v253
  v_mul_f32 v17, v17, v253
  v_mul_f32 v18, v18, v253
  v_mul_f32 v19, v19, v253
  v_mul_f32 v20, v20, v253
  v_mul_f32 v21, v21, v253
  v_mul_f32 v22, v22, v253
  v_mul_f32 v23, v23, v253
  v_mul_f32 v24, v24, v253
  v_mul_f32 v25, v25, v253
  v_mul_f32 v26, v26, v253
  v_mul_f32 v27, v27, v253
  v_mul_f32 v28, v28, v253
  v_mul_f32 v29, v29, v253
  v_mul_f32 v30, v30, v253
  v_mul_f32 v31, v31, v253
  v_mul_f32 v240, v240, v253
  v_mul_f32 v241, v241, v253
  v_mul_f32 v242, v242, v253
  v_mul_f32 v243, v243, v253
  v_max3_f32 v252, v168, v169, v170
  v_max3_f32 v252, v252, v171, v172
  v_max3_f32 v252, v252, v173, v174
  v_max_f32 v252, v252, v175
  v_mov_b32 v253, v252
  s_nop 1
  v_permlane16_swap_b32 v252, v253
  v_max_f32 v252, v252, v253
  v_mov_b32 v253, v252
  s_nop 1
  v_permlane32_swap_b32 v252, v253
  v_max_f32 v252, v252, v253
  v_max_f32 v252, 0, v252
  v_sub_f32 v253, 0, v252
  v_exp_f32 v253, v253
  v_sub_f32 v216, v216, v252
  v_sub_f32 v217, v217, v252
  v_sub_f32 v218, v218, v252
  v_sub_f32 v219, v219, v252
  v_sub_f32 v168, v168, v252
  v_sub_f32 v169, v169, v252
  v_sub_f32 v170, v170, v252
  v_sub_f32 v171, v171, v252
  v_sub_f32 v172, v172, v252
  v_sub_f32 v173, v173, v252
  v_sub_f32 v174, v174, v252
  v_sub_f32 v175, v175, v252
  v_mul_f32 v32, v32, v253
  v_mul_f32 v33, v33, v253
  v_mul_f32 v34, v34, v253
  v_mul_f32 v35, v35, v253
  v_mul_f32 v36, v36, v253
  v_mul_f32 v37, v37, v253
  v_mul_f32 v38, v38, v253
  v_mul_f32 v39, v39, v253
  v_mul_f32 v40, v40, v253
  v_mul_f32 v41, v41, v253
  v_mul_f32 v42, v42, v253
  v_mul_f32 v43, v43, v253
  v_mul_f32 v44, v44, v253
  v_mul_f32 v45, v45, v253
  v_mul_f32 v46, v46, v253
  v_mul_f32 v47, v47, v253
  v_mul_f32 v48, v48, v253
  v_mul_f32 v49, v49, v253
  v_mul_f32 v50, v50, v253
  v_mul_f32 v51, v51, v253
  v_mul_f32 v52, v52, v253
  v_mul_f32 v53, v53, v253
  v_mul_f32 v54, v54, v253
  v_mul_f32 v55, v55, v253
  v_mul_f32 v56, v56, v253
  v_mul_f32 v57, v57, v253
  v_mul_f32 v58, v58, v253
  v_mul_f32 v59, v59, v253
  v_mul_f32 v60, v60, v253
  v_mul_f32 v61, v61, v253
  v_mul_f32 v62, v62, v253
  v_mul_f32 v63, v63, v253
  v_mul_f32 v244, v244, v253
  v_mul_f32 v245, v245, v253
  v_mul_f32 v246, v246, v253
  v_mul_f32 v247, v247, v253
  s_nop 3
  s_setpc_b64 s[50:51]
L_rescale1:
  s_nop 15
  v_max3_f32 v252, v176, v177, v178
  v_max3_f32 v252, v252, v179, v180
  v_max3_f32 v252, v252, v181, v182
  v_max_f32 v252, v252, v183
  v_mov_b32 v253, v252
  s_nop 1
  v_permlane16_swap_b32 v252, v253
  v_max_f32 v252, v252, v253
  v_mov_b32 v253, v252
  s_nop 1
  v_permlane32_swap_b32 v252, v253
  v_max_f32 v252, v252, v253
  v_max_f32 v252, 0, v252
  v_sub_f32 v253, 0, v252
  v_exp_f32 v253, v253
  v_sub_f32 v212, v212, v252
  v_sub_f32 v213, v213, v252
  v_sub_f32 v214, v214, v252
  v_sub_f32 v215, v215, v252
  v_sub_f32 v176, v176, v252
  v_sub_f32 v177, v177, v252
  v_sub_f32 v178, v178, v252
  v_sub_f32 v179, v179, v252
  v_sub_f32 v180, v180, v252
  v_sub_f32 v181, v181, v252
  v_sub_f32 v182, v182, v252
  v_sub_f32 v183, v183, v252
  v_mul_f32 v0, v0, v253
  v_mul_f32 v1, v1, v253
  v_mul_f32 v2, v2, v253
  v_mul_f32 v3, v3, v253
  v_mul_f32 v4, v4, v253
  v_mul_f32 v5, v5, v253
  v_mul_f32 v6, v6, v253
  v_mul_f32 v7, v7, v253
  v_mul_f32 v8, v8, v253
  v_mul_f32 v9, v9, v253
  v_mul_f32 v10, v10, v253
  v_mul_f32 v11, v11, v253
  v_mul_f32 v12, v12, v253
  v_mul_f32 v13, v13, v253
  v_mul_f32 v14, v14, v253
  v_mul_f32 v15, v15, v253
  v_mul_f32 v16, v16, v253
  v_mul_f32 v17, v17, v253
  v_mul_f32 v18, v18, v253
  v_mul_f32 v19, v19, v253
  v_mul_f32 v20, v20, v253
  v_mul_f32 v21, v21, v253
  v_mul_f32 v22, v22, v253
  v_mul_f32 v23, v23, v253
  v_mul_f32 v24, v24, v253
  v_mul_f32 v25, v25, v253
  v_mul_f32 v26, v26, v253
  v_mul_f32 v27, v27, v253
  v_mul_f32 v28, v28, v253
  v_mul_f32 v29, v29, v253
  v_mul_f32 v30, v30, v253
  v_mul_f32 v31, v31, v253
  v_mul_f32 v240, v240, v253
  v_mul_f32 v241, v241, v253
  v_mul_f32 v242, v242, v253
  v_mul_f32 v243, v243, v253
  v_max3_f32 v252, v184, v185, v186
  v_max3_f32 v252, v252, v187, v188
  v_max3_f32 v252, v252, v189, v190
  v_max_f32 v252, v252, v191
  v_mov_b32 v253, v252
  s_nop 1
  v_permlane16_swap_b32 v252, v253
  v_max_f32 v252, v252, v253
  v_mov_b32 v253, v252
  s_nop 1
  v_permlane32_swap_b32 v252, v253
  v_max_f32 v252, v252, v253
  v_max_f32 v252, 0, v252
  v_sub_f32 v253, 0, v252
  v_exp_f32 v253, v253
  v_sub_f32 v216, v216, v252
  v_sub_f32 v217, v217, v252
  v_sub_f32 v218, v218, v252
  v_sub_f32 v219, v219, v252
  v_sub_f32 v184, v184, v252
  v_sub_f32 v185, v185, v252
  v_sub_f32 v186, v186, v252
  v_sub_f32 v187, v187, v252
  v_sub_f32 v188, v188, v252
  v_sub_f32 v189, v189, v252
  v_sub_f32 v190, v190, v252
  v_sub_f32 v191, v191, v252
  v_mul_f32 v32, v32, v253
  v_mul_f32 v33, v33, v253
  v_mul_f32 v34, v34, v253
  v_mul_f32 v35, v35, v253
  v_mul_f32 v36, v36, v253
  v_mul_f32 v37, v37, v253
  v_mul_f32 v38, v38, v253
  v_mul_f32 v39, v39, v253
  v_mul_f32 v40, v40, v253
  v_mul_f32 v41, v41, v253
  v_mul_f32 v42, v42, v253
  v_mul_f32 v43, v43, v253
  v_mul_f32 v44, v44, v253
  v_mul_f32 v45, v45, v253
  v_mul_f32 v46, v46, v253
  v_mul_f32 v47, v47, v253
  v_mul_f32 v48, v48, v253
  v_mul_f32 v49, v49, v253
  v_mul_f32 v50, v50, v253
  v_mul_f32 v51, v51, v253
  v_mul_f32 v52, v52, v253
  v_mul_f32 v53, v53, v253
  v_mul_f32 v54, v54, v253
  v_mul_f32 v55, v55, v253
  v_mul_f32 v56, v56, v253
  v_mul_f32 v57, v57, v253
  v_mul_f32 v58, v58, v253
  v_mul_f32 v59, v59, v253
  v_mul_f32 v60, v60, v253
  v_mul_f32 v61, v61, v253
  v_mul_f32 v62, v62, v253
  v_mul_f32 v63, v63, v253
  v_mul_f32 v244, v244, v253
  v_mul_f32 v245, v245, v253
  v_mul_f32 v246, v246, v253
  v_mul_f32 v247, v247, v253
  s_nop 3
  s_setpc_b64 s[50:51]
L_cspin:
  s_mov_b32 s90, 0
L_cspin_l:
  ds_read_b128 v[236:239], v220
  s_waitcnt lgkmcnt(0)
  v_min3_u32 v255, v236, v237, v238
  v_min_u32 v255, v255, v239
  v_cmp_gt_u32 vcc, s91, v255
  s_cbranch_vccz L_cspin_x
  s_sleep 3
  s_add_u32 s90, s90, 1
  s_cmp_lt_u32 s90, 0x200000
  s_cbranch_scc1 L_cspin_l
L_cspin_x:
  s_setpc_b64 s[50:51]
L_hspin:
  s_mov_b32 s90, 0
L_hspin_l:
  ds_read_b128 v[232:235], v245
  s_waitcnt lgkmcnt(0)
  v_min3_u32 v236, v232, v233, v234
  v_min_u32 v236, v236, v235
  v_cmp_gt_u32 vcc, s91, v236
  s_cbranch_vccz L_hspin_x
  s_sleep 3
  s_add_u32 s90, s90, 1
  s_cmp_lt_u32 s90, 0x200000
  s_cbranch_scc1 L_hspin_l
L_hspin_x:
  s_setpc_b64 s[50:51]
L_sspin:
  s_mov_b32 s90, 0
L_sspin_l:
  ds_read_b128 v[240:243], v236
  s_waitcnt lgkmcnt(0)
  v_min3_u32 v249, v240, v241, v242
  v_min_u32 v249, v249, v243
  v_cmp_gt_u32 vcc, s91, v249
  s_cbranch_vccz L_sspin_x
  s_sleep 3
  s_add_u32 s90, s90, 1
  s_cmp_lt_u32 s90, 0x200000
  s_cbranch_scc1 L_sspin_l
L_sspin_x:
  s_setpc_b64 s[50:51]
L_h2spin:
  s_mov_b32 s90, 0
L_h2spin_l:
  ds_read_b128 v[232:235], v239
  s_waitcnt lgkmcnt(0)
  v_min3_u32 v236, v232, v233, v234
  v_min_u32 v236, v236, v235
  v_cmp_gt_u32 vcc, s91, v236
  s_cbranch_vccz L_h2spin_x
  s_sleep 3
  s_add_u32 s90, s90, 1
  s_cmp_lt_u32 s90, 0x200000
  s_cbranch_scc1 L_h2spin_l
L_h2spin_x:
  s_setpc_b64 s[50:51]
L_helper:
  s_mov_b32 s84, 0
  s_cmp_lt_u32 s2, 16
  s_cselect_b32 s42, s8, 0
  s_cmp_lg_u32 s42, 3
  s_cbranch_scc1 L_nozero
  v_mov_b32 v232, 0
  v_mov_b32 v233, 0
  v_mov_b32 v234, 0
  v_mov_b32 v235, 0
  s_lshl_b32 s42, s2, 11
  s_add_u32 s42, s42, 25198592
  buffer_store_dwordx4 v[232:235], v250, s[32:35], s42 offen sc1
  buffer_store_dwordx4 v[232:235], v250, s[32:35], s42 offen offset:1024 sc1
  v_mov_b32 v236, 1
  v_mov_b32 v237, s2
  s_waitcnt vmcnt(0) lgkmcnt(0)
  s_mov_b64 exec, 1
  buffer_store_byte v236, v237, s[36:39], 0 offen sc1
  s_mov_b64 exec, -1
L_nozero:
  s_and_b32 s42, s8, 1
  s_cmp_eq_u32 s42, 1
  s_cselect_b32 s96, s20, s24
  s_cselect_b32 s97, s21, s25
  s_mov_b32 s98, 0x40000
  s_mov_b32 s99, 0x00020000
  s_cselect_b32 s54, 0, 1
  s_cselect_b32 s44, 64, 0x80
  s_cselect_b32 s46, 0x80, 0
  s_cselect_b32 s45, 0, 1
  s_lshl_b32 s55, s8, 13
  s_lshr_b32 s88, s8, 1
  s_lshl_b32 s88, s88, 13
  v_lshlrev_b32 v232, s45, v253
  v_xor_b32 v232, v232, v254
  v_lshlrev_b32 v232, 4, v232
  v_lshl_add_u32 v240, v253, 8, v232
  v_xor_b32 v241, s44, v240
  v_xor_b32 v242, s46, v240
  v_xor_b32 v243, s46, v241
  v_lshrrev_b32 v232, 3, v255
  v_and_b32 v233, 7, v255
  v_and_b32 v234, 1, v253
  v_lshlrev_b32 v235, 2, v234
  v_xor_b32 v233, v233, v235
  v_lshlrev_b32 v233, 4, v233
  v_lshl_add_u32 v244, v232, 10, v233
  s_lshl_b32 s52, s3, 19
  s_lshl_b32 s42, s6, 9
  s_add_u32 s52, s52, s42
  s_lshl_b32 s42, s8, 7
  s_add_u32 s52, s52, s42
  v_lshrrev_b32 v232, 2, v254
  v_and_b32 v233, 3, v254
  v_lshl_add_u32 v235, v251, 3, v232
  v_lshlrev_b32 v235, 7, v235
  v_lshl_add_u32 v235, v234, 5, v235
  v_lshl_add_u32 v235, v233, 3, v235
  v_lshrrev_b32 v232, 1, v232
  v_lshl_add_u32 v235, v232, 6, v235
  s_lshl_b32 s48, s8, 12
  s_add_u32 s48, s48, 131072
  v_add_u32 v246, s48, v235
  v_xor_b32 v247, 64, v246
  v_mov_b32 v245, 147472
  s_lshl_b32 s42, s8, 2
  s_add_u32 s42, s42, 147456
  v_mov_b32 v248, s42
  v_add_u32 v231, s55, v250
  v_add_u32 v230, 0x10000, v231
  s_mov_b32 s83, 0
  s_add_u32 s49, s88, 0
  buffer_load_dwordx4 v[0:3], v240, s[96:99], s49 offen offset:0 nt
  buffer_load_dwordx4 v[4:7], v241, s[96:99], s49 offen offset:1024 nt
  buffer_load_dwordx4 v[8:11], v242, s[96:99], s49 offen offset:2048 nt
  buffer_load_dwordx4 v[12:15], v243, s[96:99], s49 offen offset:3072 nt
  s_waitcnt vmcnt(2)
  s_add_u32 s49, s88, 4096
  buffer_load_dwordx4 v[16:19], v240, s[96:99], s49 offen offset:0 nt
  buffer_load_dwordx4 v[20:23], v241, s[96:99], s49 offen offset:1024 nt
  s_waitcnt vmcnt(2)
  buffer_load_dwordx4 v[24:27], v242, s[96:99], s49 offen offset:2048 nt
  buffer_load_dwordx4 v[28:31], v243, s[96:99], s49 offen offset:3072 nt
  v_lshlrev_b32 v229, 2, v255
  s_cmp_lg_u32 s8, 2
  s_cbranch_scc1 L_cks_a
  s_mov_b32 s47, 0x01010101
  s_mov_b32 s90, 0
L_ck_a:
  s_mov_b64 exec, 15
  buffer_load_dword v228, v229, s[36:39], 0 offen sc1
  s_waitcnt vmcnt(0)
  v_cmp_ne_u32 vcc, s47, v228
  s_mov_b64 exec, -1
  s_cbranch_vccz L_cko_a
  s_sleep 16
  s_add_u32 s90, s90, 1
  s_cmp_lt_u32 s90, 0x20000
  s_cbranch_scc1 L_ck_a
L_cko_a:
  v_mov_b32 v232, 1
  v_mov_b32 v233, 1
  v_mov_b32 v234, 1
  v_mov_b32 v235, 1
  s_mov_b64 exec, 1
  ds_write_b128 v245, v[232:235] offset:48
  s_mov_b64 exec, -1
L_cks_a:
  v_mov_b32 v239, 147504
  s_mov_b32 s91, 2
  s_call_b64 s[50:51], L_h2spin
  s_waitcnt vmcnt(0)
  ds_write_b128 v231, v[0:3] offset:0
  ds_write_b128 v231, v[4:7] offset:1024
  ds_write_b128 v231, v[8:11] offset:2048
  ds_write_b128 v231, v[12:15] offset:3072
  ds_write_b128 v231, v[16:19] offset:4096
  ds_write_b128 v231, v[20:23] offset:5120
  ds_write_b128 v231, v[24:27] offset:6144
  ds_write_b128 v231, v[28:31] offset:7168
  s_waitcnt lgkmcnt(0)
  s_add_u32 s46, s54, 1
  v_mov_b32 v237, s46
  s_mov_b64 exec, 1
  ds_write_b32 v248, v237
  s_mov_b64 exec, -1
  v_mov_b32 v239, 147488
  s_mov_b32 s91, 1
  s_call_b64 s[50:51], L_h2spin
  s_add_u32 m0, s55, 32768
  s_add_u32 s49, s88, 16384
  buffer_load_dwordx4 v240, s[96:99], s49 offen offset:0 nt lds
  buffer_load_dwordx4 v241, s[96:99], s49 offen offset:1024 nt lds
  buffer_load_dwordx4 v242, s[96:99], s49 offen offset:2048 nt lds
  buffer_load_dwordx4 v243, s[96:99], s49 offen offset:3072 nt lds
  s_add_u32 m0, s55, 36864
  s_add_u32 s49, s88, 20480
  buffer_load_dwordx4 v240, s[96:99], s49 offen offset:0 nt lds
  buffer_load_dwordx4 v241, s[96:99], s49 offen offset:1024 nt lds
  buffer_load_dwordx4 v242, s[96:99], s49 offen offset:2048 nt lds
  buffer_load_dwordx4 v243, s[96:99], s49 offen offset:3072 nt lds
  s_waitcnt vmcnt(6)
  s_add_u32 m0, s55, 65536
  s_add_u32 s49, s88, 32768
  buffer_load_dwordx4 v240, s[96:99], s49 offen offset:0 nt lds
  buffer_load_dwordx4 v241, s[96:99], s49 offen offset:1024 nt lds
  s_waitcnt vmcnt(6)
  buffer_load_dwordx4 v242, s[96:99], s49 offen offset:2048 nt lds
  buffer_load_dwordx4 v243, s[96:99], s49 offen offset:3072 nt lds
  s_waitcnt vmcnt(6)
  s_add_u32 m0, s55, 69632
  s_add_u32 s49, s88, 36864
  buffer_load_dwordx4 v240, s[96:99], s49 offen offset:0 nt lds
  buffer_load_dwordx4 v241, s[96:99], s49 offen offset:1024 nt lds
  s_waitcnt vmcnt(6)
  s_add_u32 s46, s54, 2
  v_mov_b32 v237, s46
  s_mov_b64 exec, 1
  ds_write_b32 v248, v237
  s_mov_b64 exec, -1
  buffer_load_dwordx4 v242, s[96:99], s49 offen offset:2048 nt lds
  buffer_load_dwordx4 v243, s[96:99], s49 offen offset:3072 nt lds
  s_waitcnt vmcnt(6)
  s_add_u32 m0, s55, 98304
  s_add_u32 s49, s88, 49152
  buffer_load_dwordx4 v240, s[96:99], s49 offen offset:0 nt lds
  buffer_load_dwordx4 v241, s[96:99], s49 offen offset:1024 nt lds
  s_waitcnt vmcnt(6)
  buffer_load_dwordx4 v242, s[96:99], s49 offen offset:2048 nt lds
  buffer_load_dwordx4 v243, s[96:99], s49 offen offset:3072 nt lds
  s_waitcnt vmcnt(6)
  s_add_u32 m0, s55, 102400
  s_add_u32 s49, s88, 53248
  buffer_load_dwordx4 v240, s[96:99], s49 offen offset:0 nt lds
  buffer_load_dwordx4 v241, s[96:99], s49 offen offset:1024 nt lds
  s_waitcnt vmcnt(6)
  s_add_u32 s46, s54, 3
  v_mov_b32 v237, s46
  s_mov_b64 exec, 1
  ds_write_b32 v248, v237
  s_mov_b64 exec, -1
  buffer_load_dwordx4 v242, s[96:99], s49 offen offset:2048 nt lds
  buffer_load_dwordx4 v243, s[96:99], s49 offen offset:3072 nt lds
  ds_read_b128 v[232:235], v245
  s_add_u32 s91, s54, 1
  s_waitcnt lgkmcnt(0)
  v_min3_u32 v236, v232, v233, v234
  v_min_u32 v236, v236, v235
  v_cmp_gt_u32 vcc, s91, v236
  s_cbranch_vccz L_hf_i4
  s_waitcnt vmcnt(0)
  s_add_u32 s46, s54, 4
  v_mov_b32 v237, s46
  s_mov_b64 exec, 1
  ds_write_b32 v248, v237
  s_mov_b64 exec, -1
  s_call_b64 s[50:51], L_hspin
L_hf_i4:
  s_waitcnt lgkmcnt(0)
  s_waitcnt vmcnt(6)
  s_add_u32 m0, s55, 0
  s_add_u32 s49, s88, 65536
  buffer_load_dwordx4 v240, s[96:99], s49 offen offset:0 nt lds
  buffer_load_dwordx4 v241, s[96:99], s49 offen offset:1024 nt lds
  s_waitcnt vmcnt(6)
  buffer_load_dwordx4 v242, s[96:99], s49 offen offset:2048 nt lds
  buffer_load_dwordx4 v243, s[96:99], s49 offen offset:3072 nt lds
  s_waitcnt vmcnt(6)
  s_add_u32 m0, s55, 4096
  s_add_u32 s49, s88, 69632
  buffer_load_dwordx4 v240, s[96:99], s49 offen offset:0 nt lds
  buffer_load_dwordx4 v241, s[96:99], s49 offen offset:1024 nt lds
  s_waitcnt vmcnt(6)
  s_add_u32 s46, s54, 4
  v_mov_b32 v237, s46
  s_mov_b64 exec, 1
  ds_write_b32 v248, v237
  s_mov_b64 exec, -1
  buffer_load_dwordx4 v242, s[96:99], s49 offen offset:2048 nt lds
  buffer_load_dwordx4 v243, s[96:99], s49 offen offset:3072 nt lds
  s_waitcnt lgkmcnt(0)
  s_add_u32 s82, s83, 0
  s_and_b32 s82, s82, 15
  s_lshl_b32 s82, s82, 15
  s_add_u32 s82, s82, s52
  s_waitcnt vmcnt(6)
  s_add_u32 m0, s48, 0
  s_add_u32 s47, s82, 0
  buffer_load_dwordx4 v244, s[28:31], s47 offen nt lds
  s_add_u32 m0, s48, 1024
  s_add_u32 s47, s82, 8192
  buffer_load_dwordx4 v244, s[28:31], s47 offen nt lds
  s_waitcnt vmcnt(6)
  s_add_u32 m0, s48, 2048
  s_add_u32 s47, s82, 16384
  buffer_load_dwordx4 v244, s[28:31], s47 offen nt lds
  s_add_u32 m0, s48, 3072
  s_add_u32 s47, s82, 24576
  buffer_load_dwordx4 v244, s[28:31], s47 offen nt lds
  ds_read_b128 v[232:235], v245
  s_add_u32 s91, s54, 2
  s_waitcnt lgkmcnt(0)
  v_min3_u32 v236, v232, v233, v234
  v_min_u32 v236, v236, v235
  v_cmp_gt_u32 vcc, s91, v236
  s_cbranch_vccz L_hf_i5
  s_waitcnt vmcnt(0)
  s_add_u32 s46, s54, 5
  v_mov_b32 v237, s46
  s_mov_b64 exec, 1
  ds_write_b32 v248, v237
  s_mov_b64 exec, -1
  s_call_b64 s[50:51], L_hspin
L_hf_i5:
  s_waitcnt lgkmcnt(0)
  s_waitcnt vmcnt(6)
  s_add_u32 m0, s55, 32768
  s_add_u32 s49, s88, 81920
  buffer_load_dwordx4 v240, s[96:99], s49 offen offset:0 nt lds
  buffer_load_dwordx4 v241, s[96:99], s49 offen offset:1024 nt lds
  s_waitcnt vmcnt(6)
  s_add_u32 s46, s54, 5
  v_mov_b32 v237, s46
  s_mov_b64 exec, 1
  ds_write_b32 v248, v237
  s_mov_b64 exec, -1
  buffer_load_dwordx4 v242, s[96:99], s49 offen offset:2048 nt lds
  buffer_load_dwordx4 v243, s[96:99], s49 offen offset:3072 nt lds
  s_waitcnt vmcnt(6)
  s_add_u32 m0, s55, 36864
  s_add_u32 s49, s88, 86016
  buffer_load_dwordx4 v240, s[96:99], s49 offen offset:0 nt lds
  buffer_load_dwordx4 v241, s[96:99], s49 offen offset:1024 nt lds
  s_waitcnt vmcnt(6)
  ds_read_b64_tr_b16 v[0:1], v246 offset:0
  ds_read_b64_tr_b16 v[2:3], v246 offset:512
  ds_read_b64_tr_b16 v[4:5], v247 offset:0
  ds_read_b64_tr_b16 v[6:7], v247 offset:512
  ds_read_b64_tr_b16 v[8:9], v246 offset:2048
  ds_read_b64_tr_b16 v[10:11], v246 offset:2560
  ds_read_b64_tr_b16 v[12:13], v247 offset:2048
  ds_read_b64_tr_b16 v[14:15], v247 offset:2560
  buffer_load_dwordx4 v242, s[96:99], s49 offen offset:2048 nt lds
  buffer_load_dwordx4 v243, s[96:99], s49 offen offset:3072 nt lds
  s_waitcnt lgkmcnt(0)
  s_add_u32 s82, s83, 1
  s_and_b32 s82, s82, 15
  s_lshl_b32 s82, s82, 15
  s_add_u32 s82, s82, s52
  s_waitcnt vmcnt(6)
  s_add_u32 m0, s48, 0
  s_add_u32 s47, s82, 0
  buffer_load_dwordx4 v244, s[28:31], s47 offen nt lds
  s_add_u32 m0, s48, 1024
  s_add_u32 s47, s82, 8192
  buffer_load_dwordx4 v244, s[28:31], s47 offen nt lds
  s_waitcnt vmcnt(6)
  s_add_u32 m0, s48, 2048
  s_add_u32 s47, s82, 16384
  buffer_load_dwordx4 v244, s[28:31], s47 offen nt lds
  s_add_u32 m0, s48, 3072
  s_add_u32 s47, s82, 24576
  buffer_load_dwordx4 v244, s[28:31], s47 offen nt lds
  ds_read_b128 v[232:235], v245
  s_add_u32 s91, s54, 3
  s_waitcnt lgkmcnt(0)
  v_min3_u32 v236, v232, v233, v234
  v_min_u32 v236, v236, v235
  v_cmp_gt_u32 vcc, s91, v236
  s_cbranch_vccz L_hf_i6
  s_waitcnt vmcnt(0)
  s_add_u32 s46, s54, 6
  v_mov_b32 v237, s46
  s_mov_b64 exec, 1
  ds_write_b32 v248, v237
  s_mov_b64 exec, -1
  s_call_b64 s[50:51], L_hspin
L_hf_i6:
  s_waitcnt lgkmcnt(0)
  s_waitcnt vmcnt(6)
  s_add_u32 m0, s55, 65536
  s_add_u32 s49, s88, 98304
  buffer_load_dwordx4 v240, s[96:99], s49 offen offset:0 nt lds
  buffer_load_dwordx4 v241, s[96:99], s49 offen offset:1024 nt lds
  s_waitcnt vmcnt(6)
  s_add_u32 s46, s54, 6
  v_mov_b32 v237, s46
  s_mov_b64 exec, 1
  ds_write_b32 v248, v237
  s_mov_b64 exec, -1
  buffer_load_dwordx4 v242, s[96:99], s49 offen offset:2048 nt lds
  buffer_load_dwordx4 v243, s[96:99], s49 offen offset:3072 nt lds
  s_waitcnt vmcnt(6)
  s_add_u32 m0, s55, 69632
  s_add_u32 s49, s88, 102400
  buffer_load_dwordx4 v240, s[96:99], s49 offen offset:0 nt lds
  buffer_load_dwordx4 v241, s[96:99], s49 offen offset:1024 nt lds
  s_waitcnt vmcnt(6)
  ds_read_b64_tr_b16 v[16:17], v246 offset:0
  ds_read_b64_tr_b16 v[18:19], v246 offset:512
  ds_read_b64_tr_b16 v[20:21], v247 offset:0
  ds_read_b64_tr_b16 v[22:23], v247 offset:512
  ds_read_b64_tr_b16 v[24:25], v246 offset:2048
  ds_read_b64_tr_b16 v[26:27], v246 offset:2560
  ds_read_b64_tr_b16 v[28:29], v247 offset:2048
  ds_read_b64_tr_b16 v[30:31], v247 offset:2560
  buffer_load_dwordx4 v242, s[96:99], s49 offen offset:2048 nt lds
  buffer_load_dwordx4 v243, s[96:99], s49 offen offset:3072 nt lds
  s_waitcnt lgkmcnt(0)
  s_add_u32 s82, s83, 2
  s_and_b32 s82, s82, 15
  s_lshl_b32 s82, s82, 15
  s_add_u32 s82, s82, s52
  s_waitcnt vmcnt(6)
  s_add_u32 m0, s48, 0
  s_add_u32 s47, s82, 0
  buffer_load_dwordx4 v244, s[28:31], s47 offen nt lds
  s_add_u32 m0, s48, 1024
  s_add_u32 s47, s82, 8192
  buffer_load_dwordx4 v244, s[28:31], s47 offen nt lds
  s_waitcnt vmcnt(6)
  s_add_u32 m0, s48, 2048
  s_add_u32 s47, s82, 16384
  buffer_load_dwordx4 v244, s[28:31], s47 offen nt lds
  s_add_u32 m0, s48, 3072
  s_add_u32 s47, s82, 24576
  buffer_load_dwordx4 v244, s[28:31], s47 offen nt lds
  ds_read_b128 v[232:235], v245
  s_add_u32 s91, s54, 4
  s_waitcnt lgkmcnt(0)
  v_min3_u32 v236, v232, v233, v234
  v_min_u32 v236, v236, v235
  v_cmp_gt_u32 vcc, s91, v236
  s_cbranch_vccz L_hf_i7
  s_waitcnt vmcnt(0)
  s_add_u32 s46, s54, 7
  v_mov_b32 v237, s46
  s_mov_b64 exec, 1
  ds_write_b32 v248, v237
  s_mov_b64 exec, -1
  s_call_b64 s[50:51], L_hspin
L_hf_i7:
  s_waitcnt lgkmcnt(0)
  s_waitcnt vmcnt(6)
  s_add_u32 m0, s55, 98304
  s_add_u32 s49, s88, 114688
  buffer_load_dwordx4 v240, s[96:99], s49 offen offset:0 nt lds
  buffer_load_dwordx4 v241, s[96:99], s49 offen offset:1024 nt lds
  s_waitcnt vmcnt(6)
  s_add_u32 s46, s54, 7
  v_mov_b32 v237, s46
  s_mov_b64 exec, 1
  ds_write_b32 v248, v237
  s_mov_b64 exec, -1
  buffer_load_dwordx4 v242, s[96:99], s49 offen offset:2048 nt lds
  buffer_load_dwordx4 v243, s[96:99], s49 offen offset:3072 nt lds
  s_waitcnt vmcnt(6)
  s_add_u32 m0, s55, 102400
  s_add_u32 s49, s88, 118784
  buffer_load_dwordx4 v240, s[96:99], s49 offen offset:0 nt lds
  buffer_load_dwordx4 v241, s[96:99], s49 offen offset:1024 nt lds
  s_waitcnt vmcnt(6)
  ds_read_b64_tr_b16 v[32:33], v246 offset:0
  ds_read_b64_tr_b16 v[34:35], v246 offset:512
  ds_read_b64_tr_b16 v[36:37], v247 offset:0
  ds_read_b64_tr_b16 v[38:39], v247 offset:512
  ds_read_b64_tr_b16 v[40:41], v246 offset:2048
  ds_read_b64_tr_b16 v[42:43], v246 offset:2560
  ds_read_b64_tr_b16 v[44:45], v247 offset:2048
  ds_read_b64_tr_b16 v[46:47], v247 offset:2560
  buffer_load_dwordx4 v242, s[96:99], s49 offen offset:2048 nt lds
  buffer_load_dwordx4 v243, s[96:99], s49 offen offset:3072 nt lds
  s_waitcnt lgkmcnt(0)
  s_add_u32 s82, s83, 3
  s_and_b32 s82, s82, 15
  s_lshl_b32 s82, s82, 15
  s_add_u32 s82, s82, s52
  s_waitcnt vmcnt(6)
  s_add_u32 m0, s48, 0
  s_add_u32 s47, s82, 0
  buffer_load_dwordx4 v244, s[28:31], s47 offen nt lds
  s_add_u32 m0, s48, 1024
  s_add_u32 s47, s82, 8192
  buffer_load_dwordx4 v244, s[28:31], s47 offen nt lds
  s_waitcnt vmcnt(6)
  s_add_u32 m0, s48, 2048
  s_add_u32 s47, s82, 16384
  buffer_load_dwordx4 v244, s[28:31], s47 offen nt lds
  s_add_u32 m0, s48, 3072
  s_add_u32 s47, s82, 24576
  buffer_load_dwordx4 v244, s[28:31], s47 offen nt lds
  ds_read_b128 v[232:235], v245
  s_add_u32 s91, s54, 5
  s_waitcnt lgkmcnt(0)
  v_min3_u32 v236, v232, v233, v234
  v_min_u32 v236, v236, v235
  v_cmp_gt_u32 vcc, s91, v236
  s_cbranch_vccz L_hf_i8
  s_waitcnt vmcnt(0)
  s_add_u32 s46, s54, 8
  v_mov_b32 v237, s46
  s_mov_b64 exec, 1
  ds_write_b32 v248, v237
  s_mov_b64 exec, -1
  s_call_b64 s[50:51], L_hspin
L_hf_i8:
  s_waitcnt lgkmcnt(0)
  s_waitcnt vmcnt(6)
  s_add_u32 m0, s55, 0
  s_add_u32 s49, s88, 131072
  buffer_load_dwordx4 v240, s[96:99], s49 offen offset:0 nt lds
  buffer_load_dwordx4 v241, s[96:99], s49 offen offset:1024 nt lds
  s_waitcnt vmcnt(6)
  s_add_u32 s46, s54, 8
  v_mov_b32 v237, s46
  s_mov_b64 exec, 1
  ds_write_b32 v248, v237
  s_mov_b64 exec, -1
  buffer_load_dwordx4 v242, s[96:99], s49 offen offset:2048 nt lds
  buffer_load_dwordx4 v243, s[96:99], s49 offen offset:3072 nt lds
  s_waitcnt vmcnt(6)
  s_add_u32 m0, s55, 4096
  s_add_u32 s49, s88, 135168
  buffer_load_dwordx4 v240, s[96:99], s49 offen offset:0 nt lds
  buffer_load_dwordx4 v241, s[96:99], s49 offen offset:1024 nt lds
  s_waitcnt vmcnt(6)
  ds_read_b64_tr_b16 v[48:49], v246 offset:0
  ds_read_b64_tr_b16 v[50:51], v246 offset:512
  ds_read_b64_tr_b16 v[52:53], v247 offset:0
  ds_read_b64_tr_b16 v[54:55], v247 offset:512
  ds_read_b64_tr_b16 v[56:57], v246 offset:2048
  ds_read_b64_tr_b16 v[58:59], v246 offset:2560
  ds_read_b64_tr_b16 v[60:61], v247 offset:2048
  ds_read_b64_tr_b16 v[62:63], v247 offset:2560
  buffer_load_dwordx4 v242, s[96:99], s49 offen offset:2048 nt lds
  buffer_load_dwordx4 v243, s[96:99], s49 offen offset:3072 nt lds
  s_waitcnt lgkmcnt(0)
  s_add_u32 s82, s83, 4
  s_and_b32 s82, s82, 15
  s_lshl_b32 s82, s82, 15
  s_add_u32 s82, s82, s52
  s_waitcnt vmcnt(6)
  s_add_u32 m0, s48, 0
  s_add_u32 s47, s82, 0
  buffer_load_dwordx4 v244, s[28:31], s47 offen nt lds
  s_add_u32 m0, s48, 1024
  s_add_u32 s47, s82, 8192
  buffer_load_dwordx4 v244, s[28:31], s47 offen nt lds
  s_waitcnt vmcnt(6)
  s_add_u32 m0, s48, 2048
  s_add_u32 s47, s82, 16384
  buffer_load_dwordx4 v244, s[28:31], s47 offen nt lds
  s_add_u32 m0, s48, 3072
  s_add_u32 s47, s82, 24576
  buffer_load_dwordx4 v244, s[28:31], s47 offen nt lds
  ds_read_b128 v[232:235], v245
  s_add_u32 s91, s54, 6
  s_waitcnt lgkmcnt(0)
  v_min3_u32 v236, v232, v233, v234
  v_min_u32 v236, v236, v235
  v_cmp_gt_u32 vcc, s91, v236
  s_cbranch_vccz L_hf_i9
  s_waitcnt vmcnt(0)
  s_add_u32 s46, s54, 9
  v_mov_b32 v237, s46
  s_mov_b64 exec, 1
  ds_write_b32 v248, v237
  s_mov_b64 exec, -1
  s_call_b64 s[50:51], L_hspin
L_hf_i9:
  s_waitcnt lgkmcnt(0)
  s_waitcnt vmcnt(6)
  s_add_u32 m0, s55, 32768
  s_add_u32 s49, s88, 147456
  buffer_load_dwordx4 v240, s[96:99], s49 offen offset:0 nt lds
  buffer_load_dwordx4 v241, s[96:99], s49 offen offset:1024 nt lds
  s_waitcnt vmcnt(6)
  s_add_u32 s46, s54, 9
  v_mov_b32 v237, s46
  s_mov_b64 exec, 1
  ds_write_b32 v248, v237
  s_mov_b64 exec, -1
  buffer_load_dwordx4 v242, s[96:99], s49 offen offset:2048 nt lds
  buffer_load_dwordx4 v243, s[96:99], s49 offen offset:3072 nt lds
  s_waitcnt vmcnt(6)
  s_add_u32 m0, s55, 36864
  s_add_u32 s49, s88, 151552
  buffer_load_dwordx4 v240, s[96:99], s49 offen offset:0 nt lds
  buffer_load_dwordx4 v241, s[96:99], s49 offen offset:1024 nt lds
  s_waitcnt vmcnt(6)
  ds_read_b64_tr_b16 v[64:65], v246 offset:0
  ds_read_b64_tr_b16 v[66:67], v246 offset:512
  ds_read_b64_tr_b16 v[68:69], v247 offset:0
  ds_read_b64_tr_b16 v[70:71], v247 offset:512
  ds_read_b64_tr_b16 v[72:73], v246 offset:2048
  ds_read_b64_tr_b16 v[74:75], v246 offset:2560
  ds_read_b64_tr_b16 v[76:77], v247 offset:2048
  ds_read_b64_tr_b16 v[78:79], v247 offset:2560
  buffer_load_dwordx4 v242, s[96:99], s49 offen offset:2048 nt lds
  buffer_load_dwordx4 v243, s[96:99], s49 offen offset:3072 nt lds
  s_waitcnt lgkmcnt(0)
  s_add_u32 s82, s83, 5
  s_and_b32 s82, s82, 15
  s_lshl_b32 s82, s82, 15
  s_add_u32 s82, s82, s52
  s_waitcnt vmcnt(6)
  s_add_u32 m0, s48, 0
  s_add_u32 s47, s82, 0
  buffer_load_dwordx4 v244, s[28:31], s47 offen nt lds
  s_add_u32 m0, s48, 1024
  s_add_u32 s47, s82, 8192
  buffer_load_dwordx4 v244, s[28:31], s47 offen nt lds
  s_waitcnt vmcnt(6)
  s_add_u32 m0, s48, 2048
  s_add_u32 s47, s82, 16384
  buffer_load_dwordx4 v244, s[28:31], s47 offen nt lds
  s_add_u32 m0, s48, 3072
  s_add_u32 s47, s82, 24576
  buffer_load_dwordx4 v244, s[28:31], s47 offen nt lds
  ds_read_b128 v[232:235], v245
  s_add_u32 s91, s54, 7
  s_waitcnt lgkmcnt(0)
  v_min3_u32 v236, v232, v233, v234
  v_min_u32 v236, v236, v235
  v_cmp_gt_u32 vcc, s91, v236
  s_cbranch_vccz L_hf_i10
  s_waitcnt vmcnt(0)
  s_add_u32 s46, s54, 10
  v_mov_b32 v237, s46
  s_mov_b64 exec, 1
  ds_write_b32 v248, v237
  s_mov_b64 exec, -1
  s_call_b64 s[50:51], L_hspin
L_hf_i10:
  s_waitcnt lgkmcnt(0)
  s_waitcnt vmcnt(6)
  s_add_u32 m0, s55, 65536
  s_add_u32 s49, s88, 163840
  buffer_load_dwordx4 v240, s[96:99], s49 offen offset:0 nt lds
  buffer_load_dwordx4 v241, s[96:99], s49 offen offset:1024 nt lds
  s_waitcnt vmcnt(6)
  s_add_u32 s46, s54, 10
  v_mov_b32 v237, s46
  s_mov_b64 exec, 1
  ds_write_b32 v248, v237
  s_mov_b64 exec, -1
  buffer_load_dwordx4 v242, s[96:99], s49 offen offset:2048 nt lds
  buffer_load_dwordx4 v243, s[96:99], s49 offen offset:3072 nt lds
  s_waitcnt vmcnt(6)
  s_add_u32 m0, s55, 69632
  s_add_u32 s49, s88, 167936
  buffer_load_dwordx4 v240, s[96:99], s49 offen offset:0 nt lds
  buffer_load_dwordx4 v241, s[96:99], s49 offen offset:1024 nt lds
  s_waitcnt vmcnt(6)
  ds_read_b64_tr_b16 v[80:81], v246 offset:0
  ds_read_b64_tr_b16 v[82:83], v246 offset:512
  ds_read_b64_tr_b16 v[84:85], v247 offset:0
  ds_read_b64_tr_b16 v[86:87], v247 offset:512
  ds_read_b64_tr_b16 v[88:89], v246 offset:2048
  ds_read_b64_tr_b16 v[90:91], v246 offset:2560
  ds_read_b64_tr_b16 v[92:93], v247 offset:2048
  ds_read_b64_tr_b16 v[94:95], v247 offset:2560
  buffer_load_dwordx4 v242, s[96:99], s49 offen offset:2048 nt lds
  buffer_load_dwordx4 v243, s[96:99], s49 offen offset:3072 nt lds
  s_waitcnt lgkmcnt(0)
  s_add_u32 s82, s83, 6
  s_and_b32 s82, s82, 15
  s_lshl_b32 s82, s82, 15
  s_add_u32 s82, s82, s52
  s_waitcnt vmcnt(6)
  s_add_u32 m0, s48, 0
  s_add_u32 s47, s82, 0
  buffer_load_dwordx4 v244, s[28:31], s47 offen nt lds
  s_add_u32 m0, s48, 1024
  s_add_u32 s47, s82, 8192
  buffer_load_dwordx4 v244, s[28:31], s47 offen nt lds
  s_waitcnt vmcnt(6)
  s_add_u32 m0, s48, 2048
  s_add_u32 s47, s82, 16384
  buffer_load_dwordx4 v244, s[28:31], s47 offen nt lds
  s_add_u32 m0, s48, 3072
  s_add_u32 s47, s82, 24576
  buffer_load_dwordx4 v244, s[28:31], s47 offen nt lds
  ds_read_b128 v[232:235], v245
  s_add_u32 s91, s54, 8
  s_waitcnt lgkmcnt(0)
  v_min3_u32 v236, v232, v233, v234
  v_min_u32 v236, v236, v235
  v_cmp_gt_u32 vcc, s91, v236
  s_cbranch_vccz L_hf_i11
  s_waitcnt vmcnt(0)
  s_add_u32 s46, s54, 11
  v_mov_b32 v237, s46
  s_mov_b64 exec, 1
  ds_write_b32 v248, v237
  s_mov_b64 exec, -1
  s_call_b64 s[50:51], L_hspin
L_hf_i11:
  s_waitcnt lgkmcnt(0)
  s_waitcnt vmcnt(6)
  s_add_u32 m0, s55, 98304
  s_add_u32 s49, s88, 180224
  buffer_load_dwordx4 v240, s[96:99], s49 offen offset:0 nt lds
  buffer_load_dwordx4 v241, s[96:99], s49 offen offset:1024 nt lds
  s_waitcnt vmcnt(6)
  s_add_u32 s46, s54, 11
  v_mov_b32 v237, s46
  s_mov_b64 exec, 1
  ds_write_b32 v248, v237
  s_mov_b64 exec, -1
  buffer_load_dwordx4 v242, s[96:99], s49 offen offset:2048 nt lds
  buffer_load_dwordx4 v243, s[96:99], s49 offen offset:3072 nt lds
  s_waitcnt vmcnt(6)
  s_add_u32 m0, s55, 102400
  s_add_u32 s49, s88, 184320
  buffer_load_dwordx4 v240, s[96:99], s49 offen offset:0 nt lds
  buffer_load_dwordx4 v241, s[96:99], s49 offen offset:1024 nt lds
  s_waitcnt vmcnt(6)
  ds_read_b64_tr_b16 v[96:97], v246 offset:0
  ds_read_b64_tr_b16 v[98:99], v246 offset:512
  ds_read_b64_tr_b16 v[100:101], v247 offset:0
  ds_read_b64_tr_b16 v[102:103], v247 offset:512
  ds_read_b64_tr_b16 v[104:105], v246 offset:2048
  ds_read_b64_tr_b16 v[106:107], v246 offset:2560
  ds_read_b64_tr_b16 v[108:109], v247 offset:2048
  ds_read_b64_tr_b16 v[110:111], v247 offset:2560
  buffer_load_dwordx4 v242, s[96:99], s49 offen offset:2048 nt lds
  buffer_load_dwordx4 v243, s[96:99], s49 offen offset:3072 nt lds
  s_waitcnt lgkmcnt(0)
  s_add_u32 s82, s83, 7
  s_and_b32 s82, s82, 15
  s_lshl_b32 s82, s82, 15
  s_add_u32 s82, s82, s52
  s_waitcnt vmcnt(6)
  s_add_u32 m0, s48, 0
  s_add_u32 s47, s82, 0
  buffer_load_dwordx4 v244, s[28:31], s47 offen nt lds
  s_add_u32 m0, s48, 1024
  s_add_u32 s47, s82, 8192
  buffer_load_dwordx4 v244, s[28:31], s47 offen nt lds
  s_waitcnt vmcnt(6)
  s_add_u32 m0, s48, 2048
  s_add_u32 s47, s82, 16384
  buffer_load_dwordx4 v244, s[28:31], s47 offen nt lds
  s_add_u32 m0, s48, 3072
  s_add_u32 s47, s82, 24576
  buffer_load_dwordx4 v244, s[28:31], s47 offen nt lds
  ds_read_b128 v[232:235], v245
  s_add_u32 s91, s54, 9
  s_waitcnt lgkmcnt(0)
  v_min3_u32 v236, v232, v233, v234
  v_min_u32 v236, v236, v235
  v_cmp_gt_u32 vcc, s91, v236
  s_cbranch_vccz L_hf_i12
  s_waitcnt vmcnt(0)
  s_add_u32 s46, s54, 12
  v_mov_b32 v237, s46
  s_mov_b64 exec, 1
  ds_write_b32 v248, v237
  s_mov_b64 exec, -1
  s_call_b64 s[50:51], L_hspin
L_hf_i12:
  s_waitcnt lgkmcnt(0)
  s_waitcnt vmcnt(6)
  s_add_u32 m0, s55, 0
  s_add_u32 s49, s88, 196608
  buffer_load_dwordx4 v240, s[96:99], s49 offen offset:0 nt lds
  buffer_load_dwordx4 v241, s[96:99], s49 offen offset:1024 nt lds
  s_waitcnt vmcnt(6)
  s_add_u32 s46, s54, 12
  v_mov_b32 v237, s46
  s_mov_b64 exec, 1
  ds_write_b32 v248, v237
  s_mov_b64 exec, -1
  buffer_load_dwordx4 v242, s[96:99], s49 offen offset:2048 nt lds
  buffer_load_dwordx4 v243, s[96:99], s49 offen offset:3072 nt lds
  s_waitcnt vmcnt(6)
  s_add_u32 m0, s55, 4096
  s_add_u32 s49, s88, 200704
  buffer_load_dwordx4 v240, s[96:99], s49 offen offset:0 nt lds
  buffer_load_dwordx4 v241, s[96:99], s49 offen offset:1024 nt lds
  s_waitcnt vmcnt(6)
  ds_read_b64_tr_b16 v[112:113], v246 offset:0
  ds_read_b64_tr_b16 v[114:115], v246 offset:512
  ds_read_b64_tr_b16 v[116:117], v247 offset:0
  ds_read_b64_tr_b16 v[118:119], v247 offset:512
  ds_read_b64_tr_b16 v[120:121], v246 offset:2048
  ds_read_b64_tr_b16 v[122:123], v246 offset:2560
  ds_read_b64_tr_b16 v[124:125], v247 offset:2048
  ds_read_b64_tr_b16 v[126:127], v247 offset:2560
  buffer_load_dwordx4 v242, s[96:99], s49 offen offset:2048 nt lds
  buffer_load_dwordx4 v243, s[96:99], s49 offen offset:3072 nt lds
  s_waitcnt lgkmcnt(0)
  s_add_u32 s82, s83, 8
  s_and_b32 s82, s82, 15
  s_lshl_b32 s82, s82, 15
  s_add_u32 s82, s82, s52
  s_waitcnt vmcnt(6)
  s_add_u32 m0, s48, 0
  s_add_u32 s47, s82, 0
  buffer_load_dwordx4 v244, s[28:31], s47 offen nt lds
  s_add_u32 m0, s48, 1024
  s_add_u32 s47, s82, 8192
  buffer_load_dwordx4 v244, s[28:31], s47 offen nt lds
  s_waitcnt vmcnt(6)
  s_add_u32 m0, s48, 2048
  s_add_u32 s47, s82, 16384
  buffer_load_dwordx4 v244, s[28:31], s47 offen nt lds
  s_add_u32 m0, s48, 3072
  s_add_u32 s47, s82, 24576
  buffer_load_dwordx4 v244, s[28:31], s47 offen nt lds
  ds_read_b128 v[232:235], v245
  s_add_u32 s91, s54, 10
  s_waitcnt lgkmcnt(0)
  v_min3_u32 v236, v232, v233, v234
  v_min_u32 v236, v236, v235
  v_cmp_gt_u32 vcc, s91, v236
  s_cbranch_vccz L_hf_i13
  s_waitcnt vmcnt(0)
  s_add_u32 s46, s54, 13
  v_mov_b32 v237, s46
  s_mov_b64 exec, 1
  ds_write_b32 v248, v237
  s_mov_b64 exec, -1
  s_call_b64 s[50:51], L_hspin
L_hf_i13:
  s_waitcnt lgkmcnt(0)
  s_waitcnt vmcnt(6)
  s_add_u32 m0, s55, 32768
  s_add_u32 s49, s88, 212992
  buffer_load_dwordx4 v240, s[96:99], s49 offen offset:0 nt lds
  buffer_load_dwordx4 v241, s[96:99], s49 offen offset:1024 nt lds
  s_waitcnt vmcnt(6)
  s_add_u32 s46, s54, 13
  v_mov_b32 v237, s46
  s_mov_b64 exec, 1
  ds_write_b32 v248, v237
  s_mov_b64 exec, -1
  buffer_load_dwordx4 v242, s[96:99], s49 offen offset:2048 nt lds
  buffer_load_dwordx4 v243, s[96:99], s49 offen offset:3072 nt lds
  s_waitcnt vmcnt(6)
  s_add_u32 m0, s55, 36864
  s_add_u32 s49, s88, 217088
  buffer_load_dwordx4 v240, s[96:99], s49 offen offset:0 nt lds
  buffer_load_dwordx4 v241, s[96:99], s49 offen offset:1024 nt lds
  s_waitcnt vmcnt(6)
  ds_read_b64_tr_b16 v[128:129], v246 offset:0
  ds_read_b64_tr_b16 v[130:131], v246 offset:512
  ds_read_b64_tr_b16 v[132:133], v247 offset:0
  ds_read_b64_tr_b16 v[134:135], v247 offset:512
  ds_read_b64_tr_b16 v[136:137], v246 offset:2048
  ds_read_b64_tr_b16 v[138:139], v246 offset:2560
  ds_read_b64_tr_b16 v[140:141], v247 offset:2048
  ds_read_b64_tr_b16 v[142:143], v247 offset:2560
  buffer_load_dwordx4 v242, s[96:99], s49 offen offset:2048 nt lds
  buffer_load_dwordx4 v243, s[96:99], s49 offen offset:3072 nt lds
  s_waitcnt lgkmcnt(0)
  s_add_u32 s82, s83, 9
  s_and_b32 s82, s82, 15
  s_lshl_b32 s82, s82, 15
  s_add_u32 s82, s82, s52
  s_waitcnt vmcnt(6)
  s_add_u32 m0, s48, 0
  s_add_u32 s47, s82, 0
  buffer_load_dwordx4 v244, s[28:31], s47 offen nt lds
  s_add_u32 m0, s48, 1024
  s_add_u32 s47, s82, 8192
  buffer_load_dwordx4 v244, s[28:31], s47 offen nt lds
  s_waitcnt vmcnt(6)
  s_add_u32 m0, s48, 2048
  s_add_u32 s47, s82, 16384
  buffer_load_dwordx4 v244, s[28:31], s47 offen nt lds
  s_add_u32 m0, s48, 3072
  s_add_u32 s47, s82, 24576
  buffer_load_dwordx4 v244, s[28:31], s47 offen nt lds
  ds_read_b128 v[232:235], v245
  s_add_u32 s91, s54, 11
  s_waitcnt lgkmcnt(0)
  v_min3_u32 v236, v232, v233, v234
  v_min_u32 v236, v236, v235
  v_cmp_gt_u32 vcc, s91, v236
  s_cbranch_vccz L_hf_i14
  s_waitcnt vmcnt(0)
  s_add_u32 s46, s54, 14
  v_mov_b32 v237, s46
  s_mov_b64 exec, 1
  ds_write_b32 v248, v237
  s_mov_b64 exec, -1
  s_call_b64 s[50:51], L_hspin
L_hf_i14:
  s_waitcnt lgkmcnt(0)
  s_waitcnt vmcnt(6)
  s_add_u32 m0, s55, 65536
  s_add_u32 s49, s88, 229376
  buffer_load_dwordx4 v240, s[96:99], s49 offen offset:0 nt lds
  buffer_load_dwordx4 v241, s[96:99], s49 offen offset:1024 nt lds
  s_waitcnt vmcnt(6)
  s_add_u32 s46, s54, 14
  v_mov_b32 v237, s46
  s_mov_b64 exec, 1
  ds_write_b32 v248, v237
  s_mov_b64 exec, -1
  buffer_load_dwordx4 v242, s[96:99], s49 offen offset:2048 nt lds
  buffer_load_dwordx4 v243, s[96:99], s49 offen offset:3072 nt lds
  s_waitcnt vmcnt(6)
  s_add_u32 m0, s55, 69632
  s_add_u32 s49, s88, 233472
  buffer_load_dwordx4 v240, s[96:99], s49 offen offset:0 nt lds
  buffer_load_dwordx4 v241, s[96:99], s49 offen offset:1024 nt lds
  s_waitcnt vmcnt(6)
  ds_read_b64_tr_b16 v[144:145], v246 offset:0
  ds_read_b64_tr_b16 v[146:147], v246 offset:512
  ds_read_b64_tr_b16 v[148:149], v247 offset:0
  ds_read_b64_tr_b16 v[150:151], v247 offset:512
  ds_read_b64_tr_b16 v[152:153], v246 offset:2048
  ds_read_b64_tr_b16 v[154:155], v246 offset:2560
  ds_read_b64_tr_b16 v[156:157], v247 offset:2048
  ds_read_b64_tr_b16 v[158:159], v247 offset:2560
  buffer_load_dwordx4 v242, s[96:99], s49 offen offset:2048 nt lds
  buffer_load_dwordx4 v243, s[96:99], s49 offen offset:3072 nt lds
  s_waitcnt lgkmcnt(0)
  s_add_u32 s82, s83, 10
  s_and_b32 s82, s82, 15
  s_lshl_b32 s82, s82, 15
  s_add_u32 s82, s82, s52
  s_waitcnt vmcnt(6)
  s_add_u32 m0, s48, 0
  s_add_u32 s47, s82, 0
  buffer_load_dwordx4 v244, s[28:31], s47 offen nt lds
  s_add_u32 m0, s48, 1024
  s_add_u32 s47, s82, 8192
  buffer_load_dwordx4 v244, s[28:31], s47 offen nt lds
  s_waitcnt vmcnt(6)
  s_add_u32 m0, s48, 2048
  s_add_u32 s47, s82, 16384
  buffer_load_dwordx4 v244, s[28:31], s47 offen nt lds
  s_add_u32 m0, s48, 3072
  s_add_u32 s47, s82, 24576
  buffer_load_dwordx4 v244, s[28:31], s47 offen nt lds
  ds_read_b128 v[232:235], v245
  s_add_u32 s91, s54, 12
  s_waitcnt lgkmcnt(0)
  v_min3_u32 v236, v232, v233, v234
  v_min_u32 v236, v236, v235
  v_cmp_gt_u32 vcc, s91, v236
  s_cbranch_vccz L_hf_i15
  s_waitcnt vmcnt(0)
  s_add_u32 s46, s54, 15
  v_mov_b32 v237, s46
  s_mov_b64 exec, 1
  ds_write_b32 v248, v237
  s_mov_b64 exec, -1
  s_call_b64 s[50:51], L_hspin
L_hf_i15:
  s_waitcnt lgkmcnt(0)
  s_waitcnt vmcnt(6)
  s_add_u32 m0, s55, 98304
  s_add_u32 s49, s88, 245760
  buffer_load_dwordx4 v240, s[96:99], s49 offen offset:0 nt lds
  buffer_load_dwordx4 v241, s[96:99], s49 offen offset:1024 nt lds
  s_waitcnt vmcnt(6)
  s_add_u32 s46, s54, 15
  v_mov_b32 v237, s46
  s_mov_b64 exec, 1
  ds_write_b32 v248, v237
  s_mov_b64 exec, -1
  buffer_load_dwordx4 v242, s[96:99], s49 offen offset:2048 nt lds
  buffer_load_dwordx4 v243, s[96:99], s49 offen offset:3072 nt lds
  s_waitcnt vmcnt(6)
  s_add_u32 m0, s55, 102400
  s_add_u32 s49, s88, 249856
  buffer_load_dwordx4 v240, s[96:99], s49 offen offset:0 nt lds
  buffer_load_dwordx4 v241, s[96:99], s49 offen offset:1024 nt lds
  s_waitcnt vmcnt(6)
  ds_read_b64_tr_b16 v[160:161], v246 offset:0
  ds_read_b64_tr_b16 v[162:163], v246 offset:512
  ds_read_b64_tr_b16 v[164:165], v247 offset:0
  ds_read_b64_tr_b16 v[166:167], v247 offset:512
  ds_read_b64_tr_b16 v[168:169], v246 offset:2048
  ds_read_b64_tr_b16 v[170:171], v246 offset:2560
  ds_read_b64_tr_b16 v[172:173], v247 offset:2048
  ds_read_b64_tr_b16 v[174:175], v247 offset:2560
  buffer_load_dwordx4 v242, s[96:99], s49 offen offset:2048 nt lds
  buffer_load_dwordx4 v243, s[96:99], s49 offen offset:3072 nt lds
  s_waitcnt lgkmcnt(0)
  s_add_u32 s82, s83, 11
  s_and_b32 s82, s82, 15
  s_lshl_b32 s82, s82, 15
  s_add_u32 s82, s82, s52
  s_waitcnt vmcnt(6)
  s_add_u32 m0, s48, 0
  s_add_u32 s47, s82, 0
  buffer_load_dwordx4 v244, s[28:31], s47 offen nt lds
  s_add_u32 m0, s48, 1024
  s_add_u32 s47, s82, 8192
  buffer_load_dwordx4 v244, s[28:31], s47 offen nt lds
  s_waitcnt vmcnt(6)
  s_add_u32 m0, s48, 2048
  s_add_u32 s47, s82, 16384
  buffer_load_dwordx4 v244, s[28:31], s47 offen nt lds
  s_add_u32 m0, s48, 3072
  s_add_u32 s47, s82, 24576
  buffer_load_dwordx4 v244, s[28:31], s47 offen nt lds
  s_waitcnt vmcnt(0) lgkmcnt(0)
  s_add_u32 s46, s54, 40
  v_mov_b32 v237, s46
  s_mov_b64 exec, 1
  ds_write_b32 v248, v237
  s_mov_b64 exec, -1
  ds_read_b64_tr_b16 v[176:177], v246 offset:0
  ds_read_b64_tr_b16 v[178:179], v246 offset:512
  ds_read_b64_tr_b16 v[180:181], v247 offset:0
  ds_read_b64_tr_b16 v[182:183], v247 offset:512
  ds_read_b64_tr_b16 v[184:185], v246 offset:2048
  ds_read_b64_tr_b16 v[186:187], v246 offset:2560
  ds_read_b64_tr_b16 v[188:189], v247 offset:2048
  ds_read_b64_tr_b16 v[190:191], v247 offset:2560
  s_waitcnt lgkmcnt(0)
  s_add_u32 s82, s83, 12
  s_and_b32 s82, s82, 15
  s_lshl_b32 s82, s82, 15
  s_add_u32 s82, s82, s52
  s_add_u32 m0, s48, 0
  s_add_u32 s47, s82, 0
  buffer_load_dwordx4 v244, s[28:31], s47 offen nt lds
  s_add_u32 m0, s48, 1024
  s_add_u32 s47, s82, 8192
  buffer_load_dwordx4 v244, s[28:31], s47 offen nt lds
  s_add_u32 m0, s48, 2048
  s_add_u32 s47, s82, 16384
  buffer_load_dwordx4 v244, s[28:31], s47 offen nt lds
  s_add_u32 m0, s48, 3072
  s_add_u32 s47, s82, 24576
  buffer_load_dwordx4 v244, s[28:31], s47 offen nt lds
  ds_read_b128 v[232:235], v245
  s_add_u32 s91, s54, 13
  s_waitcnt lgkmcnt(0)
  v_min3_u32 v236, v232, v233, v234
  v_min_u32 v236, v236, v235
  v_cmp_gt_u32 vcc, s91, v236
  s_cbranch_vccz L_hf_w0
  s_waitcnt vmcnt(0)
  s_add_u32 s46, s54, 40
  v_mov_b32 v237, s46
  s_mov_b64 exec, 1
  ds_write_b32 v248, v237
  s_mov_b64 exec, -1
  s_call_b64 s[50:51], L_hspin
L_hf_w0:
  s_waitcnt lgkmcnt(0)
  s_add_u32 s82, s83, 13
  s_and_b32 s82, s82, 15
  s_lshl_b32 s82, s82, 15
  s_add_u32 s82, s82, s52
  s_add_u32 m0, s55, 0
  s_add_u32 s47, s82, 0
  buffer_load_dwordx4 v244, s[28:31], s47 offen nt lds
  s_add_u32 m0, s55, 1024
  s_add_u32 s47, s82, 8192
  buffer_load_dwordx4 v244, s[28:31], s47 offen nt lds
  s_add_u32 m0, s55, 2048
  s_add_u32 s47, s82, 16384
  buffer_load_dwordx4 v244, s[28:31], s47 offen nt lds
  s_add_u32 m0, s55, 3072
  s_add_u32 s47, s82, 24576
  buffer_load_dwordx4 v244, s[28:31], s47 offen nt lds
  s_add_u32 s82, s83, 14
  s_and_b32 s82, s82, 15
  s_lshl_b32 s82, s82, 15
  s_add_u32 s82, s82, s52
  s_add_u32 m0, s55, 4096
  s_add_u32 s47, s82, 0
  buffer_load_dwordx4 v244, s[28:31], s47 offen nt lds
  s_add_u32 m0, s55, 5120
  s_add_u32 s47, s82, 8192
  buffer_load_dwordx4 v244, s[28:31], s47 offen nt lds
  s_add_u32 m0, s55, 6144
  s_add_u32 s47, s82, 16384
  buffer_load_dwordx4 v244, s[28:31], s47 offen nt lds
  s_add_u32 m0, s55, 7168
  s_add_u32 s47, s82, 24576
  buffer_load_dwordx4 v244, s[28:31], s47 offen nt lds
  ds_read_b128 v[232:235], v245
  s_add_u32 s91, s54, 14
  s_waitcnt lgkmcnt(0)
  v_min3_u32 v236, v232, v233, v234
  v_min_u32 v236, v236, v235
  v_cmp_gt_u32 vcc, s91, v236
  s_cbranch_vccz L_hf_w1
  s_waitcnt vmcnt(0)
  s_add_u32 s46, s54, 40
  v_mov_b32 v237, s46
  s_mov_b64 exec, 1
  ds_write_b32 v248, v237
  s_mov_b64 exec, -1
  s_call_b64 s[50:51], L_hspin
L_hf_w1:
  s_waitcnt lgkmcnt(0)
  s_add_u32 s82, s83, 15
  s_and_b32 s82, s82, 15
  s_lshl_b32 s82, s82, 15
  s_add_u32 s82, s82, s52
  s_add_u32 m0, s55, 32768
  s_add_u32 s47, s82, 0
  buffer_load_dwordx4 v244, s[28:31], s47 offen nt lds
  s_add_u32 m0, s55, 33792
  s_add_u32 s47, s82, 8192
  buffer_load_dwordx4 v244, s[28:31], s47 offen nt lds
  s_add_u32 m0, s55, 34816
  s_add_u32 s47, s82, 16384
  buffer_load_dwordx4 v244, s[28:31], s47 offen nt lds
  s_add_u32 m0, s55, 35840
  s_add_u32 s47, s82, 24576
  buffer_load_dwordx4 v244, s[28:31], s47 offen nt lds
  s_sub_u32 s42, s55, s48
  v_add_u32 v240, s42, v246
  v_add_u32 v241, s42, v247
  v_add_u32 v242, 0x10000, v240
  v_add_u32 v243, 0x10000, v241
  v_mov_b32 v253, v248
  v_xor_b32 v248, v251, v254
  v_lshlrev_b32 v248, 4, v248
  v_lshl_add_u32 v248, v252, 10, v248
  v_add_u32 v248, 98304, v248
  s_lshr_b32 s42, s2, 3
  s_lshl_b32 s42, s42, 18
  s_lshl_b32 s43, s8, 16
  s_add_u32 s42, s42, s43
  s_lshl_b32 s43, s89, 12
  s_add_u32 s42, s42, s43
  s_add_u32 s45, s42, 16777216
  s_add_u32 s46, s45, 32768
  s_waitcnt vmcnt(0) lgkmcnt(0)
  s_barrier
  s_lshl_b32 s83, s83, 6
  s_add_u32 s82, s83, 0
  s_and_b32 s82, s82, 0x3e0
  v_xor_b32 v244, s82, v248
  ds_read_b128 v[224:227], v244
  s_add_u32 s82, s83, 32
  s_and_b32 s82, s82, 0x3e0
  v_xor_b32 v245, s82, v248
  ds_read_b128 v[228:231], v245
  s_add_u32 s82, s83, 64
  s_and_b32 s82, s82, 0x3e0
  v_xor_b32 v244, s82, v248
  ds_read_b128 v[232:235], v244
  s_add_u32 s82, s83, 96
  s_and_b32 s82, s82, 0x3e0
  v_xor_b32 v245, s82, v248
  ds_read_b128 v[236:239], v245
  s_waitcnt lgkmcnt(3)
  v_mfma_f32_32x32x16_bf16 v[192:207], v[0:3], v[224:227], 0
  v_mfma_f32_32x32x16_bf16 v[208:223], v[4:7], v[224:227], 0
  s_add_u32 s82, s83, 128
  s_and_b32 s82, s82, 0x3e0
  v_xor_b32 v244, s82, v248
  ds_read_b128 v[224:227], v244
  s_waitcnt lgkmcnt(3)
  v_mfma_f32_32x32x16_bf16 v[192:207], v[8:11], v[228:231], v[192:207]
  v_mfma_f32_32x32x16_bf16 v[208:223], v[12:15], v[228:231], v[208:223]
  s_add_u32 s82, s83, 160
  s_and_b32 s82, s82, 0x3e0
  v_xor_b32 v245, s82, v248
  ds_read_b128 v[228:231], v245
  s_waitcnt lgkmcnt(3)
  v_mfma_f32_32x32x16_bf16 v[192:207], v[16:19], v[232:235], v[192:207]
  v_mfma_f32_32x32x16_bf16 v[208:223], v[20:23], v[232:235], v[208:223]
  ds_read_b64_tr_b16 v[0:1], v246 offset:0
  ds_read_b64_tr_b16 v[2:3], v246 offset:512
  ds_read_b64_tr_b16 v[4:5], v247 offset:0
  ds_read_b64_tr_b16 v[6:7], v247 offset:512
  ds_read_b64_tr_b16 v[8:9], v246 offset:2048
  ds_read_b64_tr_b16 v[10:11], v246 offset:2560
  ds_read_b64_tr_b16 v[12:13], v247 offset:2048
  ds_read_b64_tr_b16 v[14:15], v247 offset:2560
  s_add_u32 s82, s83, 192
  s_and_b32 s82, s82, 0x3e0
  v_xor_b32 v244, s82, v248
  ds_read_b128 v[232:235], v244
  s_waitcnt lgkmcnt(11)
  v_mfma_f32_32x32x16_bf16 v[192:207], v[24:27], v[236:239], v[192:207]
  v_mfma_f32_32x32x16_bf16 v[208:223], v[28:31], v[236:239], v[208:223]
  s_add_u32 s82, s83, 224
  s_and_b32 s82, s82, 0x3e0
  v_xor_b32 v245, s82, v248
  ds_read_b128 v[236:239], v245
  s_waitcnt lgkmcnt(11)
  v_mfma_f32_32x32x16_bf16 v[192:207], v[32:35], v[224:227], v[192:207]
  v_mfma_f32_32x32x16_bf16 v[208:223], v[36:39], v[224:227], v[208:223]
  ds_read_b64_tr_b16 v[16:17], v240 offset:0
  ds_read_b64_tr_b16 v[18:19], v240 offset:512
  ds_read_b64_tr_b16 v[20:21], v241 offset:0
  ds_read_b64_tr_b16 v[22:23], v241 offset:512
  ds_read_b64_tr_b16 v[24:25], v240 offset:2048
  ds_read_b64_tr_b16 v[26:27], v240 offset:2560
  ds_read_b64_tr_b16 v[28:29], v241 offset:2048
  ds_read_b64_tr_b16 v[30:31], v241 offset:2560
  s_add_u32 s82, s83, 256
  s_and_b32 s82, s82, 0x3e0
  v_xor_b32 v244, s82, v248
  ds_read_b128 v[224:227], v244
  s_waitcnt lgkmcnt(15)
  v_mfma_f32_32x32x16_bf16 v[192:207], v[40:43], v[228:231], v[192:207]
  v_mfma_f32_32x32x16_bf16 v[208:223], v[44:47], v[228:231], v[208:223]
  s_add_u32 s82, s83, 288
  s_and_b32 s82, s82, 0x3e0
  v_xor_b32 v245, s82, v248
  ds_read_b128 v[228:231], v245
  s_waitcnt lgkmcnt(11)
  v_mfma_f32_32x32x16_bf16 v[192:207], v[48:51], v[232:235], v[192:207]
  v_mfma_f32_32x32x16_bf16 v[208:223], v[52:55], v[232:235], v[208:223]
  ds_read_b64_tr_b16 v[32:33], v240 offset:4096
  ds_read_b64_tr_b16 v[34:35], v240 offset:4608
  ds_read_b64_tr_b16 v[36:37], v241 offset:4096
  ds_read_b64_tr_b16 v[38:39], v241 offset:4608
  ds_read_b64_tr_b16 v[40:41], v240 offset:6144
  ds_read_b64_tr_b16 v[42:43], v240 offset:6656
  ds_read_b64_tr_b16 v[44:45], v241 offset:6144
  ds_read_b64_tr_b16 v[46:47], v241 offset:6656
  s_add_u32 s82, s83, 320
  s_and_b32 s82, s82, 0x3e0
  v_xor_b32 v244, s82, v248
  ds_read_b128 v[232:235], v244
  s_waitcnt lgkmcnt(15)
  v_mfma_f32_32x32x16_bf16 v[192:207], v[56:59], v[236:239], v[192:207]
  v_mfma_f32_32x32x16_bf16 v[208:223], v[60:63], v[236:239], v[208:223]
  s_add_u32 s82, s83, 352
  s_and_b32 s82, s82, 0x3e0
  v_xor_b32 v245, s82, v248
  ds_read_b128 v[236:239], v245
  s_waitcnt lgkmcnt(11)
  v_mfma_f32_32x32x16_bf16 v[192:207], v[64:67], v[224:227], v[192:207]
  v_mfma_f32_32x32x16_bf16 v[208:223], v[68:71], v[224:227], v[208:223]
  ds_read_b64_tr_b16 v[48:49], v240 offset:32768
  ds_read_b64_tr_b16 v[50:51], v240 offset:33280
  ds_read_b64_tr_b16 v[52:53], v241 offset:32768
  ds_read_b64_tr_b16 v[54:55], v241 offset:33280
  ds_read_b64_tr_b16 v[56:57], v240 offset:34816
  ds_read_b64_tr_b16 v[58:59], v240 offset:35328
  ds_read_b64_tr_b16 v[60:61], v241 offset:34816
  ds_read_b64_tr_b16 v[62:63], v241 offset:35328
  s_add_u32 s82, s83, 384
  s_and_b32 s82, s82, 0x3e0
  v_xor_b32 v244, s82, v248
  ds_read_b128 v[224:227], v244
  s_waitcnt lgkmcnt(15)
  v_mfma_f32_32x32x16_bf16 v[192:207], v[72:75], v[228:231], v[192:207]
  v_mfma_f32_32x32x16_bf16 v[208:223], v[76:79], v[228:231], v[208:223]
  s_add_u32 s82, s83, 416
  s_and_b32 s82, s82, 0x3e0
  v_xor_b32 v245, s82, v248
  ds_read_b128 v[228:231], v245
  s_waitcnt lgkmcnt(11)
  v_mfma_f32_32x32x16_bf16 v[192:207], v[80:83], v[232:235], v[192:207]
  v_mfma_f32_32x32x16_bf16 v[208:223], v[84:87], v[232:235], v[208:223]
  s_add_u32 s82, s83, 448
  s_and_b32 s82, s82, 0x3e0
  v_xor_b32 v244, s82, v248
  ds_read_b128 v[232:235], v244
  s_waitcnt lgkmcnt(11)
  v_mfma_f32_32x32x16_bf16 v[192:207], v[88:91], v[236:239], v[192:207]
  v_mfma_f32_32x32x16_bf16 v[208:223], v[92:95], v[236:239], v[208:223]
  s_add_u32 s82, s83, 480
  s_and_b32 s82, s82, 0x3e0
  v_xor_b32 v245, s82, v248
  ds_read_b128 v[236:239], v245
  s_waitcnt lgkmcnt(3)
  v_mfma_f32_32x32x16_bf16 v[192:207], v[96:99], v[224:227], v[192:207]
  v_mfma_f32_32x32x16_bf16 v[208:223], v[100:103], v[224:227], v[208:223]
  s_add_u32 s82, s83, 512
  s_and_b32 s82, s82, 0x3e0
  v_xor_b32 v244, s82, v248
  ds_read_b128 v[224:227], v244
  s_waitcnt lgkmcnt(3)
  v_mfma_f32_32x32x16_bf16 v[192:207], v[104:107], v[228:231], v[192:207]
  v_mfma_f32_32x32x16_bf16 v[208:223], v[108:111], v[228:231], v[208:223]
  s_add_u32 s82, s83, 544
  s_and_b32 s82, s82, 0x3e0
  v_xor_b32 v245, s82, v248
  ds_read_b128 v[228:231], v245
  s_waitcnt lgkmcnt(3)
  v_mfma_f32_32x32x16_bf16 v[192:207], v[112:115], v[232:235], v[192:207]
  v_mfma_f32_32x32x16_bf16 v[208:223], v[116:119], v[232:235], v[208:223]
  s_add_u32 s82, s83, 576
  s_and_b32 s82, s82, 0x3e0
  v_xor_b32 v244, s82, v248
  ds_read_b128 v[232:235], v244
  s_waitcnt lgkmcnt(3)
  v_mfma_f32_32x32x16_bf16 v[192:207], v[120:123], v[236:239], v[192:207]
  v_mfma_f32_32x32x16_bf16 v[208:223], v[124:127], v[236:239], v[208:223]
  s_add_u32 s82, s83, 608
  s_and_b32 s82, s82, 0x3e0
  v_xor_b32 v245, s82, v248
  ds_read_b128 v[236:239], v245
  s_waitcnt lgkmcnt(3)
  v_mfma_f32_32x32x16_bf16 v[192:207], v[128:131], v[224:227], v[192:207]
  v_mfma_f32_32x32x16_bf16 v[208:223], v[132:135], v[224:227], v[208:223]
  s_add_u32 s82, s83, 640
  s_and_b32 s82, s82, 0x3e0
  v_xor_b32 v244, s82, v248
  ds_read_b128 v[224:227], v244
  s_waitcnt lgkmcnt(3)
  v_mfma_f32_32x32x16_bf16 v[192:207], v[136:139], v[228:231], v[192:207]
  v_mfma_f32_32x32x16_bf16 v[208:223], v[140:143], v[228:231], v[208:223]
  s_add_u32 s82, s83, 672
  s_and_b32 s82, s82, 0x3e0
  v_xor_b32 v245, s82, v248
  ds_read_b128 v[228:231], v245
  s_waitcnt lgkmcnt(3)
  v_mfma_f32_32x32x16_bf16 v[192:207], v[144:147], v[232:235], v[192:207]
  v_mfma_f32_32x32x16_bf16 v[208:223], v[148:151], v[232:235], v[208:223]
  s_add_u32 s82, s83, 704
  s_and_b32 s82, s82, 0x3e0
  v_xor_b32 v244, s82, v248
  ds_read_b128 v[232:235], v244
  s_waitcnt lgkmcnt(3)
  v_mfma_f32_32x32x16_bf16 v[192:207], v[152:155], v[236:239], v[192:207]
  v_mfma_f32_32x32x16_bf16 v[208:223], v[156:159], v[236:239], v[208:223]
  s_add_u32 s82, s83, 736
  s_and_b32 s82, s82, 0x3e0
  v_xor_b32 v245, s82, v248
  ds_read_b128 v[236:239], v245
  s_waitcnt lgkmcnt(3)
  v_mfma_f32_32x32x16_bf16 v[192:207], v[160:163], v[224:227], v[192:207]
  v_mfma_f32_32x32x16_bf16 v[208:223], v[164:167], v[224:227], v[208:223]
  s_add_u32 s82, s83, 768
  s_and_b32 s82, s82, 0x3e0
  v_xor_b32 v244, s82, v248
  ds_read_b128 v[224:227], v244
  s_waitcnt lgkmcnt(3)
  v_mfma_f32_32x32x16_bf16 v[192:207], v[168:171], v[228:231], v[192:207]
  v_mfma_f32_32x32x16_bf16 v[208:223], v[172:175], v[228:231], v[208:223]
  s_add_u32 s82, s83, 800
  s_and_b32 s82, s82, 0x3e0
  v_xor_b32 v245, s82, v248
  ds_read_b128 v[228:231], v245
  s_waitcnt lgkmcnt(3)
  v_mfma_f32_32x32x16_bf16 v[192:207], v[176:179], v[232:235], v[192:207]
  v_mfma_f32_32x32x16_bf16 v[208:223], v[180:183], v[232:235], v[208:223]
  s_add_u32 s82, s83, 832
  s_and_b32 s82, s82, 0x3e0
  v_xor_b32 v244, s82, v248
  ds_read_b128 v[232:235], v244
  s_waitcnt lgkmcnt(3)
  v_mfma_f32_32x32x16_bf16 v[192:207], v[184:187], v[236:239], v[192:207]
  v_mfma_f32_32x32x16_bf16 v[208:223], v[188:191], v[236:239], v[208:223]
  s_add_u32 s82, s83, 864
  s_and_b32 s82, s82, 0x3e0
  v_xor_b32 v245, s82, v248
  ds_read_b128 v[236:239], v245
  s_waitcnt lgkmcnt(3)
  v_mfma_f32_32x32x16_bf16 v[192:207], v[0:3], v[224:227], v[192:207]
  v_mfma_f32_32x32x16_bf16 v[208:223], v[4:7], v[224:227], v[208:223]
  s_add_u32 s82, s83, 896
  s_and_b32 s82, s82, 0x3e0
  v_xor_b32 v244, s82, v248
  ds_read_b128 v[224:227], v244
  s_waitcnt lgkmcnt(3)
  v_mfma_f32_32x32x16_bf16 v[192:207], v[8:11], v[228:231], v[192:207]
  v_mfma_f32_32x32x16_bf16 v[208:223], v[12:15], v[228:231], v[208:223]
  s_add_u32 s82, s83, 928
  s_and_b32 s82, s82, 0x3e0
  v_xor_b32 v245, s82, v248
  ds_read_b128 v[228:231], v245
  s_waitcnt lgkmcnt(3)
  v_mfma_f32_32x32x16_bf16 v[192:207], v[16:19], v[232:235], v[192:207]
  v_mfma_f32_32x32x16_bf16 v[208:223], v[20:23], v[232:235], v[208:223]
  s_add_u32 s82, s83, 960
  s_and_b32 s82, s82, 0x3e0
  v_xor_b32 v244, s82, v248
  ds_read_b128 v[232:235], v244
  s_waitcnt lgkmcnt(3)
  v_mfma_f32_32x32x16_bf16 v[192:207], v[24:27], v[236:239], v[192:207]
  v_mfma_f32_32x32x16_bf16 v[208:223], v[28:31], v[236:239], v[208:223]
  s_add_u32 s82, s83, 992
  s_and_b32 s82, s82, 0x3e0
  v_xor_b32 v245, s82, v248
  ds_read_b128 v[236:239], v245
  s_waitcnt lgkmcnt(3)
  v_mfma_f32_32x32x16_bf16 v[192:207], v[32:35], v[224:227], v[192:207]
  v_mfma_f32_32x32x16_bf16 v[208:223], v[36:39], v[224:227], v[208:223]
  s_waitcnt lgkmcnt(2)
  v_mfma_f32_32x32x16_bf16 v[192:207], v[40:43], v[228:231], v[192:207]
  v_mfma_f32_32x32x16_bf16 v[208:223], v[44:47], v[228:231], v[208:223]
  s_waitcnt lgkmcnt(1)
  v_mfma_f32_32x32x16_bf16 v[192:207], v[48:51], v[232:235], v[192:207]
  v_mfma_f32_32x32x16_bf16 v[208:223], v[52:55], v[232:235], v[208:223]
  s_waitcnt lgkmcnt(0)
  v_mfma_f32_32x32x16_bf16 v[192:207], v[56:59], v[236:239], v[192:207]
  v_mfma_f32_32x32x16_bf16 v[208:223], v[60:63], v[236:239], v[208:223]
  s_nop 10
  buffer_store_dwordx4 v[192:195], v250, s[32:35], s45 offen offset:0 sc1
  buffer_store_dwordx4 v[196:199], v250, s[32:35], s45 offen offset:1024 sc1
  buffer_store_dwordx4 v[200:203], v250, s[32:35], s45 offen offset:2048 sc1
  buffer_store_dwordx4 v[204:207], v250, s[32:35], s45 offen offset:3072 sc1
  buffer_store_dwordx4 v[208:211], v250, s[32:35], s46 offen offset:0 sc1
  buffer_store_dwordx4 v[212:215], v250, s[32:35], s46 offen offset:1024 sc1
  buffer_store_dwordx4 v[216:219], v250, s[32:35], s46 offen offset:2048 sc1
  buffer_store_dwordx4 v[220:223], v250, s[32:35], s46 offen offset:3072 sc1
  s_waitcnt vmcnt(0) lgkmcnt(0)
  s_add_u32 s53, s53, 0x8000
  s_lshl_b32 s42, s8, 2
  s_add_u32 s42, s42, s53
  v_mov_b32 v240, 1
  v_mov_b32 v241, 0
  s_mov_b64 exec, 1
  buffer_store_dword v240, v241, s[32:35], s42 offen offset:32 sc1
  s_mov_b64 exec, -1
  v_mov_b32 v243, 1
  s_mov_b64 exec, 1
  ds_write_b32 v253, v243 offset:96
  s_mov_b64 exec, -1
  s_branch L_end
L_end:
  s_endpgm
.section .rodata,"a"
.p2align 6
.amdhsa_kernel concat_heads__gqa_block_cached__gqa_block_cached__near_ridge_kernel
  .amdhsa_next_free_vgpr 256
  .amdhsa_next_free_sgpr 102
  .amdhsa_accum_offset 256
  .amdhsa_group_segment_fixed_size 0
  .amdhsa_kernarg_size 104
  .amdhsa_user_sgpr_count 2
  .amdhsa_user_sgpr_kernarg_segment_ptr 1
  .amdhsa_system_sgpr_workgroup_id_x 1
.end_amdhsa_kernel
.p2align 6
```
